```python
import torch

def _softmax(x, axis=-1):
    return torch.softmax(x, dim=axis)
def _gelu(x):
    return torch.nn.functional.gelu(x, approximate="tanh")
def _silu(x):
    return torch.nn.functional.silu(x)
def _sigmoid(x):
    return torch.sigmoid(x)
def _layernorm(x, axis=-1, eps=1e-5):
    m = x.mean(dim=axis, keepdim=True)
    v = x.var(dim=axis, keepdim=True, unbiased=False)
    return (x - m) / torch.sqrt(v + eps)
def _scatter_add(tgt, idx, src, axis=0):
    return tgt.clone().index_add_(axis, idx, src)
def _segment_sum(src, seg, n):
    out = torch.zeros((n,) + src.shape[1:], dtype=src.dtype)
    return out.index_add_(0, seg, src)
def _pad(x, pw):
    flat = tuple(v for pair in reversed(pw) for v in pair)
    return torch.nn.functional.pad(x, flat)

kernel_name = 'interleave_layers__sliding_local_dilated__linear_kernel_hedgehog__prompt'

def setup_inputs():

    _w = (lambda a: (lambda t: t.to(torch.bfloat16) if t.is_floating_point() else t)(torch.as_tensor(a)))
    def _A_setup():
        B, S, D = 1, 2048, 512
        return {
            "x": _w((lambda *s: torch.randn(*s, dtype=torch.bfloat16) * 0.05)(B, S, D)),
            "wqkv": _w((lambda *s: torch.randn(*s, dtype=torch.bfloat16) * 0.05)(D, 3 * D)),
            "wo": _w((lambda *s: torch.randn(*s, dtype=torch.bfloat16) * 0.05)(D, D)),
        }
    _A_in = _A_setup()

    def _B_setup():
        B, S, D, H = 1, 2048, 512, 32
        Dh = D // H
        return {
            "x": _w((lambda *s: torch.randn(*s, dtype=torch.bfloat16) * 0.05)(B, S, D)),
            "wqkv": _w((lambda *s: torch.randn(*s, dtype=torch.bfloat16) * 0.4)(D, 3 * D)),
            "w_phi": _w((lambda *s: torch.randn(*s, dtype=torch.bfloat16) * 0.4)(H, Dh, Dh) * (Dh ** -0.5)),
            "wo": _w((lambda *s: torch.randn(*s, dtype=torch.bfloat16) * 0.1)(D, D)),
        }
    _B_in = _B_setup()

    return {
        "A_x": _A_in["x"],
        "A_wqkv": _A_in["wqkv"],
        "A_wo": _A_in["wo"],
        "B_x": _B_in["x"],
        "B_wqkv": _B_in["wqkv"],
        "B_w_phi": _B_in["w_phi"],
        "B_wo": _B_in["wo"],
    }

def reference(A_x, A_wqkv, A_wo, B_x, B_wqkv, B_w_phi, B_wo):
    def _A_ref(x, wqkv, wo):
        B, S, D = x.shape
        H = 32; Dh = D // H
        W, dil = 8, 2
        qkv = (lambda x, *d: x.permute(*d))((x @ wqkv).reshape(B, S, 3, H, Dh), 2, 0, 3, 1, 4)
        q, k, v = qkv[0], qkv[1], qkv[2]
        scale = Dh ** -0.5
        pos = torch.arange(S)
        off = torch.arange(W) * dil
        idx = pos[:, None] - off[None, :]
        mask = idx >= 0
        idx_c = torch.where(mask, idx, 0).reshape(-1)
        kg = k[:, :, idx_c, :].reshape(B, H, S, W, Dh)
        vg = v[:, :, idx_c, :].reshape(B, H, S, W, Dh)
        logits = torch.einsum("bhsd,bhswd->bhsw", q, kg) * scale
        logits = torch.where(mask[None, None, :, :], logits, -1e9)
        attn = _softmax(logits, axis=-1)
        o = torch.einsum("bhsw,bhswd->bhsd", attn, vg)
        return (lambda x, *d: x.permute(*d))(o, 0, 2, 1, 3).reshape(B, S, D) @ wo

    def _B_ref(x, wqkv, w_phi, wo):
        B, S, D = x.shape
        H = 32; Dh = D // H
        qkv = (lambda x, *d: x.permute(*d))((x @ wqkv).reshape(B, S, 3, H, Dh), 2, 0, 3, 1, 4)
        q, k, v = qkv[0], qkv[1], qkv[2]
        pq = torch.einsum("bhsd,hdf->bhsf", q, w_phi)
        pk = torch.einsum("bhsd,hdf->bhsf", k, w_phi)
        phi_q = torch.concatenate([_softmax(pq, axis=-1), _softmax(-pq, axis=-1)], axis=-1)
        phi_k = torch.concatenate([_softmax(pk, axis=-1), _softmax(-pk, axis=-1)], axis=-1)
        kv = torch.einsum("bhsf,bhsd->bhfd", phi_k, v)
        z  = torch.einsum("bhsf->bhf", phi_k)
        num = torch.einsum("bhqf,bhfd->bhqd", phi_q, kv)
        den = torch.einsum("bhqf,bhf->bhq", phi_q, z)[..., None] + 1e-6
        o = num / den
        return (lambda x, *d: x.permute(*d))(o, 0, 2, 1, 3).reshape(B, S, D) @ wo

    x = A_x
    x = x + _A_ref(_layernorm(x, axis=-1), A_wqkv, A_wo)
    x = x + _B_ref(_layernorm(x, axis=-1), B_wqkv, B_w_phi, B_wo)
    x = x + _A_ref(_layernorm(x, axis=-1), A_wqkv, A_wo)
    x = x + _B_ref(_layernorm(x, axis=-1), B_wqkv, B_w_phi, B_wo)
    return x
```

```asm
; @launch grid=(256,1,1) block=(256,1,1) lds=163840
.amdgcn_target "amdgcn-amd-amdhsa--gfx950"
.text
.globl interleave_layers__sliding_local_dilated__linear_kernel_hedgehog__prompt_kernel
.p2align 8
.type interleave_layers__sliding_local_dilated__linear_kernel_hedgehog__prompt_kernel,@function
interleave_layers__sliding_local_dilated__linear_kernel_hedgehog__prompt_kernel:
    s_cmp_ge_u32 s2, 256
    s_cbranch_scc1 L_end
    s_load_dwordx16 s[84:99], s[0:1], 0
    s_load_dwordx4 s[40:43], s[0:1], 64
    s_getpc_b64 s[100:101]
L_pc:
    s_mov_b32 m0, 158720
    v_lshlrev_b32 v12, 7, v0
    v_min_u32 v13, L_last-L_pc, v12
    v_lshrrev_b32 v14, 6, v0
    global_load_lds_dword v13, s[100:101]
    v_add_u32 v12, 0x8000, v12
    v_min_u32 v13, L_last-L_pc, v12
    v_readfirstlane_b32 s3, v14
    global_load_lds_dword v13, s[100:101]
    v_and_b32 v15, 63, v0
    v_lshlrev_b32 v0, 4, v15
    v_mov_b32 v1, 0
    s_and_b32 s6, s2, 7
    s_lshr_b32 s80, s2, 3
    s_and_b32 s4, s80, 7
    s_lshr_b32 s7, s80, 3
    s_lshl_b32 s5, s6, 2
    s_add_u32 s5, s5, s7
    s_lshl_b32 s60, s6, 1
    s_max_u32 s61, s5, 1
    s_lshl_b32 s62, s3, 10
    s_mul_i32 s63, s3, 3072
    s_mov_b32 s49, 0x80000
    v_lshrrev_b32 v12, 4, v0
    v_lshrrev_b32 v13, 3, v12
    v_and_b32 v14, 7, v12
    v_lshrrev_b32 v15, 1, v13
    v_xor_b32 v14, v14, v15
    v_lshlrev_b32 v14, 4, v14
    v_lshl_add_u32 v16, v13, 11, v14
    s_lshl_b32 s80, s5, 6
    s_and_b32 s81, s3, 1
    s_lshl_b32 s82, s3, 4
    s_add_u32 s82, s82, s80
    s_lshl_b32 s82, s82, 10
    s_lshl_b32 s80, s61, 6
    s_sub_u32 s80, s80, 16
    s_add_u32 s80, s80, s81
    s_lshl_b32 s80, s80, 10
    s_lshl_b32 s81, s81, 6
    v_xor_b32 v19, s81, v16
    v_add_u32 v17, s82, v19
    v_add_u32 v19, s80, v19
    v_lshrrev_b32 v12, 4, v0
    v_lshrrev_b32 v22, 3, v12
    s_lshl_b32 s80, s3, 3
    v_add_u32 v22, s80, v22
    v_mul_u32_u24 v22, 3072, v22
    v_bfe_u32 v13, v12, 4, 1
    s_and_b32 s81, s3, 1
    s_lshl_b32 s81, s81, 1
    v_or_b32 v13, s81, v13
    v_lshlrev_b32 v13, 1, v13
    v_and_b32 v12, 7, v12
    v_xor_b32 v12, v12, v13
    v_lshl_add_u32 v22, v12, 4, v22
    s_lshl_b32 s80, s4, 7
    v_add_u32 v22, s80, v22
    s_lshr_b32 s48, s2, 3
    s_lshl_b32 s48, s48, 2
    s_add_u32 s48, s48, s3
    v_lshrrev_b32 v80, 4, v0
    v_min_u32 v80, 11, v80
    v_lshl_add_u32 v80, v80, 7, s48
    s_mul_i32 s80, s60, 96
    v_add_u32 v80, s80, v80
    v_subrev_u32 v81, 1536, v80
    v_min_u32 v80, v80, v81
    v_lshlrev_b32 v80, 10, v80
    v_add_u32 v2, 384, v80
    v_bfe_u32 v3, v0, 4, 2
    v_lshl_add_u32 v3, v3, 7, s48
    v_lshlrev_b32 v3, 10, v3
    v_add_u32 v3, 384, v3
    s_getreg_b32 s51, hwreg(HW_REG_XCC_ID, 0, 4)
    s_mov_b32 s52, 1069066811
    s_mov_b32 s53, 1069066811
    s_mov_b32 s50, 0x3f803f80
    s_mov_b32 s54, 0xff00ff00
    s_mov_b32 s55, 0xff00ff00
    s_mov_b32 s56, 0x00f0000f
    s_mov_b32 s57, 0xf0000f00
    s_lshl_b32 s83, s6, 20
    s_lshl_b32 s81, s7, 7
    s_add_u32 s75, s83, s81
    s_add_u32 s75, s75, 933888
    s_lshl_b32 s81, s4, 4
    s_add_u32 s74, s75, s81
    s_lshl_b32 s81, s3, 2
    s_add_u32 s74, s74, s81
    s_lshl_b32 s81, s7, 12
    s_add_u32 s73, s83, s81
    s_add_u32 s73, s73, s62
    s_add_u32 s73, s73, 524288
    s_lshl_b32 s81, s4, 7
    s_add_u32 s72, s73, s81
    s_lshl_b32 s81, s4, 2
    s_add_u32 s81, s81, s3
    s_mul_i32 s81, s81, 12288
    s_add_u32 s77, s83, s81
    s_add_u32 s77, s77, 540672
    s_lshl_b32 s81, s7, 16
    s_add_u32 s83, s83, s81
    s_lshl_b32 s81, s3, 14
    s_add_u32 s66, s83, s81
    s_add_u32 s67, s66, 4096
    s_add_u32 s68, s66, 8192
    s_add_u32 s69, s66, 12288
    s_lshl_b32 s81, s4, 1
    s_sub_u32 s81, s81, s60
    s_and_b32 s81, s81, 15
    s_lshl_b32 s82, s81, 10
    s_add_u32 s64, s83, s82
    s_lshl_b32 s82, s3, 9
    s_add_u32 s64, s64, s82
    s_add_u32 s65, s64, 32768
    s_lshl_b32 s82, s81, 12
    s_add_u32 s70, s83, s82
    s_add_u32 s70, s70, s62
    s_add_u32 s70, s70, 262144
    s_add_u32 s71, s70, 4096
    s_and_b32 s81, s3, 1
    s_lshl_b32 s81, s81, 10
    s_lshr_b32 s82, s3, 1
    s_lshl_b32 s82, s82, 12
    s_add_u32 s78, s81, s82
    s_add_u32 s79, s83, 262144
    v_mov_b32 v76, -1
    v_mov_b32 v77, -1
    v_mov_b32 v78, -1
    v_mov_b32 v79, -1
    v_mov_b32 v104, 0
    v_mov_b32 v105, 0
    v_mov_b32 v106, 0
    v_mov_b32 v107, 0
    s_lshl_b32 s44, s4, 2
    s_add_u32 s44, s44, s7
    s_lshl_b32 s44, s44, 3
    s_add_u32 s44, s44, s6
    s_lshl_b32 s45, s44, 7
    s_add_u32 s45, s45, 9502720
    s_lshl_b32 s44, s44, 10
    s_add_u32 s44, s44, 8978432
    s_add_u32 s46, s44, 0x40000
    v_and_b32 v100, 0x70, v0
    v_bfe_u32 v101, v0, 7, 1
    v_lshl_add_u32 v100, v101, 15, v100
    s_mul_i32 s47, s51, s51
    s_lshl_b32 s47, s47, 16
    s_lshl_b32 s80, s51, 6
    s_add_u32 s47, s47, s80
    s_add_u32 s51, s47, 1
    v_lshrrev_b32 v6, 4, v0
    v_min_u32 v7, 11, v6
    v_lshlrev_b32 v7, 7, v7
    s_lshl_b32 s80, s2, 2
    s_add_u32 s80, s80, s3
    s_mul_i32 s80, s80, 1536
    v_add_u32 v7, s80, v7
    v_and_b32 v8, 3, v6
    v_lshlrev_b32 v8, 7, v8
    s_lshl_b32 s80, s2, 2
    s_add_u32 s80, s80, s3
    s_lshl_b32 s80, s80, 9
    v_add_u32 v8, s80, v8
    v_min_u32 v6, 19, v6
    v_lshlrev_b32 v6, 7, v6
    s_lshl_b32 s80, s4, 2
    s_add_u32 s80, s80, s3
    s_mul_i32 s80, s80, 2560
    s_lshl_b32 s81, s5, 16
    s_add_u32 s80, s80, s81
    s_sub_u32 s80, s80, 16384
    v_add_u32 v6, s80, v6
    v_max_i32 v6, 0, v6
    s_add_u32 s16, s5, 1
    s_lshr_b32 s17, s16, 2
    s_sub_u32 s17, s4, s17
    s_and_b32 s17, s17, 7
    s_lshl_b32 s17, s17, 11
    s_lshl_b32 s18, s16, 14
    s_add_u32 s18, s18, s17
    s_lshl_b32 s17, s3, 6
    s_and_b32 s17, s17, 0
    s_add_u32 s18, s18, s17
    s_add_u32 s18, s18, 8388608
    s_lshl_b32 s19, s16, 10
    s_lshl_b32 s16, s4, 7
    s_add_u32 s19, s19, s16
    s_lshr_b32 s17, s17, 2
    s_add_u32 s19, s19, s17
    s_add_u32 s19, s19, 8929280
    v_and_b32 v102, 0x70, v0
    s_waitcnt lgkmcnt(0)
    s_mov_b32 s36, s42
    s_mov_b32 s37, s43
    s_mov_b32 s38, 9895936
    s_mov_b32 s39, 0x20000
    s_mov_b32 s8, s84
    s_mov_b32 s9, s85
    s_mov_b32 s10, 2097152
    s_mov_b32 s11, 0x20000
    s_mov_b32 s12, s86
    s_mov_b32 s13, s87
    s_mov_b32 s14, 1572864
    s_mov_b32 s15, 0x20000
    s_lshr_b32 s76, s3, 1
    s_lshl_b32 s76, s76, 14
    s_and_b32 s87, s3, 1
    s_lshl_b32 s87, s87, 10
    s_add_u32 s76, s76, s87
    s_and_b32 s87, s3, 2
    s_add_u32 s87, s87, s60
    s_mov_b32 m0, 158720
    s_add_u32 s82, s60, 0
    buffer_load_dword v2, s[12:15], 0 offen lds
    s_and_b32 s82, s82, 15
    buffer_load_dword v6, s[8:11], 0 offen lds
    s_lshl_b32 s82, s82, 6
    s_add_u32 m0, s76, 0
    s_add_u32 s84, s60, 0
    buffer_load_dwordx4 v17, s[8:11], s82 offen offset:0 lds
    s_add_u32 s82, s60, 0
    s_and_b32 s82, s82, 15
    s_lshl_b32 s82, s82, 6
    s_add_u32 m0, s76, 31744
    s_and_b32 s84, s84, 15
    buffer_load_dwordx4 v17, s[8:11], s82 offen offset:1024 lds
    s_mul_i32 s84, s84, 98304
    s_add_u32 m0, s63, 81920
    s_add_u32 s85, s60, 1
    buffer_load_dwordx4 v22, s[12:15], s84 offen offset:0 lds
    s_and_b32 s85, s85, 15
    buffer_load_dwordx4 v22, s[12:15], s84 offen offset:1024 lds
    s_mul_i32 s85, s85, 98304
    buffer_load_dwordx4 v22, s[12:15], s84 offen offset:2048 lds
    s_add_u32 m0, s63, 94208
    s_add_u32 s83, s60, 2
    buffer_load_dwordx4 v22, s[12:15], s85 offen offset:0 lds
    s_and_b32 s83, s83, 15
    buffer_load_dwordx4 v22, s[12:15], s85 offen offset:1024 lds
    s_lshl_b32 s83, s83, 6
    buffer_load_dwordx4 v22, s[12:15], s85 offen offset:2048 lds
    s_add_u32 m0, s76, 2048
    s_add_u32 s84, s60, 2
    buffer_load_dwordx4 v17, s[8:11], s83 offen offset:0 lds
    s_add_u32 s83, s60, 2
    s_and_b32 s83, s83, 15
    s_lshl_b32 s83, s83, 6
    s_add_u32 m0, s76, 33792
    s_and_b32 s84, s84, 15
    buffer_load_dwordx4 v17, s[8:11], s83 offen offset:1024 lds
    s_mul_i32 s84, s84, 98304
    s_add_u32 m0, s63, 106496
    s_add_u32 s85, s60, 3
    buffer_load_dwordx4 v22, s[12:15], s84 offen offset:0 lds
    s_and_b32 s85, s85, 15
    buffer_load_dwordx4 v22, s[12:15], s84 offen offset:1024 lds
    s_mul_i32 s85, s85, 98304
    buffer_load_dwordx4 v22, s[12:15], s84 offen offset:2048 lds
    s_add_u32 m0, s63, 118784
    s_add_u32 s84, s60, 4
    buffer_load_dwordx4 v22, s[12:15], s85 offen offset:0 lds
    s_and_b32 s84, s84, 15
    s_mul_i32 s84, s84, 98304
    s_mov_b32 s20, s92
    s_mov_b32 s21, s93
    s_mov_b32 s22, 1572864
    s_mov_b32 s23, 0x20000
    s_mov_b32 s24, s96
    s_mov_b32 s25, s97
    s_mov_b32 s26, 524288
    s_mov_b32 s27, 0x20000
    buffer_load_dwordx4 v22, s[12:15], s85 offen offset:1024 lds
    v_lshrrev_b32 v84, 4, v0
    v_and_b32 v85, 15, v84
    v_lshrrev_b32 v86, 2, v84
    v_and_b32 v86, 12, v86
    v_sub_u32 v87, v86, v85
    v_mov_b32 v93, 0xf149f2ca
    v_add_u32 v92, 0, v87
    v_lshrrev_b32 v96, 4, v0
    v_lshrrev_b32 v23, 4, v96
    buffer_load_dwordx4 v22, s[12:15], s85 offen offset:2048 lds
    s_add_u32 m0, s63, 131072
    v_mul_u32_u24 v23, 3072, v23
    v_bfe_u32 v97, v96, 2, 2
    v_lshl_add_u32 v23, v97, 7, v23
    v_and_b32 v97, 3, v96
    v_lshl_add_u32 v23, v97, 3, v23
    v_bfe_u32 v97, v96, 3, 2
    v_xor_b32 v97, s3, v97
    v_lshl_add_u32 v23, v97, 5, v23
    buffer_load_dwordx4 v22, s[12:15], s84 offen offset:0 lds
    v_add_u32 v23, 81920, v23
    v_mov_b32 v24, s50
    v_mov_b32 v25, s50
    v_mov_b32 v26, s50
    v_mov_b32 v27, s50
    v_lshrrev_b32 v20, 4, v0
    v_bfe_u32 v21, v20, 1, 3
    v_lshrrev_b32 v12, 4, v20
    v_xor_b32 v21, v21, v12
    buffer_load_dwordx4 v22, s[12:15], s84 offen offset:1024 lds
    v_lshlrev_b32 v21, 4, v21
    v_and_b32 v12, 15, v20
    v_lshl_add_u32 v12, v12, 7, v21
    v_xor_b32 v13, 64, v12
    v_add_u32 v14, 65536, v12
    v_add_u32 v15, 65536, v13
    s_lshl_b32 s96, s3, 14
    v_add_u32 v20, s96, v12
    v_add_u32 v21, s96, v13
    buffer_load_dwordx4 v22, s[12:15], s84 offen offset:2048 lds
    s_cmp_lg_u32 s3, 0
    s_cbranch_scc1 L1
    buffer_store_dwordx4 v[104:107], off, s[36:39], s74 sc1
    buffer_store_dwordx4 v[76:79], v0, s[36:39], s18 offen sc1
    buffer_store_dwordx4 v[76:79], v0, s[36:39], s18 offen offset:1024 sc1
    buffer_store_dwordx4 v[76:79], v102, s[36:39], s19 offen sc1
    buffer_store_dwordx4 v[76:79], v0, s[36:39], s44 offen sc1
    buffer_store_dwordx4 v[76:79], v0, s[36:39], s46 offen sc1
    buffer_store_dwordx4 v[76:79], v100, s[36:39], s45 offen sc1
L1:
    s_mov_b32 s16, s88
    s_mov_b32 s17, s89
    s_mov_b32 s18, 524288
    s_mov_b32 s19, 0x20000
    s_mov_b32 s32, s98
    s_mov_b32 s33, s99
    s_mov_b32 s34, 2097152
    s_mov_b32 s35, 0x20000
    s_add_u32 s44, s36, s79
    s_addc_u32 s45, s37, 0
    s_mov_b32 s46, 65536
    s_mov_b32 s47, 0x20000
    s_mov_b32 s28, s94
    s_mov_b32 s29, s95
    s_mov_b32 s30, 16384
    s_mov_b32 s31, 0x20000
    s_mov_b32 s42, 256
    s_mov_b32 s43, 0x20000
    s_cmp_eq_u32 s3, 0
    s_cselect_b32 s88, -7, 9
    s_cselect_b32 s89, 0, 64
    s_cmp_eq_u32 s3, 2
    s_cselect_b32 s88, 1, s88
    s_cselect_b32 s90, 7, 64
    s_cmp_ge_u32 s3, 2
    s_cselect_b32 s91, 1, 0
    s_cmp_eq_u32 s5, 0
    s_cselect_b32 s91, s91, 0
    s_cmp_eq_u32 s91, 1
    s_cselect_b32 s88, 64, s88
    v_cmp_le_i32 vcc, s88, v92
    s_add_u32 s91, s62, 159744
    s_and_b32 s97, s3, 1
    v_cndmask_b32 v88, v93, 0, vcc
    v_cmp_ge_i32 vcc, s89, v92
    v_add_u32 v92, 0, v86
    s_lshl_b32 s97, s97, 6
    v_cndmask_b32 v88, v93, v88, vcc
    v_cmp_ge_i32 vcc, s90, v92
    v_add_u32 v92, 1, v87
    v_xor_b32 v16, s97, v14
    v_cndmask_b32 v88, v93, v88, vcc
    v_cmp_le_i32 vcc, s88, v92
    s_lshr_b32 s98, s3, 1
    s_lshl_b32 s98, s98, 11
    v_cndmask_b32 v89, v93, 0, vcc
    v_cmp_ge_i32 vcc, s89, v92
    v_add_u32 v92, 1, v86
    v_add_u32 v16, s98, v16
    v_cndmask_b32 v89, v93, v89, vcc
    v_cmp_ge_i32 vcc, s90, v92
    v_add_u32 v92, 2, v87
    s_nop 0
    v_cndmask_b32 v89, v93, v89, vcc
    v_cmp_le_i32 vcc, s88, v92
    s_nop 1
    v_cndmask_b32 v90, v93, 0, vcc
    v_cmp_ge_i32 vcc, s89, v92
    v_add_u32 v92, 2, v86
    s_nop 0
    v_cndmask_b32 v90, v93, v90, vcc
    v_cmp_ge_i32 vcc, s90, v92
    v_add_u32 v92, 3, v87
    s_nop 0
    v_cndmask_b32 v90, v93, v90, vcc
    v_cmp_le_i32 vcc, s88, v92
    s_nop 1
    v_cndmask_b32 v91, v93, 0, vcc
    v_cmp_ge_i32 vcc, s89, v92
    v_add_u32 v92, 3, v86
    s_nop 0
    v_cndmask_b32 v91, v93, v91, vcc
    v_cmp_ge_i32 vcc, s90, v92
    v_add_u32 v92, s91, v0
    s_nop 0
    v_cndmask_b32 v91, v93, v91, vcc
    ds_write_b128 v92, v[88:91]
    s_add_u32 s85, s60, 5
    s_and_b32 s85, s85, 15
    s_mul_i32 s85, s85, 98304
    s_add_u32 m0, s63, 143360
    s_add_u32 s82, s60, 4
    s_and_b32 s82, s82, 15
    s_lshl_b32 s82, s82, 6
    s_add_u32 s84, s60, 6
    s_and_b32 s84, s84, 15
    s_mul_i32 s84, s84, 98304
    s_add_u32 s83, s60, 6
    s_and_b32 s83, s83, 15
    s_lshl_b32 s83, s83, 6
    s_lshl_b32 s91, s6, 5
    v_lshrrev_b32 v18, 4, v0
    v_lshrrev_b32 v10, 3, v18
    s_lshl_b32 s80, s3, 3
    v_add_u32 v10, s80, v10
    v_mul_u32_u24 v10, 1024, v10
    s_and_b32 s81, s3, 1
    s_lshl_b32 s81, s81, 1
    s_lshl_b32 s80, s4, 7
    s_add_u32 s86, s60, 10
    s_and_b32 s86, s86, 15
    s_mul_i32 s86, s86, 32768
    s_lshl_b32 s96, s3, 6
    s_add_u32 s96, s96, 155648
    s_lshl_b32 s97, s3, 7
    s_add_u32 s97, s97, 156672
    s_waitcnt vmcnt(14) lgkmcnt(0)
    s_barrier
    buffer_load_dwordx4 v22, s[12:15], s85 offen offset:0 lds
    ds_read_b64_tr_b16 a[0:1], v23 offset:0
    ds_read_b64_tr_b16 a[2:3], v23 offset:512
    ds_read_b64_tr_b16 a[4:5], v23 offset:1024
    buffer_load_dwordx4 v22, s[12:15], s85 offen offset:1024 lds
    ds_read_b64_tr_b16 a[6:7], v23 offset:1536
    ds_read_b64_tr_b16 a[8:9], v23 offset:2048
    ds_read_b64_tr_b16 a[10:11], v23 offset:2560
    buffer_load_dwordx4 v22, s[12:15], s85 offen offset:2048 lds
    ds_read_b128 v[28:31], v12 offset:0
    ds_read_b128 v[32:35], v12 offset:16384
    ds_read_b128 v[36:39], v12 offset:32768
    ds_read_b128 v[40:43], v12 offset:49152
    s_add_u32 m0, s76, 4096
    s_add_u32 s85, s60, 7
    buffer_load_dwordx4 v17, s[8:11], s82 offen offset:0 lds
    s_add_u32 s82, s60, 4
    s_and_b32 s82, s82, 15
    s_lshl_b32 s82, s82, 6
    s_add_u32 m0, s76, 35840
    s_and_b32 s85, s85, 15
    buffer_load_dwordx4 v17, s[8:11], s82 offen offset:1024 lds
    s_add_u32 s82, s87, 0
    s_and_b32 s82, s82, 15
    s_lshl_b32 s82, s82, 6
    s_add_u32 m0, s62, 65536
    s_mul_i32 s85, s85, 98304
    buffer_load_dwordx4 v19, s[8:11], s82 offen lds
    s_add_u32 m0, s63, 81920
    s_add_u32 s82, s60, 8
    s_and_b32 s82, s82, 15
    s_lshl_b32 s82, s82, 6
    s_waitcnt lgkmcnt(8)
    v_mfma_f32_16x16x32_bf16 v[116:119], a[0:3], v[24:27], 0
    v_mov_b32 v11, v22
    v_mov_b32 v8, v14
    s_waitcnt lgkmcnt(4)
    v_mfma_f32_16x16x32_bf16 v[120:123], a[4:7], v[24:27], 0
    s_waitcnt vmcnt(17)
    s_barrier
    v_mfma_f32_16x16x32_bf16 v[124:127], v[24:27], a[8:11], 0
    buffer_load_dwordx4 v22, s[12:15], s84 offen offset:0 lds
    ds_read_b64_tr_b16 a[12:13], v23 offset:12288
    s_waitcnt lgkmcnt(1)
    v_mfma_f32_16x16x32_bf16 v[76:79], a[4:7], v[28:31], 0
    buffer_load_dwordx4 v22, s[12:15], s84 offen offset:1024 lds
    ds_read_b64_tr_b16 a[14:15], v23 offset:12800
    v_mfma_f32_16x16x32_bf16 v[96:99], v[28:31], a[8:11], 0
    buffer_load_dwordx4 v22, s[12:15], s84 offen offset:2048 lds
    ds_read_b64_tr_b16 a[16:17], v23 offset:13312
    v_mfma_f32_16x16x32_bf16 v[60:63], a[0:3], v[28:31], 0
    ds_read_b64_tr_b16 a[18:19], v23 offset:13824
    ds_read_b64_tr_b16 a[20:21], v23 offset:14336
    v_mfma_f32_16x16x32_bf16 v[80:83], a[4:7], v[32:35], 0
    ds_read_b64_tr_b16 a[22:23], v23 offset:14848
    ds_read_b128 v[44:47], v13 offset:0
    v_mfma_f32_16x16x32_bf16 v[100:103], v[32:35], a[8:11], 0
    ds_read_b128 v[48:51], v13 offset:16384
    ds_read_b128 v[28:31], v13 offset:32768
    v_mfma_f32_16x16x32_bf16 v[64:67], a[0:3], v[32:35], 0
    ds_read_b128 v[32:35], v13 offset:49152
    s_add_u32 m0, s76, 6144
    v_mfma_f32_16x16x32_bf16 v[84:87], a[4:7], v[36:39], 0
    buffer_load_dwordx4 v17, s[8:11], s83 offen offset:0 lds
    s_add_u32 s83, s60, 6
    v_mfma_f32_16x16x32_bf16 v[104:107], v[36:39], a[8:11], 0
    s_and_b32 s83, s83, 15
    s_lshl_b32 s83, s83, 6
    v_mfma_f32_16x16x32_bf16 v[68:71], a[0:3], v[36:39], 0
    s_add_u32 m0, s76, 37888
    s_add_u32 s84, s60, 8
    v_mfma_f32_16x16x32_bf16 v[88:91], a[4:7], v[40:43], 0
    buffer_load_dwordx4 v17, s[8:11], s83 offen offset:1024 lds
    s_add_u32 m0, s63, 94208
    v_mfma_f32_16x16x32_bf16 v[108:111], v[40:43], a[8:11], 0
    s_and_b32 s84, s84, 15
    s_mul_i32 s84, s84, 98304
    v_mfma_f32_16x16x32_bf16 v[72:75], a[0:3], v[40:43], 0
    s_waitcnt vmcnt(17) lgkmcnt(3)
    s_barrier
    v_mfma_f32_16x16x32_bf16 v[116:119], a[12:15], v[24:27], v[116:119]
    buffer_load_dwordx4 v22, s[12:15], s85 offen offset:0 lds
    ds_read_b64_tr_b16 a[24:25], v23 offset:24576
    v_mfma_f32_16x16x32_bf16 v[120:123], a[16:19], v[24:27], v[120:123]
    buffer_load_dwordx4 v22, s[12:15], s85 offen offset:1024 lds
    ds_read_b64_tr_b16 a[26:27], v23 offset:25088
    v_mfma_f32_16x16x32_bf16 v[124:127], v[24:27], a[20:23], v[124:127]
    buffer_load_dwordx4 v22, s[12:15], s85 offen offset:2048 lds
    ds_read_b64_tr_b16 a[28:29], v23 offset:25600
    v_mfma_f32_16x16x32_bf16 v[76:79], a[16:19], v[44:47], v[76:79]
    ds_read_b64_tr_b16 a[30:31], v23 offset:26112
    ds_read_b64_tr_b16 a[32:33], v23 offset:26624
    v_mfma_f32_16x16x32_bf16 v[96:99], v[44:47], a[20:23], v[96:99]
    ds_read_b64_tr_b16 a[34:35], v23 offset:27136
    ds_read_b128 v[36:39], v12 offset:2048
    v_mfma_f32_16x16x32_bf16 v[60:63], a[12:15], v[44:47], v[60:63]
    ds_read_b128 v[40:43], v12 offset:18432
    ds_read_b128 v[44:47], v12 offset:34816
    s_waitcnt lgkmcnt(9)
    v_mfma_f32_16x16x32_bf16 v[80:83], a[16:19], v[48:51], v[80:83]
    s_add_u32 m0, s76, 8192
    s_add_u32 s83, s60, 10
    v_mfma_f32_16x16x32_bf16 v[100:103], v[48:51], a[20:23], v[100:103]
    buffer_load_dwordx4 v17, s[8:11], s82 offen offset:0 lds
    s_add_u32 s82, s60, 8
    v_mfma_f32_16x16x32_bf16 v[64:67], a[12:15], v[48:51], v[64:67]
    ds_read_b128 v[48:51], v12 offset:51200
    s_and_b32 s82, s82, 15
    v_mfma_f32_16x16x32_bf16 v[84:87], a[16:19], v[28:31], v[84:87]
    s_lshl_b32 s82, s82, 6
    s_add_u32 m0, s76, 39936
    v_mfma_f32_16x16x32_bf16 v[104:107], v[28:31], a[20:23], v[104:107]
    buffer_load_dwordx4 v17, s[8:11], s82 offen offset:1024 lds
    s_add_u32 s82, s87, 4
    v_mfma_f32_16x16x32_bf16 v[68:71], a[12:15], v[28:31], v[68:71]
    s_and_b32 s82, s82, 15
    s_waitcnt vmcnt(19) lgkmcnt(4)
    s_barrier
    v_mfma_f32_16x16x32_bf16 v[88:91], a[16:19], v[32:35], v[88:91]
    ds_read_b64_tr_b16 a[36:37], v23 offset:36864
    ds_read_b64_tr_b16 a[38:39], v23 offset:37376
    v_mfma_f32_16x16x32_bf16 v[108:111], v[32:35], a[20:23], v[108:111]
    ds_read_b64_tr_b16 a[40:41], v23 offset:37888
    ds_read_b64_tr_b16 a[42:43], v23 offset:38400
    v_mfma_f32_16x16x32_bf16 v[72:75], a[12:15], v[32:35], v[72:75]
    ds_read_b64_tr_b16 a[44:45], v23 offset:38912
    ds_read_b64_tr_b16 a[46:47], v23 offset:39424
    v_mfma_f32_16x16x32_bf16 v[116:119], a[24:27], v[24:27], v[116:119]
    ds_read_b128 v[28:31], v13 offset:2048
    ds_read_b128 v[32:35], v13 offset:18432
    v_mfma_f32_16x16x32_bf16 v[120:123], a[28:31], v[24:27], v[120:123]
    s_lshl_b32 s82, s82, 6
    s_add_u32 m0, s62, 69632
    v_mfma_f32_16x16x32_bf16 v[124:127], v[24:27], a[32:35], v[124:127]
    buffer_load_dwordx4 v19, s[8:11], s82 offen lds
    s_add_u32 m0, s63, 106496
    s_waitcnt lgkmcnt(8)
    v_mfma_f32_16x16x32_bf16 v[76:79], a[28:31], v[36:39], v[76:79]
    buffer_load_dwordx4 v22, s[12:15], s84 offen offset:0 lds
    s_and_b32 s83, s83, 15
    v_mfma_f32_16x16x32_bf16 v[96:99], v[36:39], a[32:35], v[96:99]
    buffer_load_dwordx4 v22, s[12:15], s84 offen offset:1024 lds
    s_lshl_b32 s83, s83, 6
    v_mfma_f32_16x16x32_bf16 v[60:63], a[24:27], v[36:39], v[60:63]
    buffer_load_dwordx4 v22, s[12:15], s84 offen offset:2048 lds
    ds_read_b128 v[36:39], v13 offset:34816
    v_mfma_f32_16x16x32_bf16 v[80:83], a[28:31], v[40:43], v[80:83]
    s_add_u32 m0, s76, 10240
    s_add_u32 s85, s60, 9
    v_mfma_f32_16x16x32_bf16 v[100:103], v[40:43], a[32:35], v[100:103]
    buffer_load_dwordx4 v17, s[8:11], s83 offen offset:0 lds
    s_add_u32 s83, s60, 10
    v_mfma_f32_16x16x32_bf16 v[64:67], a[24:27], v[40:43], v[64:67]
    ds_read_b128 v[40:43], v13 offset:51200
    s_and_b32 s83, s83, 15
    v_mfma_f32_16x16x32_bf16 v[84:87], a[28:31], v[44:47], v[84:87]
    s_waitcnt vmcnt(16) lgkmcnt(2)
    s_barrier
    v_mfma_f32_16x16x32_bf16 v[104:107], v[44:47], a[32:35], v[104:107]
    ds_read_b64_tr_b16 a[48:49], v23 offset:49152
    ds_read_b64_tr_b16 a[50:51], v23 offset:49664
    v_mfma_f32_16x16x32_bf16 v[68:71], a[24:27], v[44:47], v[68:71]
    ds_read_b64_tr_b16 a[52:53], v23 offset:50176
    ds_read_b64_tr_b16 a[54:55], v23 offset:50688
    v_mfma_f32_16x16x32_bf16 v[88:91], a[28:31], v[48:51], v[88:91]
    ds_read_b64_tr_b16 a[56:57], v23 offset:51200
    ds_read_b64_tr_b16 a[58:59], v23 offset:51712
    v_mfma_f32_16x16x32_bf16 v[108:111], v[48:51], a[32:35], v[108:111]
    ds_read_b128 v[44:47], v12 offset:4096
    s_lshl_b32 s83, s83, 6
    v_mfma_f32_16x16x32_bf16 v[72:75], a[24:27], v[48:51], v[72:75]
    ds_read_b128 v[48:51], v12 offset:20480
    s_add_u32 m0, s76, 41984
    v_mfma_f32_16x16x32_bf16 v[116:119], a[36:39], v[24:27], v[116:119]
    buffer_load_dwordx4 v17, s[8:11], s83 offen offset:1024 lds
    s_and_b32 s85, s85, 15
    v_mfma_f32_16x16x32_bf16 v[120:123], a[40:43], v[24:27], v[120:123]
    s_mul_i32 s85, s85, 98304
    s_add_u32 m0, s63, 118784
    v_mfma_f32_16x16x32_bf16 v[124:127], v[24:27], a[44:47], v[124:127]
    buffer_load_dwordx4 v22, s[12:15], s85 offen offset:0 lds
    s_add_u32 s82, s60, 12
    v_mfma_f32_16x16x32_bf16 v[76:79], a[40:43], v[28:31], v[76:79]
    buffer_load_dwordx4 v22, s[12:15], s85 offen offset:1024 lds
    s_and_b32 s82, s82, 15
    v_mfma_f32_16x16x32_bf16 v[96:99], v[28:31], a[44:47], v[96:99]
    buffer_load_dwordx4 v22, s[12:15], s85 offen offset:2048 lds
    s_lshl_b32 s82, s82, 6
    v_mfma_f32_16x16x32_bf16 v[60:63], a[36:39], v[28:31], v[60:63]
    ds_read_b128 v[28:31], v12 offset:36864
    s_add_u32 m0, s76, 12288
    v_mfma_f32_16x16x32_bf16 v[80:83], a[40:43], v[32:35], v[80:83]
    buffer_load_dwordx4 v17, s[8:11], s82 offen offset:0 lds
    s_add_u32 s82, s60, 12
    v_mfma_f32_16x16x32_bf16 v[100:103], v[32:35], a[44:47], v[100:103]
    s_and_b32 s82, s82, 15
    s_lshl_b32 s82, s82, 6
    v_mfma_f32_16x16x32_bf16 v[64:67], a[36:39], v[32:35], v[64:67]
    ds_read_b128 v[32:35], v12 offset:53248
    s_waitcnt vmcnt(20) lgkmcnt(2)
    s_barrier
    v_mfma_f32_16x16x32_bf16 v[84:87], a[40:43], v[36:39], v[84:87]
    ds_read_b64_tr_b16 a[60:61], v23 offset:61440
    ds_read_b64_tr_b16 a[62:63], v23 offset:61952
    v_mfma_f32_16x16x32_bf16 v[104:107], v[36:39], a[44:47], v[104:107]
    ds_read_b64_tr_b16 a[64:65], v23 offset:62464
    ds_read_b64_tr_b16 a[66:67], v23 offset:62976
    v_mfma_f32_16x16x32_bf16 v[68:71], a[36:39], v[36:39], v[68:71]
    ds_read_b64_tr_b16 a[68:69], v23 offset:63488
    ds_read_b64_tr_b16 a[70:71], v23 offset:64000
    v_mfma_f32_16x16x32_bf16 v[88:91], a[40:43], v[40:43], v[88:91]
    ds_read_b128 v[36:39], v20 offset:0
    s_add_u32 m0, s76, 44032
    v_mfma_f32_16x16x32_bf16 v[108:111], v[40:43], a[44:47], v[108:111]
    buffer_load_dwordx4 v17, s[8:11], s82 offen offset:1024 lds
    s_add_u32 s82, s87, 8
    v_mfma_f32_16x16x32_bf16 v[72:75], a[36:39], v[40:43], v[72:75]
    ds_read_b128 v[40:43], v21 offset:0
    s_and_b32 s82, s82, 15
    v_mfma_f32_16x16x32_bf16 v[116:119], a[48:51], v[24:27], v[116:119]
    s_lshl_b32 s82, s82, 6
    s_add_u32 m0, s62, 73728
    v_mfma_f32_16x16x32_bf16 v[120:123], a[52:55], v[24:27], v[120:123]
    buffer_load_dwordx4 v19, s[8:11], s82 offen lds
    s_add_u32 s84, s60, 10
    v_mfma_f32_16x16x32_bf16 v[124:127], v[24:27], a[56:59], v[124:127]
    s_and_b32 s84, s84, 15
    s_mul_i32 s84, s84, 98304
    v_mfma_f32_16x16x32_bf16 v[76:79], a[52:55], v[44:47], v[76:79]
    s_add_u32 m0, s63, 131072
    s_add_u32 s83, s60, 14
    v_mfma_f32_16x16x32_bf16 v[96:99], v[44:47], a[56:59], v[96:99]
    buffer_load_dwordx4 v22, s[12:15], s84 offen offset:0 lds
    s_and_b32 s83, s83, 15
    v_mfma_f32_16x16x32_bf16 v[60:63], a[48:51], v[44:47], v[60:63]
    buffer_load_dwordx4 v22, s[12:15], s84 offen offset:1024 lds
    ds_read_b128 v[44:47], v16 offset:0
    v_mfma_f32_16x16x32_bf16 v[80:83], a[52:55], v[48:51], v[80:83]
    buffer_load_dwordx4 v22, s[12:15], s84 offen offset:2048 lds
    s_lshl_b32 s83, s83, 6
    v_mfma_f32_16x16x32_bf16 v[100:103], v[48:51], a[56:59], v[100:103]
    s_add_u32 m0, s76, 14336
    s_add_u32 s85, s60, 11
    v_mfma_f32_16x16x32_bf16 v[64:67], a[48:51], v[48:51], v[64:67]
    buffer_load_dwordx4 v17, s[8:11], s83 offen offset:0 lds
    ds_read_b128 v[48:51], v13 offset:4096
    s_waitcnt lgkmcnt(2)
    v_mfma_f32_16x16x32_bf16 v[84:87], a[52:55], v[28:31], v[84:87]
    s_add_u32 s83, s60, 14
    s_and_b32 s83, s83, 15
    v_mfma_f32_16x16x32_bf16 v[104:107], v[28:31], a[56:59], v[104:107]
    s_lshl_b32 s83, s83, 6
    s_add_u32 m0, s76, 46080
    v_mfma_f32_16x16x32_bf16 v[68:71], a[48:51], v[28:31], v[68:71]
    buffer_load_dwordx4 v17, s[8:11], s83 offen offset:1024 lds
    ds_read_b128 v[28:31], v13 offset:20480
    v_mfma_f32_16x16x32_bf16 v[88:91], a[52:55], v[32:35], v[88:91]
    s_and_b32 s85, s85, 15
    s_mul_i32 s85, s85, 98304
    v_mfma_f32_16x16x32_bf16 v[108:111], v[32:35], a[56:59], v[108:111]
    s_add_u32 m0, s63, 143360
    s_add_u32 s82, s87, 12
    v_mfma_f32_16x16x32_bf16 v[72:75], a[48:51], v[32:35], v[72:75]
    ds_read_b128 v[32:35], v13 offset:36864
    s_and_b32 s82, s82, 15
    v_mfma_f32_16x16x32_bf16 v[116:119], a[60:63], v[24:27], v[116:119]
    s_lshl_b32 s82, s82, 6
    s_add_u32 s84, s60, 12
    v_mfma_f32_16x16x32_bf16 v[120:123], a[64:67], v[24:27], v[120:123]
    s_and_b32 s84, s84, 15
    s_mul_i32 s84, s84, 98304
    v_mfma_f32_16x16x32_bf16 v[124:127], v[24:27], a[68:71], v[124:127]
    v_mov_b32 v17, s51
    s_add_u32 s87, s60, 11
    v_mfma_f32_16x16x32_bf16 v[92:95], v[24:27], v[36:39], 0
    s_and_b32 s87, s87, 15
    s_mul_i32 s87, s87, 32768
    v_mfma_f32_16x16x32_bf16 v[112:115], v[36:39], v[36:39], 0
    ds_read_b128 v[36:39], v13 offset:53248
    s_waitcnt vmcnt(22)
    s_barrier
    v_mfma_f32_16x16x32_bf16 v[92:95], v[24:27], v[40:43], v[92:95]
    buffer_load_dwordx4 v22, s[12:15], s85 offen offset:0 lds
    ds_read_b64_tr_b16 a[72:73], v23 offset:0
    v_mfma_f32_16x16x32_bf16 v[112:115], v[40:43], v[40:43], v[112:115]
    buffer_load_dwordx4 v22, s[12:15], s85 offen offset:1024 lds
    ds_read_b64_tr_b16 a[74:75], v23 offset:512
    s_waitcnt lgkmcnt(3)
    v_mfma_f32_16x16x32_bf16 v[52:55], v[24:27], v[44:47], 0
    buffer_load_dwordx4 v22, s[12:15], s85 offen offset:2048 lds
    ds_read_b64_tr_b16 a[76:77], v23 offset:1024
    v_mfma_f32_16x16x32_bf16 v[56:59], v[44:47], v[44:47], 0
    ds_read_b64_tr_b16 a[78:79], v23 offset:1536
    ds_read_b64_tr_b16 a[80:81], v23 offset:2048
    v_mfma_f32_16x16x32_bf16 v[76:79], a[64:67], v[48:51], v[76:79]
    ds_read_b64_tr_b16 a[82:83], v23 offset:2560
    ds_read_b128 v[40:43], v20 offset:2048
    v_mfma_f32_16x16x32_bf16 v[96:99], v[48:51], a[68:71], v[96:99]
    ds_read_b128 v[44:47], v21 offset:2048
    s_add_u32 m0, s62, 77824
    v_mfma_f32_16x16x32_bf16 v[60:63], a[60:63], v[48:51], v[60:63]
    buffer_load_dwordx4 v19, s[8:11], s82 offen lds
    ds_read_b128 v[48:51], v12 offset:6144
    v_mfma_f32_16x16x32_bf16 v[80:83], a[64:67], v[28:31], v[80:83]
    s_add_u32 m0, s63, 81920
    s_add_u32 s85, s60, 13
    v_mfma_f32_16x16x32_bf16 v[100:103], v[28:31], a[68:71], v[100:103]
    s_and_b32 s85, s85, 15
    s_mul_i32 s85, s85, 98304
    v_mfma_f32_16x16x32_bf16 v[64:67], a[60:63], v[28:31], v[64:67]
    ds_read_b128 v[28:31], v12 offset:22528
    v_bfe_u32 v19, v18, 4, 1
    v_mfma_f32_16x16x32_bf16 v[84:87], a[64:67], v[32:35], v[84:87]
    v_or_b32 v19, s81, v19
    v_lshlrev_b32 v19, 1, v19
    v_mfma_f32_16x16x32_bf16 v[104:107], v[32:35], a[68:71], v[104:107]
    v_and_b32 v18, 7, v18
    v_xor_b32 v18, v18, v19
    v_mfma_f32_16x16x32_bf16 v[68:71], a[60:63], v[32:35], v[68:71]
    ds_read_b128 v[32:35], v12 offset:38912
    v_lshl_add_u32 v10, v18, 4, v10
    s_waitcnt lgkmcnt(3)
    v_mfma_f32_16x16x32_bf16 v[88:91], a[64:67], v[36:39], v[88:91]
    v_add_u32 v10, s80, v10
    v_mov_b32 v9, v15
    v_mfma_f32_16x16x32_bf16 v[108:111], v[36:39], a[68:71], v[108:111]
    v_lshlrev_b32 v4, 1, v0
    v_and_b32 v4, 0xe0, v4
    v_mfma_f32_16x16x32_bf16 v[72:75], a[60:63], v[36:39], v[72:75]
    ds_read_b128 v[36:39], v12 offset:55296
    s_waitcnt vmcnt(20)
    s_barrier
    v_mfma_f32_16x16x32_bf16 v[116:119], a[72:75], v[24:27], v[116:119]
    buffer_load_dwordx4 v22, s[12:15], s84 offen offset:0 lds
    ds_read_b64_tr_b16 a[84:85], v23 offset:12288
    v_mfma_f32_16x16x32_bf16 v[120:123], a[76:79], v[24:27], v[120:123]
    buffer_load_dwordx4 v22, s[12:15], s84 offen offset:1024 lds
    ds_read_b64_tr_b16 a[86:87], v23 offset:12800
    v_mfma_f32_16x16x32_bf16 v[124:127], v[24:27], a[80:83], v[124:127]
    buffer_load_dwordx4 v22, s[12:15], s84 offen offset:2048 lds
    ds_read_b64_tr_b16 a[88:89], v23 offset:13312
    v_mfma_f32_16x16x32_bf16 v[92:95], v[24:27], v[40:43], v[92:95]
    ds_read_b64_tr_b16 a[90:91], v23 offset:13824
    ds_read_b64_tr_b16 a[92:93], v23 offset:14336
    v_mfma_f32_16x16x32_bf16 v[112:115], v[40:43], v[40:43], v[112:115]
    ds_read_b64_tr_b16 a[94:95], v23 offset:14848
    ds_read_b128 v[40:43], v20 offset:4096
    v_mfma_f32_16x16x32_bf16 v[92:95], v[24:27], v[44:47], v[92:95]
    s_add_u32 m0, s63, 94208
    s_add_u32 s84, s60, 14
    v_mfma_f32_16x16x32_bf16 v[112:115], v[44:47], v[44:47], v[112:115]
    ds_read_b128 v[44:47], v21 offset:4096
    s_and_b32 s84, s84, 15
    s_waitcnt lgkmcnt(8)
    v_mfma_f32_16x16x32_bf16 v[76:79], a[76:79], v[48:51], v[76:79]
    s_mul_i32 s84, s84, 98304
    s_mul_i32 s82, s3, 192
    v_mfma_f32_16x16x32_bf16 v[96:99], v[48:51], a[80:83], v[96:99]
    s_add_u32 s82, s82, 157184
    s_and_b32 s83, s3, 1
    v_mfma_f32_16x16x32_bf16 v[60:63], a[72:75], v[48:51], v[60:63]
    ds_read_b128 v[48:51], v16 offset:4096
    s_lshl_b32 s83, s83, 5
    v_mfma_f32_16x16x32_bf16 v[80:83], a[76:79], v[28:31], v[80:83]
    v_mfma_f32_16x16x32_bf16 v[100:103], v[28:31], a[80:83], v[100:103]
    v_mfma_f32_16x16x32_bf16 v[64:67], a[72:75], v[28:31], v[64:67]
    ds_read_b128 v[28:31], v13 offset:6144
    v_mfma_f32_16x16x32_bf16 v[84:87], a[76:79], v[32:35], v[84:87]
    v_mfma_f32_16x16x32_bf16 v[104:107], v[32:35], a[80:83], v[104:107]
    v_mfma_f32_16x16x32_bf16 v[68:71], a[72:75], v[32:35], v[68:71]
    ds_read_b128 v[32:35], v13 offset:22528
    v_mfma_f32_16x16x32_bf16 v[88:91], a[76:79], v[36:39], v[88:91]
    v_mfma_f32_16x16x32_bf16 v[108:111], v[36:39], a[80:83], v[108:111]
    v_mfma_f32_16x16x32_bf16 v[72:75], a[72:75], v[36:39], v[72:75]
    ds_read_b128 v[36:39], v13 offset:38912
    s_waitcnt lgkmcnt(3)
    v_mfma_f32_16x16x32_bf16 v[116:119], a[84:87], v[24:27], v[116:119]
    v_mfma_f32_16x16x32_bf16 v[120:123], a[88:91], v[24:27], v[120:123]
    v_mfma_f32_16x16x32_bf16 v[124:127], v[24:27], a[92:95], v[124:127]
    v_mfma_f32_16x16x32_bf16 v[92:95], v[24:27], v[40:43], v[92:95]
    v_mfma_f32_16x16x32_bf16 v[112:115], v[40:43], v[40:43], v[112:115]
    ds_read_b128 v[40:43], v13 offset:55296
    s_waitcnt vmcnt(20)
    s_barrier
    v_mfma_f32_16x16x32_bf16 v[92:95], v[24:27], v[44:47], v[92:95]
    buffer_load_dwordx4 v22, s[12:15], s85 offen offset:0 lds
    ds_read_b64_tr_b16 a[96:97], v23 offset:24576
    v_mfma_f32_16x16x32_bf16 v[112:115], v[44:47], v[44:47], v[112:115]
    buffer_load_dwordx4 v22, s[12:15], s85 offen offset:1024 lds
    ds_read_b64_tr_b16 a[98:99], v23 offset:25088
    v_mfma_f32_16x16x32_bf16 v[52:55], v[24:27], v[48:51], v[52:55]
    buffer_load_dwordx4 v22, s[12:15], s85 offen offset:2048 lds
    ds_read_b64_tr_b16 a[100:101], v23 offset:25600
    v_mfma_f32_16x16x32_bf16 v[56:59], v[48:51], v[48:51], v[56:59]
    ds_read_b64_tr_b16 a[102:103], v23 offset:26112
    ds_read_b64_tr_b16 a[104:105], v23 offset:26624
    s_waitcnt lgkmcnt(6)
    v_mfma_f32_16x16x32_bf16 v[76:79], a[88:91], v[28:31], v[76:79]
    ds_read_b64_tr_b16 a[106:107], v23 offset:27136
    ds_read_b128 v[44:47], v20 offset:6144
    v_mfma_f32_16x16x32_bf16 v[96:99], v[28:31], a[92:95], v[96:99]
    ds_read_b128 v[48:51], v21 offset:6144
    s_add_u32 m0, s63, 106496
    v_mfma_f32_16x16x32_bf16 v[60:63], a[84:87], v[28:31], v[60:63]
    ds_read_b128 v[28:31], v12 offset:8192
    s_add_u32 s85, s60, 15
    v_mfma_f32_16x16x32_bf16 v[80:83], a[88:91], v[32:35], v[80:83]
    s_and_b32 s85, s85, 15
    s_mul_i32 s85, s85, 98304
    v_mfma_f32_16x16x32_bf16 v[100:103], v[32:35], a[92:95], v[100:103]
    v_mfma_f32_16x16x32_bf16 v[64:67], a[84:87], v[32:35], v[64:67]
    ds_read_b128 v[32:35], v12 offset:24576
    v_mfma_f32_16x16x32_bf16 v[84:87], a[88:91], v[36:39], v[84:87]
    v_mfma_f32_16x16x32_bf16 v[104:107], v[36:39], a[92:95], v[104:107]
    v_mfma_f32_16x16x32_bf16 v[68:71], a[84:87], v[36:39], v[68:71]
    ds_read_b128 v[36:39], v12 offset:40960
    s_waitcnt lgkmcnt(3)
    v_mfma_f32_16x16x32_bf16 v[88:91], a[88:91], v[40:43], v[88:91]
    v_mfma_f32_16x16x32_bf16 v[108:111], v[40:43], a[92:95], v[108:111]
    v_mfma_f32_16x16x32_bf16 v[72:75], a[84:87], v[40:43], v[72:75]
    ds_read_b128 v[40:43], v12 offset:57344
    s_waitcnt vmcnt(15)
    s_barrier
    v_mfma_f32_16x16x32_bf16 v[116:119], a[96:99], v[24:27], v[116:119]
    buffer_load_dwordx4 v22, s[12:15], s84 offen offset:0 lds
    ds_read_b64_tr_b16 a[108:109], v23 offset:36864
    v_mfma_f32_16x16x32_bf16 v[120:123], a[100:103], v[24:27], v[120:123]
    buffer_load_dwordx4 v22, s[12:15], s84 offen offset:1024 lds
    ds_read_b64_tr_b16 a[110:111], v23 offset:37376
    v_mfma_f32_16x16x32_bf16 v[124:127], v[24:27], a[104:107], v[124:127]
    buffer_load_dwordx4 v22, s[12:15], s84 offen offset:2048 lds
    ds_read_b64_tr_b16 a[112:113], v23 offset:37888
    v_mfma_f32_16x16x32_bf16 v[92:95], v[24:27], v[44:47], v[92:95]
    ds_read_b64_tr_b16 a[114:115], v23 offset:38400
    ds_read_b64_tr_b16 a[116:117], v23 offset:38912
    v_mfma_f32_16x16x32_bf16 v[112:115], v[44:47], v[44:47], v[112:115]
    ds_read_b64_tr_b16 a[118:119], v23 offset:39424
    ds_read_b128 v[44:47], v20 offset:8192
    v_mfma_f32_16x16x32_bf16 v[92:95], v[24:27], v[48:51], v[92:95]
    s_mov_b32 m0, 158720
    s_add_u32 s84, s60, 0
    v_mfma_f32_16x16x32_bf16 v[112:115], v[48:51], v[48:51], v[112:115]
    buffer_load_dword v2, s[20:23], 0 offen lds
    ds_read_b128 v[48:51], v21 offset:8192
    s_waitcnt lgkmcnt(8)
    v_mfma_f32_16x16x32_bf16 v[76:79], a[100:103], v[28:31], v[76:79]
    buffer_load_dword v3, s[16:19], 0 offen lds
    v_bfe_u32 v2, v0, 4, 4
    v_mfma_f32_16x16x32_bf16 v[96:99], v[28:31], a[104:107], v[96:99]
    buffer_load_dword v3, s[24:27], 0 offen lds
    s_add_u32 m0, s63, 118784
    v_mfma_f32_16x16x32_bf16 v[60:63], a[96:99], v[28:31], v[60:63]
    ds_read_b128 v[28:31], v16 offset:8192
    v_lshlrev_b32 v2, 7, v2
    v_mfma_f32_16x16x32_bf16 v[80:83], a[100:103], v[32:35], v[80:83]
    v_bfe_u32 v3, v0, 8, 1
    v_lshl_add_u32 v2, v3, 18, v2
    v_mfma_f32_16x16x32_bf16 v[100:103], v[32:35], a[104:107], v[100:103]
    s_and_b32 s84, s84, 15
    s_mul_i32 s84, s84, 98304
    v_mfma_f32_16x16x32_bf16 v[64:67], a[96:99], v[32:35], v[64:67]
    ds_read_b128 v[32:35], v13 offset:8192
    v_mfma_f32_16x16x32_bf16 v[84:87], a[100:103], v[36:39], v[84:87]
    v_mfma_f32_16x16x32_bf16 v[104:107], v[36:39], a[104:107], v[104:107]
    v_mfma_f32_16x16x32_bf16 v[68:71], a[96:99], v[36:39], v[68:71]
    ds_read_b128 v[36:39], v13 offset:24576
    v_mfma_f32_16x16x32_bf16 v[88:91], a[100:103], v[40:43], v[88:91]
    v_mfma_f32_16x16x32_bf16 v[108:111], v[40:43], a[104:107], v[108:111]
    v_mfma_f32_16x16x32_bf16 v[72:75], a[96:99], v[40:43], v[72:75]
    ds_read_b128 v[40:43], v13 offset:40960
    s_waitcnt lgkmcnt(3)
    v_mfma_f32_16x16x32_bf16 v[116:119], a[108:111], v[24:27], v[116:119]
    v_mfma_f32_16x16x32_bf16 v[120:123], a[112:115], v[24:27], v[120:123]
    v_mfma_f32_16x16x32_bf16 v[124:127], v[24:27], a[116:119], v[124:127]
    v_mfma_f32_16x16x32_bf16 v[92:95], v[24:27], v[44:47], v[92:95]
    v_mfma_f32_16x16x32_bf16 v[112:115], v[44:47], v[44:47], v[112:115]
    ds_read_b128 v[44:47], v13 offset:57344
    s_waitcnt vmcnt(18)
    s_barrier
    v_mfma_f32_16x16x32_bf16 v[92:95], v[24:27], v[48:51], v[92:95]
    buffer_load_dwordx4 v22, s[12:15], s85 offen offset:0 lds
    ds_read_b64_tr_b16 a[120:121], v23 offset:49152
    v_mfma_f32_16x16x32_bf16 v[112:115], v[48:51], v[48:51], v[112:115]
    buffer_load_dwordx4 v22, s[12:15], s85 offen offset:1024 lds
    ds_read_b64_tr_b16 a[122:123], v23 offset:49664
    v_mfma_f32_16x16x32_bf16 v[52:55], v[24:27], v[28:31], v[52:55]
    buffer_load_dwordx4 v22, s[12:15], s85 offen offset:2048 lds
    ds_read_b64_tr_b16 a[124:125], v23 offset:50176
    v_mfma_f32_16x16x32_bf16 v[56:59], v[28:31], v[28:31], v[56:59]
    ds_read_b64_tr_b16 a[126:127], v23 offset:50688
    ds_read_b64_tr_b16 a[128:129], v23 offset:51200
    s_waitcnt lgkmcnt(6)
    v_mfma_f32_16x16x32_bf16 v[76:79], a[112:115], v[32:35], v[76:79]
    ds_read_b64_tr_b16 a[130:131], v23 offset:51712
    ds_read_b128 v[48:51], v20 offset:10240
    v_mfma_f32_16x16x32_bf16 v[96:99], v[32:35], a[116:119], v[96:99]
    ds_read_b128 v[28:31], v21 offset:10240
    s_cmp_lg_u32 s3, 0
    s_cbranch_scc1 L2
    s_mov_b64 exec, 1
    buffer_atomic_add v17, off, s[40:43], s91 sc1
    s_mov_b64 exec, -1
L2:
    v_mfma_f32_16x16x32_bf16 v[60:63], a[108:111], v[32:35], v[60:63]
    ds_read_b128 v[32:35], v12 offset:10240
    s_add_u32 m0, s62, 131072
    v_mfma_f32_16x16x32_bf16 v[80:83], a[112:115], v[36:39], v[80:83]
    v_bfe_u32 v17, v0, 4, 4
    v_lshlrev_b32 v17, 2, v17
    v_mfma_f32_16x16x32_bf16 v[100:103], v[36:39], a[116:119], v[100:103]
    s_lshl_b32 s14, s3, 11
    s_sub_u32 s14, s14, 1024
    v_mfma_f32_16x16x32_bf16 v[64:67], a[108:111], v[36:39], v[64:67]
    ds_read_b128 v[36:39], v12 offset:26624
    s_add_u32 s85, s60, 1
    v_mfma_f32_16x16x32_bf16 v[84:87], a[112:115], v[40:43], v[84:87]
    s_and_b32 s85, s85, 15
    s_mul_i32 s85, s85, 98304
    v_mfma_f32_16x16x32_bf16 v[104:107], v[40:43], a[116:119], v[104:107]
    s_mov_b32 s12, 0x3eb8aa3b
    s_mov_b32 s13, 0x3eb8aa3b
    v_mfma_f32_16x16x32_bf16 v[68:71], a[108:111], v[40:43], v[68:71]
    ds_read_b128 v[40:43], v12 offset:43008
    s_waitcnt lgkmcnt(3)
    v_mfma_f32_16x16x32_bf16 v[88:91], a[112:115], v[44:47], v[88:91]
    v_mfma_f32_16x16x32_bf16 v[108:111], v[44:47], a[116:119], v[108:111]
    v_mfma_f32_16x16x32_bf16 v[72:75], a[108:111], v[44:47], v[72:75]
    ds_read_b128 v[44:47], v12 offset:59392
    s_waitcnt vmcnt(15)
    s_barrier
    v_mfma_f32_16x16x32_bf16 v[116:119], a[120:123], v[24:27], v[116:119]
    buffer_load_dwordx4 v10, s[16:19], s86 offen lds
    ds_read_b64_tr_b16 a[132:133], v23 offset:61440
    v_mfma_f32_16x16x32_bf16 v[120:123], a[124:127], v[24:27], v[120:123]
    ds_read_b64_tr_b16 a[134:135], v23 offset:61952
    ds_read_b64_tr_b16 a[136:137], v23 offset:62464
    v_mfma_f32_16x16x32_bf16 v[124:127], v[24:27], a[128:131], v[124:127]
    ds_read_b64_tr_b16 a[138:139], v23 offset:62976
    ds_read_b64_tr_b16 a[140:141], v23 offset:63488
    v_mfma_f32_16x16x32_bf16 v[92:95], v[24:27], v[48:51], v[92:95]
    ds_read_b64_tr_b16 a[142:143], v23 offset:64000
    s_add_u32 m0, s62, 135168
    v_mfma_f32_16x16x32_bf16 v[112:115], v[48:51], v[48:51], v[112:115]
    ds_read_b128 v[48:51], v20 offset:12288
    buffer_load_dwordx4 v10, s[16:19], s87 offen lds
    v_mfma_f32_16x16x32_bf16 v[92:95], v[24:27], v[28:31], v[92:95]
    s_add_u32 s86, s60, 12
    s_and_b32 s86, s86, 15
    v_mfma_f32_16x16x32_bf16 v[112:115], v[28:31], v[28:31], v[112:115]
    ds_read_b128 v[28:31], v21 offset:12288
    s_mul_i32 s86, s86, 32768
    s_waitcnt lgkmcnt(8)
    v_mfma_f32_16x16x32_bf16 v[76:79], a[124:127], v[32:35], v[76:79]
    s_add_u32 m0, s62, 139264
    s_add_u32 s87, s60, 13
    v_mfma_f32_16x16x32_bf16 v[96:99], v[32:35], a[128:131], v[96:99]
    s_and_b32 s87, s87, 15
    buffer_load_dwordx4 v10, s[16:19], s86 offen lds
    v_mfma_f32_16x16x32_bf16 v[60:63], a[120:123], v[32:35], v[60:63]
    ds_read_b128 v[32:35], v16 offset:12288
    s_mul_i32 s87, s87, 32768
    v_mfma_f32_16x16x32_bf16 v[80:83], a[124:127], v[36:39], v[80:83]
    s_add_u32 m0, s62, 143360
    s_add_u32 s86, s60, 14
    v_mfma_f32_16x16x32_bf16 v[100:103], v[36:39], a[128:131], v[100:103]
    s_and_b32 s86, s86, 15
    s_mul_i32 s86, s86, 32768
    v_mfma_f32_16x16x32_bf16 v[64:67], a[120:123], v[36:39], v[64:67]
    ds_read_b128 v[36:39], v13 offset:10240
    v_lshrrev_b32 v16, 8, v0
    v_mfma_f32_16x16x32_bf16 v[84:87], a[124:127], v[40:43], v[84:87]
    v_lshl_add_u32 v16, v16, 7, v17
    v_add_u32 v16, 156672, v16
    v_mfma_f32_16x16x32_bf16 v[104:107], v[40:43], a[128:131], v[104:107]
    v_add_u32 v17, 155904, v17
    v_mfma_f32_16x16x32_bf16 v[68:71], a[120:123], v[40:43], v[68:71]
    ds_read_b128 v[40:43], v13 offset:26624
    v_mfma_f32_16x16x32_bf16 v[88:91], a[124:127], v[44:47], v[88:91]
    v_mfma_f32_16x16x32_bf16 v[108:111], v[44:47], a[128:131], v[108:111]
    v_mfma_f32_16x16x32_bf16 v[72:75], a[120:123], v[44:47], v[72:75]
    ds_read_b128 v[44:47], v13 offset:43008
    s_waitcnt lgkmcnt(3)
    v_mfma_f32_16x16x32_bf16 v[116:119], a[132:135], v[24:27], v[116:119]
    v_mfma_f32_16x16x32_bf16 v[120:123], a[136:139], v[24:27], v[120:123]
    v_mfma_f32_16x16x32_bf16 v[124:127], v[24:27], a[140:143], v[124:127]
    v_mfma_f32_16x16x32_bf16 v[92:95], v[24:27], v[48:51], v[92:95]
    v_mfma_f32_16x16x32_bf16 v[112:115], v[48:51], v[48:51], v[112:115]
    ds_read_b128 v[48:51], v13 offset:59392
    s_waitcnt vmcnt(15)
    s_barrier
    v_mfma_f32_16x16x32_bf16 v[92:95], v[24:27], v[28:31], v[92:95]
    buffer_load_dwordx4 v10, s[16:19], s87 offen lds
    ds_read_b64_tr_b16 a[144:145], v23 offset:0
    v_mfma_f32_16x16x32_bf16 v[112:115], v[28:31], v[28:31], v[112:115]
    ds_read_b64_tr_b16 a[146:147], v23 offset:512
    ds_read_b64_tr_b16 a[148:149], v23 offset:1024
    v_mfma_f32_16x16x32_bf16 v[52:55], v[24:27], v[32:35], v[52:55]
    ds_read_b64_tr_b16 a[150:151], v23 offset:1536
    ds_read_b64_tr_b16 a[152:153], v23 offset:2048
    v_mfma_f32_16x16x32_bf16 v[56:59], v[32:35], v[32:35], v[56:59]
    ds_read_b64_tr_b16 a[154:155], v23 offset:2560
    ds_read_b128 v[28:31], v20 offset:14336
    s_waitcnt lgkmcnt(8)
    v_mfma_f32_16x16x32_bf16 v[76:79], a[136:139], v[36:39], v[76:79]
    ds_read_b128 v[32:35], v21 offset:14336
    s_add_u32 m0, s62, 147456
    v_mfma_f32_16x16x32_bf16 v[96:99], v[36:39], a[140:143], v[96:99]
    buffer_load_dwordx4 v10, s[16:19], s86 offen lds
    s_add_u32 s87, s60, 15
    v_mfma_f32_16x16x32_bf16 v[60:63], a[132:135], v[36:39], v[60:63]
    ds_read_b128 v[36:39], v12 offset:12288
    s_and_b32 s87, s87, 15
    v_mfma_f32_16x16x32_bf16 v[80:83], a[136:139], v[40:43], v[80:83]
    s_mul_i32 s87, s87, 32768
    s_add_u32 m0, s62, 151552
    v_mfma_f32_16x16x32_bf16 v[100:103], v[40:43], a[140:143], v[100:103]
    s_add_u32 s86, s60, 0
    s_and_b32 s86, s86, 15
    v_mfma_f32_16x16x32_bf16 v[64:67], a[132:135], v[40:43], v[64:67]
    ds_read_b128 v[40:43], v12 offset:28672
    buffer_load_dwordx4 v10, s[16:19], s87 offen lds
    v_mfma_f32_16x16x32_bf16 v[84:87], a[136:139], v[44:47], v[84:87]
    s_mul_i32 s86, s86, 32768
    s_add_u32 m0, s62, 90112
    v_mfma_f32_16x16x32_bf16 v[104:107], v[44:47], a[140:143], v[104:107]
    v_bfe_u32 v21, v0, 4, 2
    v_bfe_u32 v20, v0, 4, 4
    v_mfma_f32_16x16x32_bf16 v[68:71], a[132:135], v[44:47], v[68:71]
    ds_read_b128 v[44:47], v12 offset:45056
    v_lshlrev_b32 v20, 2, v20
    s_waitcnt lgkmcnt(3)
    v_mfma_f32_16x16x32_bf16 v[88:91], a[136:139], v[48:51], v[88:91]
    v_cmp_eq_u32 vcc, 1, v21
    s_add_u32 s87, s60, 1
    v_mfma_f32_16x16x32_bf16 v[108:111], v[48:51], a[140:143], v[108:111]
    v_cndmask_b32 v56, v56, v57, vcc
    s_and_b32 s87, s87, 15
    v_mfma_f32_16x16x32_bf16 v[72:75], a[132:135], v[48:51], v[72:75]
    ds_read_b128 v[48:51], v12 offset:61440
    s_waitcnt vmcnt(15)
    s_barrier
    v_mfma_f32_16x16x32_bf16 v[116:119], a[144:147], v[24:27], v[116:119]
    buffer_load_dwordx4 v10, s[16:19], s86 offen lds
    ds_read_b64_tr_b16 a[156:157], v23 offset:12288
    v_mfma_f32_16x16x32_bf16 v[120:123], a[148:151], v[24:27], v[120:123]
    ds_read_b64_tr_b16 a[158:159], v23 offset:12800
    ds_read_b64_tr_b16 a[160:161], v23 offset:13312
    v_mfma_f32_16x16x32_bf16 v[124:127], v[24:27], a[152:155], v[124:127]
    ds_read_b64_tr_b16 a[162:163], v23 offset:13824
    ds_read_b64_tr_b16 a[164:165], v23 offset:14336
    v_mfma_f32_16x16x32_bf16 v[92:95], v[24:27], v[28:31], v[92:95]
    ds_read_b64_tr_b16 a[166:167], v23 offset:14848
    s_mul_i32 s87, s87, 32768
    v_mfma_f32_16x16x32_bf16 v[112:115], v[28:31], v[28:31], v[112:115]
    ds_read_b128 v[28:31], v13 offset:12288
    s_add_u32 m0, s62, 94208
    v_mfma_f32_16x16x32_bf16 v[92:95], v[24:27], v[32:35], v[92:95]
    s_add_u32 s86, s60, 2
    s_and_b32 s86, s86, 15
    v_mfma_f32_16x16x32_bf16 v[112:115], v[32:35], v[32:35], v[112:115]
    ds_read_b128 v[32:35], v13 offset:28672
    s_mul_i32 s86, s86, 32768
    s_waitcnt lgkmcnt(8)
    v_mfma_f32_16x16x32_bf16 v[76:79], a[148:151], v[36:39], v[76:79]
    s_nop 0
    v_mul_f32 v92, 0x3b000000, v92
    v_mfma_f32_16x16x32_bf16 v[96:99], v[36:39], a[152:155], v[96:99]
    s_nop 0
    v_cndmask_b32 v112, v112, v113, vcc
    v_cmp_eq_u32 vcc, 2, v21
    v_mfma_f32_16x16x32_bf16 v[60:63], a[144:147], v[36:39], v[60:63]
    ds_read_b128 v[36:39], v13 offset:45056
    v_cndmask_b32 v112, v112, v114, vcc
    v_mfma_f32_16x16x32_bf16 v[80:83], a[148:151], v[40:43], v[80:83]
    v_cndmask_b32 v56, v56, v58, vcc
    v_cmp_eq_u32 vcc, 3, v21
    v_mfma_f32_16x16x32_bf16 v[100:103], v[40:43], a[152:155], v[100:103]
    s_nop 0
    v_cndmask_b32 v112, v112, v115, vcc
    v_cndmask_b32 v56, v56, v59, vcc
    v_mfma_f32_16x16x32_bf16 v[64:67], a[144:147], v[40:43], v[64:67]
    ds_read_b128 v[40:43], v13 offset:61440
    v_mul_f32 v112, 0x3b000000, v112
    v_mfma_f32_16x16x32_bf16 v[84:87], a[148:151], v[44:47], v[84:87]
    v_fma_f32 v112, -v92, v92, v112
    v_max_f32 v112, 0, v112
    v_mfma_f32_16x16x32_bf16 v[104:107], v[44:47], a[152:155], v[104:107]
    v_add_f32 v112, 0x3727c5ac, v112
    v_rsq_f32 v112, v112
    v_mfma_f32_16x16x32_bf16 v[68:71], a[144:147], v[44:47], v[68:71]
    v_add_u32 v21, s96, v20
    v_add_u32 v20, s97, v20
    v_mfma_f32_16x16x32_bf16 v[88:91], a[148:151], v[48:51], v[88:91]
    s_mov_b64 exec, s[56:57]
    ds_write_b32 v21, v92
    ds_write_b32 v21, v112 offset:512
    ds_write_b32 v20, v52
    ds_write_b32 v20, v56 offset:64
    s_mov_b64 exec, -1
    v_mfma_f32_16x16x32_bf16 v[108:111], v[48:51], a[152:155], v[108:111]
    s_waitcnt vmcnt(13) lgkmcnt(5)
    s_barrier
    v_mfma_f32_16x16x32_bf16 v[72:75], a[144:147], v[48:51], v[72:75]
    buffer_load_dwordx4 v10, s[16:19], s87 offen lds
    ds_read_b64_tr_b16 a[168:169], v23 offset:24576
    v_mfma_f32_16x16x32_bf16 v[116:119], a[156:159], v[24:27], v[116:119]
    ds_read_b64_tr_b16 a[170:171], v23 offset:25088
    ds_read_b64_tr_b16 a[172:173], v23 offset:25600
    v_mfma_f32_16x16x32_bf16 v[120:123], a[160:163], v[24:27], v[120:123]
    ds_read_b64_tr_b16 a[174:175], v23 offset:26112
    ds_read_b64_tr_b16 a[176:177], v23 offset:26624
    v_mfma_f32_16x16x32_bf16 v[124:127], v[24:27], a[164:167], v[124:127]
    ds_read_b64_tr_b16 a[178:179], v23 offset:27136
    ds_read_b128 v[44:47], v12 offset:14336
    v_mfma_f32_16x16x32_bf16 v[76:79], a[160:163], v[28:31], v[76:79]
    ds_read_b128 v[48:51], v12 offset:30720
    s_add_u32 m0, s62, 98304
    v_mfma_f32_16x16x32_bf16 v[96:99], v[28:31], a[164:167], v[96:99]
    buffer_load_dwordx4 v10, s[16:19], s86 offen lds
    s_add_u32 s87, s60, 3
    v_mfma_f32_16x16x32_bf16 v[60:63], a[156:159], v[28:31], v[60:63]
    ds_read_b128 v[28:31], v12 offset:47104
    s_and_b32 s87, s87, 15
    v_mfma_f32_16x16x32_bf16 v[80:83], a[160:163], v[32:35], v[80:83]
    s_mul_i32 s87, s87, 32768
    s_add_u32 m0, s62, 102400
    v_mfma_f32_16x16x32_bf16 v[100:103], v[32:35], a[164:167], v[100:103]
    s_add_u32 s86, s60, 4
    s_and_b32 s86, s86, 15
    v_mfma_f32_16x16x32_bf16 v[64:67], a[156:159], v[32:35], v[64:67]
    ds_read_b128 v[32:35], v12 offset:63488
    buffer_load_dwordx4 v10, s[16:19], s87 offen lds
    v_mfma_f32_16x16x32_bf16 v[84:87], a[160:163], v[36:39], v[84:87]
    s_mul_i32 s86, s86, 32768
    s_add_u32 m0, s62, 106496
    v_mfma_f32_16x16x32_bf16 v[104:107], v[36:39], a[164:167], v[104:107]
    s_waitcnt vmcnt(10) lgkmcnt(3)
    s_barrier
    v_mfma_f32_16x16x32_bf16 v[68:71], a[156:159], v[36:39], v[68:71]
    ds_read2_b32 v[18:19], v16 offset0:0 offset1:16
    ds_read_b64_tr_b16 a[180:181], v23 offset:36864
    v_mfma_f32_16x16x32_bf16 v[88:91], a[160:163], v[40:43], v[88:91]
    ds_read_b64_tr_b16 a[182:183], v23 offset:37376
    ds_read_b64_tr_b16 a[184:185], v23 offset:37888
    v_mfma_f32_16x16x32_bf16 v[108:111], v[40:43], a[164:167], v[108:111]
    buffer_load_dwordx4 v10, s[16:19], s86 offen lds
    ds_read_b64_tr_b16 a[186:187], v23 offset:38400
    v_mfma_f32_16x16x32_bf16 v[72:75], a[156:159], v[40:43], v[72:75]
    ds_read_b64_tr_b16 a[188:189], v23 offset:38912
    ds_read_b64_tr_b16 a[190:191], v23 offset:39424
    v_mfma_f32_16x16x32_bf16 v[116:119], a[168:171], v[24:27], v[116:119]
    ds_read_b128 v[36:39], v13 offset:14336
    ds_read_b128 v[40:43], v13 offset:30720
    v_mfma_f32_16x16x32_bf16 v[120:123], a[172:175], v[24:27], v[120:123]
    s_add_u32 s87, s60, 5
    s_and_b32 s87, s87, 15
    v_mfma_f32_16x16x32_bf16 v[124:127], v[24:27], a[176:179], v[124:127]
    s_mul_i32 s87, s87, 32768
    s_add_u32 m0, s62, 110592
    v_mfma_f32_16x16x32_bf16 v[76:79], a[172:175], v[44:47], v[76:79]
    buffer_load_dwordx4 v10, s[16:19], s87 offen lds
    s_add_u32 s86, s60, 6
    v_mfma_f32_16x16x32_bf16 v[96:99], v[44:47], a[176:179], v[96:99]
    s_and_b32 s86, s86, 15
    s_mul_i32 s86, s86, 32768
    v_mfma_f32_16x16x32_bf16 v[60:63], a[168:171], v[44:47], v[60:63]
    ds_read_b128 v[44:47], v13 offset:47104
    s_add_u32 m0, s62, 114688
    s_waitcnt lgkmcnt(6)
    v_mfma_f32_16x16x32_bf16 v[80:83], a[172:175], v[48:51], v[80:83]
    s_lshl_b32 s96, s4, 2
    s_add_u32 s96, s96, s3
    v_mfma_f32_16x16x32_bf16 v[100:103], v[48:51], a[176:179], v[100:103]
    buffer_load_dwordx4 v10, s[16:19], s86 offen lds
    s_lshl_b32 s96, s96, 11
    v_mfma_f32_16x16x32_bf16 v[64:67], a[168:171], v[48:51], v[64:67]
    ds_read_b128 v[48:51], v13 offset:63488
    s_lshl_b32 s97, s3, 14
    v_mfma_f32_16x16x32_bf16 v[84:87], a[172:175], v[28:31], v[84:87]
    s_sub_u32 s97, s66, s97
    s_add_u32 s96, s96, s97
    v_mfma_f32_16x16x32_bf16 v[104:107], v[28:31], a[176:179], v[104:107]
    s_mov_b32 m0, 158720
    v_permlane32_swap_b32 v18, v19
    v_mfma_f32_16x16x32_bf16 v[68:71], a[168:171], v[28:31], v[68:71]
    buffer_load_dword v2, s[36:39], s96 offen lds
    v_add_f32 v18, v18, v19
    v_mfma_f32_16x16x32_bf16 v[88:91], a[172:175], v[32:35], v[88:91]
    v_mov_b32 v19, v18
    s_add_u32 s87, s60, 7
    v_mfma_f32_16x16x32_bf16 v[108:111], v[32:35], a[176:179], v[108:111]
    v_permlane16_swap_b32 v18, v19
    v_mfma_f32_16x16x32_bf16 v[72:75], a[168:171], v[32:35], v[72:75]
    buffer_load_dword off, s[36:39], s72 lds
    v_add_f32 v18, v18, v19
    v_mfma_f32_16x16x32_bf16 v[116:119], a[180:183], v[24:27], v[116:119]
    buffer_load_dword v5, v4, s[40:43], 0 offen sc1
    v_mov_b32 v19, v18
    s_waitcnt lgkmcnt(0)
    v_mfma_f32_16x16x32_bf16 v[120:123], a[184:187], v[24:27], v[120:123]
    v_permlane32_swap_b32 v18, v19
    v_mfma_f32_16x16x32_bf16 v[124:127], v[24:27], a[188:191], v[124:127]
    v_mul_f32 v18, 0x3b000000, v18
    v_mul_f32 v19, 0x3b000000, v19
    v_mfma_f32_16x16x32_bf16 v[76:79], a[184:187], v[36:39], v[76:79]
    v_fma_f32 v19, -v18, v18, v19
    v_max_f32 v19, 0, v19
    v_mfma_f32_16x16x32_bf16 v[96:99], v[36:39], a[188:191], v[96:99]
    v_add_f32 v19, 0x3727c5ac, v19
    v_rsq_f32 v19, v19
    v_mfma_f32_16x16x32_bf16 v[60:63], a[180:183], v[36:39], v[60:63]
    s_mov_b64 exec, 0xffff
    ds_write_b32 v17, v18
    ds_write_b32 v17, v19 offset:512
    s_mov_b64 exec, -1
    v_mfma_f32_16x16x32_bf16 v[80:83], a[184:187], v[40:43], v[80:83]
    s_and_b32 s87, s87, 15
    s_mul_i32 s87, s87, 32768
    v_mfma_f32_16x16x32_bf16 v[100:103], v[40:43], a[188:191], v[100:103]
    s_add_u32 m0, s62, 118784
    s_add_u32 s86, s60, 8
    v_mfma_f32_16x16x32_bf16 v[64:67], a[180:183], v[40:43], v[64:67]
    s_and_b32 s86, s86, 15
    s_mul_i32 s86, s86, 32768
    v_mfma_f32_16x16x32_bf16 v[84:87], a[184:187], v[44:47], v[84:87]
    s_lshl_b32 s96, s4, 2
    s_add_u32 s96, s96, s3
    v_mfma_f32_16x16x32_bf16 v[104:107], v[44:47], a[188:191], v[104:107]
    s_lshl_b32 s96, s96, 9
    v_lshrrev_b32 v125, 4, v0
    v_mfma_f32_16x16x32_bf16 v[68:71], a[180:183], v[44:47], v[68:71]
    v_and_b32 v126, 48, v125
    v_add_u32 v126, s82, v126
    v_mfma_f32_16x16x32_bf16 v[88:91], a[184:187], v[48:51], v[88:91]
    s_waitcnt lgkmcnt(0)
    s_barrier
    v_mfma_f32_16x16x32_bf16 v[108:111], v[48:51], a[188:191], v[108:111]
    buffer_load_dwordx4 v10, s[16:19], s87 offen lds
    ds_write_b128 v126, v[116:119]
    v_mfma_f32_16x16x32_bf16 v[72:75], a[180:183], v[48:51], v[72:75]
    ds_write_b128 v126, v[120:123] offset:64
    ds_read_b128 v[44:47], v8 offset:0
    ds_read_b128 v[48:51], v9 offset:0
    ds_read_b128 v[52:55], v8 offset:2048
    ds_read_b128 v[56:59], v9 offset:2048
    s_add_u32 m0, s62, 122880
    s_add_u32 s87, s60, 9
    s_and_b32 s87, s87, 15
    s_mul_i32 s87, s87, 32768
    v_and_b32 v127, 15, v125
    v_lshl_add_u32 v127, v127, 2, s82
    ds_write_b32 v127, v124 offset:128
    v_lshrrev_b32 v23, 4, v0
    buffer_load_dwordx4 v10, s[16:19], s86 offen lds
    s_add_u32 m0, s62, 126976
    v_and_b32 v22, 15, v23
    v_lshlrev_b32 v22, 2, v22
    v_add_u32 v22, 155648, v22
    ds_read2_b32 v[16:17], v22 offset0:0 offset1:128
    ds_read2_b32 v[18:19], v22 offset0:16 offset1:144
    ds_read2_b32 v[12:13], v22 offset0:32 offset1:160
    ds_read2_b32 v[14:15], v22 offset0:48 offset1:176
    v_and_b32 v23, 48, v23
    v_add_u32 v23, 155648, v23
    ds_read_b128 v[28:31], v23 offset:128
    ds_read_b128 v[32:35], v23 offset:640
    ds_read_b128 v[36:39], v23 offset:192
    ds_read_b128 v[40:43], v23 offset:704
    v_add_u32 v127, 159744, v0
    v_and_b32 v126, 0xf0, v0
    buffer_load_dwordx4 v10, s[16:19], s87 offen lds
    s_waitcnt lgkmcnt(12)
    v_mfma_f32_16x16x32_bf16 v[92:95], a[4:7], v[44:47], 0
    s_add_u32 m0, s62, 61440
    v_bfe_u32 v125, v0, 8, 1
    v_mfma_f32_16x16x32_bf16 v[112:115], v[44:47], a[8:11], 0
    ds_read_b128 v[44:47], v8 offset:4096
    v_lshl_add_u32 v126, v125, 14, v126
    s_waitcnt lgkmcnt(10)
    v_mfma_f32_16x16x32_bf16 v[92:95], a[16:19], v[48:51], v[92:95]
    v_lshrrev_b32 v125, 9, v0
    v_lshl_add_u32 v126, v125, 8, v126
    v_mfma_f32_16x16x32_bf16 v[112:115], v[48:51], a[20:23], v[112:115]
    buffer_load_dwordx4 v0, s[28:31], s96 offen lds
    ds_read_b128 v[48:51], v9 offset:4096
    v_mfma_f32_16x16x32_bf16 v[92:95], a[28:31], v[52:55], v[92:95]
    s_add_u32 m0, s14, 1024
    s_waitcnt lgkmcnt(6)
    v_fma_f32 v76, -v120, v16, v76
    v_mfma_f32_16x16x32_bf16 v[112:115], v[52:55], a[32:35], v[112:115]
    ds_read_b128 v[52:55], v8 offset:6144
    v_fma_f32 v77, -v121, v16, v77
    v_mfma_f32_16x16x32_bf16 v[92:95], a[40:43], v[56:59], v[92:95]
    v_fma_f32 v78, -v122, v16, v78
    v_fma_f32 v79, -v123, v16, v79
    v_mfma_f32_16x16x32_bf16 v[112:115], v[56:59], a[44:47], v[112:115]
    buffer_load_dwordx4 v11, s[20:23], s84 offen offset:1024 lds
    ds_read_b128 v[56:59], v9 offset:6144
    v_mul_f32 v76, v76, v17
    v_mul_f32 v77, v77, v17
    s_waitcnt lgkmcnt(3)
    v_mfma_f32_16x16x32_bf16 v[92:95], a[52:55], v[44:47], v[92:95]
    v_mul_f32 v78, v78, v17
    v_mul_f32 v79, v79, v17
    v_mfma_f32_16x16x32_bf16 v[112:115], v[44:47], a[56:59], v[112:115]
    ds_read_b128 v[44:47], v8 offset:8192
    v_cvt_pk_bf16_f32 v76, v76, v77
    v_cvt_pk_bf16_f32 v77, v78, v79
    s_waitcnt lgkmcnt(3)
    v_mfma_f32_16x16x32_bf16 v[92:95], a[64:67], v[48:51], v[92:95]
    buffer_load_dwordx4 v11, s[20:23], s84 offen offset:2048 lds
    s_add_u32 m0, s14, 9216
    v_mfma_f32_16x16x32_bf16 v[112:115], v[48:51], a[68:71], v[112:115]
    ds_read_b128 v[48:51], v9 offset:8192
    s_add_u32 s84, s60, 2
    s_waitcnt lgkmcnt(3)
    v_mfma_f32_16x16x32_bf16 v[92:95], a[76:79], v[52:55], v[92:95]
    s_and_b32 s84, s84, 15
    s_mul_i32 s84, s84, 98304
    v_mfma_f32_16x16x32_bf16 v[112:115], v[52:55], a[80:83], v[112:115]
    ds_read_b128 v[52:55], v8 offset:10240
    v_fma_f32 v80, -v120, v18, v80
    s_waitcnt lgkmcnt(3)
    v_mfma_f32_16x16x32_bf16 v[92:95], a[88:91], v[56:59], v[92:95]
    buffer_load_dwordx4 v11, s[20:23], s85 offen offset:1024 lds
    v_fma_f32 v81, -v121, v18, v81
    v_mfma_f32_16x16x32_bf16 v[112:115], v[56:59], a[92:95], v[112:115]
    ds_read_b128 v[56:59], v9 offset:10240
    v_fma_f32 v82, -v122, v18, v82
    s_waitcnt lgkmcnt(3)
    v_mfma_f32_16x16x32_bf16 v[92:95], a[100:103], v[44:47], v[92:95]
    v_fma_f32 v83, -v123, v18, v83
    v_mul_f32 v80, v80, v19
    v_mfma_f32_16x16x32_bf16 v[112:115], v[44:47], a[104:107], v[112:115]
    ds_read_b128 v[44:47], v8 offset:12288
    v_mul_f32 v81, v81, v19
    v_mul_f32 v82, v82, v19
    s_waitcnt lgkmcnt(3)
    v_mfma_f32_16x16x32_bf16 v[92:95], a[112:115], v[48:51], v[92:95]
    buffer_load_dwordx4 v11, s[20:23], s85 offen offset:2048 lds
    s_add_u32 m0, s14, 17408
    v_mfma_f32_16x16x32_bf16 v[112:115], v[48:51], a[116:119], v[112:115]
    ds_read_b128 v[48:51], v9 offset:12288
    s_add_u32 s85, s60, 3
    s_waitcnt lgkmcnt(3)
    v_mfma_f32_16x16x32_bf16 v[92:95], a[124:127], v[52:55], v[92:95]
    s_and_b32 s85, s85, 15
    s_mul_i32 s85, s85, 98304
    v_mfma_f32_16x16x32_bf16 v[112:115], v[52:55], a[128:131], v[112:115]
    ds_read_b128 v[52:55], v8 offset:14336
    v_mul_f32 v83, v83, v19
    s_waitcnt lgkmcnt(3)
    v_mfma_f32_16x16x32_bf16 v[92:95], a[136:139], v[56:59], v[92:95]
    buffer_load_dwordx4 v11, s[20:23], s84 offen offset:1024 lds
    v_cvt_pk_bf16_f32 v78, v80, v81
    v_mfma_f32_16x16x32_bf16 v[112:115], v[56:59], a[140:143], v[112:115]
    ds_read_b128 v[56:59], v9 offset:14336
    v_cvt_pk_bf16_f32 v79, v82, v83
    s_waitcnt lgkmcnt(3)
    v_mfma_f32_16x16x32_bf16 v[92:95], a[148:151], v[44:47], v[92:95]
    ds_read_b128 v[80:83], v23 offset:512
    v_fma_f32 v60, -v116, v16, v60
    v_mfma_f32_16x16x32_bf16 v[112:115], v[44:47], a[152:155], v[112:115]
    ds_read_b128 v[44:47], v23 offset:256
    v_fma_f32 v61, -v117, v16, v61
    v_fma_f32 v62, -v118, v16, v62
    s_waitcnt lgkmcnt(4)
    v_mfma_f32_16x16x32_bf16 v[92:95], a[160:163], v[48:51], v[92:95]
    buffer_load_dwordx4 v11, s[20:23], s84 offen offset:2048 lds
    s_add_u32 m0, s14, 25600
    v_mfma_f32_16x16x32_bf16 v[112:115], v[48:51], a[164:167], v[112:115]
    ds_read_b128 v[48:51], v23 offset:768
    s_add_u32 s84, s60, 4
    s_waitcnt lgkmcnt(4)
    v_mfma_f32_16x16x32_bf16 v[92:95], a[172:175], v[52:55], v[92:95]
    s_and_b32 s84, s84, 15
    s_mul_i32 s84, s84, 98304
    v_mfma_f32_16x16x32_bf16 v[112:115], v[52:55], a[176:179], v[112:115]
    v_fma_f32 v63, -v119, v16, v63
    v_mul_f32 v60, v60, v17
    s_waitcnt lgkmcnt(3)
    v_mfma_f32_16x16x32_bf16 v[92:95], a[184:187], v[56:59], v[92:95]
    buffer_load_dwordx4 v11, s[20:23], s85 offen offset:1024 lds
    v_mul_f32 v61, v61, v17
    v_mfma_f32_16x16x32_bf16 v[112:115], v[56:59], a[188:191], v[112:115]
    v_mul_f32 v62, v62, v17
    v_mul_f32 v63, v63, v17
    v_cvt_pk_bf16_f32 v60, v60, v61
    v_cvt_pk_bf16_f32 v61, v62, v63
    v_fma_f32 v64, -v116, v18, v64
    v_fma_f32 v65, -v117, v18, v65
    v_fma_f32 v66, -v118, v18, v66
    v_fma_f32 v67, -v119, v18, v67
    v_mul_f32 v64, v64, v19
    v_mul_f32 v65, v65, v19
    v_mul_f32 v66, v66, v19
    v_mul_f32 v67, v67, v19
    v_cvt_pk_bf16_f32 v62, v64, v65
    buffer_load_dwordx4 v11, s[20:23], s85 offen offset:2048 lds
    s_add_u32 m0, s14, 33792
    s_add_u32 s85, s60, 5
    s_and_b32 s85, s85, 15
    s_mul_i32 s85, s85, 98304
    v_cvt_pk_bf16_f32 v63, v66, v67
    ds_read_b128 v[64:67], v23 offset:0
    v_pk_fma_f32 v[84:85], v[120:121], v[12:13], v[84:85] op_sel_hi:[1,0,1] neg_lo:[0,1,0] neg_hi:[0,1,0]
    v_pk_fma_f32 v[86:87], v[122:123], v[12:13], v[86:87] op_sel_hi:[1,0,1] neg_lo:[0,1,0] neg_hi:[0,1,0]
    v_pk_mul_f32 v[84:85], v[84:85], v[12:13] op_sel:[0,1] op_sel_hi:[1,1]
    v_pk_mul_f32 v[86:87], v[86:87], v[12:13] op_sel:[0,1] op_sel_hi:[1,1]
    v_cvt_pk_bf16_f32 v84, v84, v85
    v_cvt_pk_bf16_f32 v85, v86, v87
    v_pk_fma_f32 v[88:89], v[120:121], v[14:15], v[88:89] op_sel_hi:[1,0,1] neg_lo:[0,1,0] neg_hi:[0,1,0]
    v_pk_fma_f32 v[90:91], v[122:123], v[14:15], v[90:91] op_sel_hi:[1,0,1] neg_lo:[0,1,0] neg_hi:[0,1,0]
    v_pk_mul_f32 v[88:89], v[88:89], v[14:15] op_sel:[0,1] op_sel_hi:[1,1]
    v_pk_mul_f32 v[90:91], v[90:91], v[14:15] op_sel:[0,1] op_sel_hi:[1,1]
    buffer_load_dwordx4 v11, s[20:23], s84 offen offset:1024 lds
    v_cvt_pk_bf16_f32 v86, v88, v89
    v_cvt_pk_bf16_f32 v87, v90, v91
    ds_read_b128 v[88:91], v127
    v_pk_fma_f32 v[68:69], v[116:117], v[12:13], v[68:69] op_sel_hi:[1,0,1] neg_lo:[0,1,0] neg_hi:[0,1,0]
    v_pk_fma_f32 v[70:71], v[118:119], v[12:13], v[70:71] op_sel_hi:[1,0,1] neg_lo:[0,1,0] neg_hi:[0,1,0]
    v_pk_mul_f32 v[68:69], v[68:69], v[12:13] op_sel:[0,1] op_sel_hi:[1,1]
    v_pk_mul_f32 v[70:71], v[70:71], v[12:13] op_sel:[0,1] op_sel_hi:[1,1]
    v_cvt_pk_bf16_f32 v68, v68, v69
    v_cvt_pk_bf16_f32 v69, v70, v71
    v_pk_fma_f32 v[72:73], v[116:117], v[14:15], v[72:73] op_sel_hi:[1,0,1] neg_lo:[0,1,0] neg_hi:[0,1,0]
    v_pk_fma_f32 v[74:75], v[118:119], v[14:15], v[74:75] op_sel_hi:[1,0,1] neg_lo:[0,1,0] neg_hi:[0,1,0]
    v_pk_mul_f32 v[72:73], v[72:73], v[14:15] op_sel:[0,1] op_sel_hi:[1,1]
    v_pk_mul_f32 v[74:75], v[74:75], v[14:15] op_sel:[0,1] op_sel_hi:[1,1]
    v_cvt_pk_bf16_f32 v70, v72, v73
    v_cvt_pk_bf16_f32 v71, v74, v75
    ds_read_b128 v[72:75], v127 offset:1024
    buffer_load_dwordx4 v11, s[20:23], s84 offen offset:2048 lds
    s_add_u32 m0, s14, 41984
    s_add_u32 s84, s60, 6
    s_and_b32 s84, s84, 15
    s_mul_i32 s84, s84, 98304
    s_waitcnt lgkmcnt(2)
    v_fma_f32 v96, -v64, v124, v96
    v_fma_f32 v97, -v65, v124, v97
    v_fma_f32 v98, -v66, v124, v98
    v_fma_f32 v99, -v67, v124, v99
    ds_read_b128 v[64:67], v23 offset:64
    v_mul_f32 v96, v96, v80
    v_mul_f32 v97, v97, v81
    v_mul_f32 v98, v98, v82
    v_mul_f32 v99, v99, v83
    ds_read_b128 v[80:83], v23 offset:576
    s_waitcnt lgkmcnt(3)
    v_mfma_f32_16x16x16_bf16 v[88:91], v[86:87], v[70:71], v[88:91]
    buffer_load_dwordx4 v11, s[20:23], s85 offen offset:1024 lds
    v_cvt_pk_bf16_f32 v99, v98, v99
    v_cvt_pk_bf16_f32 v98, v96, v97
    v_pk_fma_f32 v[104:105], v[28:29], v[124:125], v[104:105] op_sel_hi:[1,0,1] neg_lo:[0,1,0] neg_hi:[0,1,0]
    v_pk_fma_f32 v[106:107], v[30:31], v[124:125], v[106:107] op_sel_hi:[1,0,1] neg_lo:[0,1,0] neg_hi:[0,1,0]
    ds_read_b128 v[28:31], v127 offset:2048
    v_pk_mul_f32 v[104:105], v[104:105], v[32:33]
    v_pk_mul_f32 v[106:107], v[106:107], v[34:35]
    ds_read_b128 v[32:35], v127
    v_cvt_pk_bf16_f32 v107, v106, v107
    s_waitcnt lgkmcnt(4)
    v_mfma_f32_16x16x16_bf16 v[72:75], v[84:85], v[70:71], v[72:75]
    v_cvt_pk_bf16_f32 v106, v104, v105
    s_waitcnt vmcnt(15)
L3:
    v_and_b32 v6, 63, v5
    v_cmp_ne_u32 vcc, 32, v6
    s_cbranch_vccz L4
    s_sub_u32 s49, s49, 1
    s_cbranch_scc1 L_end
    buffer_load_dword v5, v4, s[40:43], 0 offen sc1
    s_waitcnt vmcnt(0)
    s_branch L3
L4:
    s_lshl_b32 s98, s51, 5
    v_cmp_ne_u32 vcc, s98, v5
    s_nop 1
    s_bitcmp1_b32 vcc_lo, s6
    s_cselect_b32 s48, 0, 1
    buffer_load_dwordx4 v11, s[20:23], s85 offen offset:2048 lds
    s_add_u32 m0, s14, 50176
    s_waitcnt lgkmcnt(2)
    v_fma_f32 v100, -v64, v124, v100
    v_fma_f32 v101, -v65, v124, v101
    v_fma_f32 v102, -v66, v124, v102
    v_fma_f32 v103, -v67, v124, v103
    ds_read_b128 v[64:67], v127 offset:1024
    v_mul_f32 v100, v100, v80
    s_waitcnt lgkmcnt(1)
    v_mfma_f32_16x16x16_bf16 v[32:35], v[76:77], v[60:61], v[32:35]
    v_mul_f32 v101, v101, v81
    v_mul_f32 v102, v102, v82
    v_mul_f32 v103, v103, v83
    ds_read_b128 v[80:83], v127
    v_cvt_pk_bf16_f32 v100, v100, v101
    buffer_load_dwordx4 v11, s[20:23], s84 offen offset:1024 lds
    v_cvt_pk_bf16_f32 v101, v102, v103
    v_pk_fma_f32 v[108:109], v[36:37], v[124:125], v[108:109] op_sel_hi:[1,0,1] neg_lo:[0,1,0] neg_hi:[0,1,0]
    v_pk_fma_f32 v[110:111], v[38:39], v[124:125], v[110:111] op_sel_hi:[1,0,1] neg_lo:[0,1,0] neg_hi:[0,1,0]
    ds_read_b128 v[36:39], v127 offset:3072
    v_pk_mul_f32 v[108:109], v[108:109], v[40:41]
    v_pk_mul_f32 v[110:111], v[110:111], v[42:43]
    ds_read_b128 v[40:43], v127
    v_cvt_pk_bf16_f32 v108, v108, v109
    v_cvt_pk_bf16_f32 v109, v110, v111
    v_lshrrev_b32 v56, 4, v0
    v_and_b32 v10, 15, v56
    v_lshlrev_b32 v10, 11, v10
    v_bfe_u32 v57, v56, 4, 1
    v_lshl_add_u32 v10, v57, 5, v10
    v_lshrrev_b32 v57, 5, v56
    v_lshl_add_u32 v10, v57, 4, v10
    buffer_load_dwordx4 v11, s[20:23], s84 offen offset:2048 lds
    s_lshl_b32 s82, s5, 6
    s_add_u32 s82, s82, s83
    s_waitcnt lgkmcnt(3)
    v_mfma_f32_16x16x16_bf16 v[64:67], v[76:77], v[62:63], v[64:67]
    s_lshr_b32 s83, s3, 1
    s_add_u32 s82, s82, s83
    s_lshl_b32 s82, s82, 10
    s_lshl_b32 s83, s4, 7
    s_add_u32 s82, s82, s83
    s_waitcnt lgkmcnt(2)
    v_mfma_f32_16x16x16_bf16 v[80:83], v[78:79], v[62:63], v[80:83]
    s_nop 0
    v_max3_f32 v20, v64, v65, v66
    v_add_u32 v10, s82, v10
    v_pk_fma_f32 v[112:113], v[44:45], v[124:125], v[112:113] op_sel_hi:[1,0,1] neg_lo:[0,1,0] neg_hi:[0,1,0]
    buffer_load_dwordx4 v[2:5], v10, s[8:11], 0 offen
    v_pk_fma_f32 v[114:115], v[46:47], v[124:125], v[114:115] op_sel_hi:[1,0,1] neg_lo:[0,1,0] neg_hi:[0,1,0]
    v_pk_mul_f32 v[112:113], v[112:113], v[48:49]
    s_waitcnt lgkmcnt(0)
    v_mfma_f32_16x16x16_bf16 v[40:43], v[84:85], v[68:69], v[40:43]
    buffer_load_dwordx4 v[6:9], v10, s[8:11], 0 offen offset:64
    v_max3_f32 v20, v20, v67, v80
    v_max3_f32 v20, v20, v81, v82
    v_max_f32 v20, v20, v83
    v_mov_b32 v21, v20
    v_pk_mul_f32 v[114:115], v[114:115], v[50:51]
    v_cvt_pk_bf16_f32 v96, v112, v113
    v_permlane32_swap_b32 v20, v21
    v_max_f32 v20, v20, v21
    v_mov_b32 v21, v20
    v_cvt_pk_bf16_f32 v97, v114, v115
    v_cvt_pk_bf16_f32 v104, v112, v113
    v_permlane16_swap_b32 v20, v21
    v_max_f32 v20, v20, v21
    v_mul_f32 v20, s12, v20
    v_fma_f32 v64, v64, s12, -v20
    v_fma_f32 v65, v65, s12, -v20
    v_fma_f32 v66, v66, s12, -v20
    v_fma_f32 v67, v67, s12, -v20
    v_fma_f32 v80, v80, s12, -v20
    v_fma_f32 v81, v81, s12, -v20
    v_fma_f32 v82, v82, s12, -v20
    v_fma_f32 v83, v83, s12, -v20
    ds_read2_b32 v[20:21], v22 offset0:64 offset1:192
    v_exp_f32 v64, v64
    v_exp_f32 v65, v65
    v_exp_f32 v66, v66
    v_exp_f32 v67, v67
    v_exp_f32 v80, v80
    v_exp_f32 v81, v81
    v_exp_f32 v82, v82
    v_exp_f32 v83, v83
    v_cvt_pk_bf16_f32 v64, v64, v65
    v_cvt_pk_bf16_f32 v65, v66, v67
    v_cvt_pk_bf16_f32 v66, v80, v81
    v_cvt_pk_bf16_f32 v67, v82, v83
    v_cvt_pk_bf16_f32 v105, v114, v115
    v_max3_f32 v116, v72, v73, v74
    v_mfma_f32_16x16x32_bf16 v[16:19], v[24:27], v[64:67], 0
    v_max3_f32 v116, v116, v75, v88
    v_max3_f32 v116, v116, v89, v90
    v_mfma_f32_16x16x32_bf16 v[80:83], v[98:101], v[64:67], 0
    v_max_f32 v116, v116, v91
    s_waitcnt lgkmcnt(0)
    v_pk_fma_f32 v[92:93], v[120:121], v[20:21], v[92:93] op_sel_hi:[1,0,1] neg_lo:[0,1,0] neg_hi:[0,1,0]
    s_nop 1
    v_rcp_f32 v16, v16
    v_pk_fma_f32 v[94:95], v[122:123], v[20:21], v[94:95] op_sel_hi:[1,0,1] neg_lo:[0,1,0] neg_hi:[0,1,0]
    v_pk_mul_f32 v[92:93], v[92:93], v[20:21] op_sel:[0,1] op_sel_hi:[1,1]
    v_mul_f32 v80, v80, v16
    v_mul_f32 v81, v81, v16
    v_mul_f32 v82, v82, v16
    v_mul_f32 v83, v83, v16
    v_cvt_pk_bf16_f32 v102, v80, v81
    v_cvt_pk_bf16_f32 v103, v82, v83
    v_pk_mul_f32 v[94:95], v[94:95], v[20:21] op_sel:[0,1] op_sel_hi:[1,1]
    v_cvt_pk_bf16_f32 v92, v92, v93
    v_cvt_pk_bf16_f32 v93, v94, v95
    s_nop 1
    v_mfma_f32_16x16x16_bf16 v[28:31], v[92:93], v[60:61], v[28:31]
    v_mfma_f32_16x16x16_bf16 v[36:39], v[92:93], v[68:69], v[36:39]
    s_nop 6
    v_max3_f32 v117, v28, v29, v30
    v_max3_f32 v117, v117, v31, v32
    v_max3_f32 v117, v117, v33, v34
    v_max_f32 v117, v117, v35
    v_max3_f32 v118, v36, v37, v38
    v_max3_f32 v118, v118, v39, v40
    v_max3_f32 v118, v118, v41, v42
    v_max_f32 v118, v118, v43
    v_mov_b32 v119, v118
    v_permlane32_swap_b32 v116, v117
    s_nop 0
    v_permlane32_swap_b32 v118, v119
    v_max_f32 v116, v116, v117
    v_max_f32 v118, v118, v119
    s_nop 1
    v_permlane16_swap_b32 v116, v118
    v_max_f32 v116, v116, v118
    v_mul_f32 v116, s12, v116
    v_mov_b32 v118, v116
    s_nop 1
    v_permlane16_swap_b32 v116, v118
    v_mov_b32 v117, v116
    v_mov_b32 v119, v118
    s_nop 0
    v_permlane32_swap_b32 v116, v117
    v_permlane32_swap_b32 v118, v119
    v_pk_fma_f32 v[72:73], v[72:73], s[12:13], v[116:117] op_sel:[0,0,0] op_sel_hi:[1,1,0] neg_lo:[0,0,1] neg_hi:[0,0,1]
    v_pk_fma_f32 v[74:75], v[74:75], s[12:13], v[116:117] op_sel:[0,0,0] op_sel_hi:[1,1,0] neg_lo:[0,0,1] neg_hi:[0,0,1]
    v_pk_fma_f32 v[88:89], v[88:89], s[12:13], v[116:117] op_sel:[0,0,0] op_sel_hi:[1,1,0] neg_lo:[0,0,1] neg_hi:[0,0,1]
    v_pk_fma_f32 v[90:91], v[90:91], s[12:13], v[116:117] op_sel:[0,0,0] op_sel_hi:[1,1,0] neg_lo:[0,0,1] neg_hi:[0,0,1]
    v_exp_f32 v72, v72
    v_exp_f32 v73, v73
    v_exp_f32 v74, v74
    v_exp_f32 v75, v75
    v_exp_f32 v88, v88
    v_exp_f32 v89, v89
    v_exp_f32 v90, v90
    v_exp_f32 v91, v91
    v_cvt_pk_bf16_f32 v72, v72, v73
    v_cvt_pk_bf16_f32 v73, v74, v75
    v_cvt_pk_bf16_f32 v74, v88, v89
    v_cvt_pk_bf16_f32 v75, v90, v91
    v_pk_fma_f32 v[28:29], v[28:29], s[12:13], v[116:117] op_sel:[0,0,1] op_sel_hi:[1,1,1] neg_lo:[0,0,1] neg_hi:[0,0,1]
    v_pk_fma_f32 v[30:31], v[30:31], s[12:13], v[116:117] op_sel:[0,0,1] op_sel_hi:[1,1,1] neg_lo:[0,0,1] neg_hi:[0,0,1]
    v_pk_fma_f32 v[32:33], v[32:33], s[12:13], v[116:117] op_sel:[0,0,1] op_sel_hi:[1,1,1] neg_lo:[0,0,1] neg_hi:[0,0,1]
    v_pk_fma_f32 v[34:35], v[34:35], s[12:13], v[116:117] op_sel:[0,0,1] op_sel_hi:[1,1,1] neg_lo:[0,0,1] neg_hi:[0,0,1]
    v_exp_f32 v28, v28
    v_mfma_f32_16x16x32_bf16 v[16:19], v[24:27], v[72:75], 0
    v_exp_f32 v29, v29
    v_mfma_f32_16x16x32_bf16 v[88:91], v[106:109], v[72:75], 0
    v_exp_f32 v30, v30
    v_exp_f32 v31, v31
    v_exp_f32 v32, v32
    v_exp_f32 v33, v33
    v_exp_f32 v34, v34
    v_exp_f32 v35, v35
    v_cvt_pk_bf16_f32 v28, v28, v29
    v_cvt_pk_bf16_f32 v29, v30, v31
    v_cvt_pk_bf16_f32 v30, v32, v33
    v_cvt_pk_bf16_f32 v31, v34, v35
    v_pk_fma_f32 v[36:37], v[36:37], s[12:13], v[118:119] op_sel:[0,0,0] op_sel_hi:[1,1,0] neg_lo:[0,0,1] neg_hi:[0,0,1]
    v_pk_fma_f32 v[38:39], v[38:39], s[12:13], v[118:119] op_sel:[0,0,0] op_sel_hi:[1,1,0] neg_lo:[0,0,1] neg_hi:[0,0,1]
    v_mfma_f32_16x16x32_bf16 v[12:15], v[24:27], v[28:31], 0
    v_exp_f32 v36, v36
    v_mfma_f32_16x16x32_bf16 v[32:35], v[96:99], v[28:31], 0
    v_exp_f32 v37, v37
    v_pk_fma_f32 v[40:41], v[40:41], s[12:13], v[118:119] op_sel:[0,0,0] op_sel_hi:[1,1,0] neg_lo:[0,0,1] neg_hi:[0,0,1]
    v_pk_fma_f32 v[42:43], v[42:43], s[12:13], v[118:119] op_sel:[0,0,0] op_sel_hi:[1,1,0] neg_lo:[0,0,1] neg_hi:[0,0,1]
    v_exp_f32 v38, v38
    v_exp_f32 v39, v39
    v_exp_f32 v40, v40
    v_exp_f32 v41, v41
    v_exp_f32 v42, v42
    v_exp_f32 v43, v43
    v_cvt_pk_bf16_f32 v36, v36, v37
    v_cvt_pk_bf16_f32 v37, v38, v39
    v_cvt_pk_bf16_f32 v38, v40, v41
    v_cvt_pk_bf16_f32 v39, v42, v43
    v_rcp_f32 v16, v16
    s_nop 0
    v_mfma_f32_16x16x32_bf16 v[52:55], v[24:27], v[36:39], 0
    v_rcp_f32 v12, v12
    v_mfma_f32_16x16x32_bf16 v[40:43], v[104:107], v[36:39], 0
    v_pk_mul_f32 v[88:89], v[88:89], v[16:17] op_sel_hi:[1,0]
    v_pk_mul_f32 v[90:91], v[90:91], v[16:17] op_sel_hi:[1,0]
    v_cvt_pk_bf16_f32 v110, v88, v89
    v_cvt_pk_bf16_f32 v111, v90, v91
    v_pk_mul_f32 v[32:33], v[32:33], v[12:13] op_sel_hi:[1,0]
    v_pk_mul_f32 v[34:35], v[34:35], v[12:13] op_sel_hi:[1,0]
    v_cvt_pk_bf16_f32 v100, v32, v33
    v_cvt_pk_bf16_f32 v101, v34, v35
    v_rcp_f32 v52, v52
    s_nop 0
    v_pk_mul_f32 v[40:41], v[40:41], v[52:53] op_sel_hi:[1,0]
    v_pk_mul_f32 v[42:43], v[42:43], v[52:53] op_sel_hi:[1,0]
    v_cvt_pk_bf16_f32 v108, v40, v41
    v_cvt_pk_bf16_f32 v109, v42, v43
    v_permlane16_swap_b32 v100, v102
    v_permlane16_swap_b32 v101, v103
    v_permlane16_swap_b32 v108, v110
    v_permlane16_swap_b32 v109, v111
    s_cmp_eq_u32 s48, 0
    s_cbranch_scc1 L5
    buffer_store_dwordx4 v[100:103], v126, s[36:39], s64 offen
    buffer_store_dwordx4 v[108:111], v126, s[36:39], s65 offen
L6:
    v_mov_b32 v47, 1
    v_lshrrev_b32 v120, 4, v0
    v_lshrrev_b32 v123, 4, v120
    v_mul_u32_u24 v123, 2048, v123
    v_bfe_u32 v121, v120, 2, 2
    v_lshl_add_u32 v123, v121, 7, v123
    v_and_b32 v121, 3, v120
    v_lshl_add_u32 v123, v121, 3, v123
    v_bfe_u32 v121, v120, 3, 2
    v_xor_b32 v121, s3, v121
    v_lshl_add_u32 v123, v121, 5, v123
    v_add_u32 v123, 1024, v123
    v_lshrrev_b32 v122, 1, v0
    s_add_u32 s96, s62, 61440
    v_add_u32 v122, s96, v122
    v_lshrrev_b32 v58, 4, v0
    v_lshrrev_b32 v124, 4, v58
    v_mul_u32_u24 v124, 1024, v124
    v_bfe_u32 v59, v58, 2, 2
    v_lshl_add_u32 v124, v59, 7, v124
    v_and_b32 v59, 3, v58
    v_lshl_add_u32 v124, v59, 3, v124
    v_bfe_u32 v59, v58, 3, 2
    v_lshl_add_u32 v124, v59, 5, v124
    v_add_u32 v124, 90112, v124
    v_xor_b32 v125, 32, v124
    v_xor_b32 v126, 64, v124
    v_xor_b32 v127, 96, v124
    s_waitcnt vmcnt(3)
    v_permlane16_swap_b32 v2, v4
    v_permlane16_swap_b32 v3, v5
    s_waitcnt vmcnt(2)
    v_permlane16_swap_b32 v6, v8
    v_permlane16_swap_b32 v7, v9
    v_lshlrev_b32 v12, 16, v2
    v_and_b32 v13, 0xffff0000, v2
    v_lshlrev_b32 v14, 16, v3
    v_and_b32 v15, 0xffff0000, v3
    v_lshlrev_b32 v16, 16, v4
    v_and_b32 v17, 0xffff0000, v4
    v_lshlrev_b32 v18, 16, v5
    v_and_b32 v19, 0xffff0000, v5
    v_lshlrev_b32 v20, 16, v6
    v_and_b32 v21, 0xffff0000, v6
    v_lshlrev_b32 v22, 16, v7
    v_and_b32 v23, 0xffff0000, v7
    v_lshlrev_b32 v24, 16, v8
    v_and_b32 v25, 0xffff0000, v8
    v_lshlrev_b32 v26, 16, v9
    v_and_b32 v27, 0xffff0000, v9
    v_lshrrev_b32 v60, 2, v0
    v_and_b32 v60, 0x7c, v60
    s_waitcnt vmcnt(0)
    s_cmp_eq_u32 s48, 0
    s_cbranch_scc1 L7
    buffer_store_dword v47, off, s[36:39], s74
L8:
    s_barrier
    ds_read_b64_tr_b16 a[196:197], v123 offset:0
    ds_read_b64_tr_b16 a[198:199], v123 offset:512
    ds_read_b64_tr_b16 a[200:201], v123 offset:1024
    ds_read_b64_tr_b16 a[202:203], v123 offset:1536
    ds_read_b64_tr_b16 a[208:209], v123 offset:8192
    ds_read_b64_tr_b16 a[210:211], v123 offset:8704
    ds_read_b64_tr_b16 a[212:213], v123 offset:9216
    ds_read_b64_tr_b16 a[214:215], v123 offset:9728
    ds_read_b64_tr_b16 a[220:221], v123 offset:16384
    ds_read_b64_tr_b16 a[222:223], v123 offset:16896
    ds_read_b64_tr_b16 a[224:225], v123 offset:17408
    ds_read_b64_tr_b16 a[226:227], v123 offset:17920
    ds_read_b64_tr_b16 a[232:233], v123 offset:24576
    ds_read_b64_tr_b16 a[234:235], v123 offset:25088
    ds_read_b64_tr_b16 a[236:237], v123 offset:25600
    ds_read_b64_tr_b16 a[238:239], v123 offset:26112
    ds_read_b64_tr_b16 a[244:245], v123 offset:32768
    ds_read_b64_tr_b16 a[246:247], v123 offset:33280
    ds_read_b64_tr_b16 a[248:249], v123 offset:33792
    ds_read_b64_tr_b16 a[250:251], v123 offset:34304
    ds_read_b64_tr_b16 v[128:129], v123 offset:40960
    ds_read_b64_tr_b16 v[130:131], v123 offset:41472
    ds_read_b64_tr_b16 v[132:133], v123 offset:41984
    ds_read_b64_tr_b16 v[134:135], v123 offset:42496
    ds_read_b64_tr_b16 v[140:141], v123 offset:49152
    ds_read_b64_tr_b16 v[142:143], v123 offset:49664
    ds_read_b64_tr_b16 v[144:145], v123 offset:50176
    ds_read_b64_tr_b16 v[146:147], v123 offset:50688
    ds_read_b64_tr_b16 v[10:11], v122
    s_waitcnt lgkmcnt(0)
    s_barrier
    ds_read_b64_tr_b16 v[28:29], v124 offset:0
    ds_read_b64_tr_b16 v[30:31], v124 offset:512
    ds_read_b64_tr_b16 v[32:33], v125 offset:0
    ds_read_b64_tr_b16 v[34:35], v125 offset:512
    ds_read_b64_tr_b16 v[36:37], v126 offset:0
    ds_read_b64_tr_b16 v[38:39], v126 offset:512
    ds_read_b64_tr_b16 v[40:41], v127 offset:0
    ds_read_b64_tr_b16 v[42:43], v127 offset:512
    ds_read_b64_tr_b16 v[44:45], v124 offset:4096
    ds_read_b64_tr_b16 v[46:47], v124 offset:4608
    ds_read_b64_tr_b16 v[48:49], v125 offset:4096
    ds_read_b64_tr_b16 v[50:51], v125 offset:4608
    ds_read_b64_tr_b16 v[52:53], v126 offset:4096
    ds_read_b64_tr_b16 v[54:55], v126 offset:4608
    ds_read_b64_tr_b16 v[56:57], v127 offset:4096
    ds_read_b64_tr_b16 v[58:59], v127 offset:4608
L9:
    buffer_load_dword v61, v60, s[36:39], s75 offen sc1
    s_sub_u32 s49, s49, 1
    s_cbranch_scc1 L_end
    s_waitcnt vmcnt(0)
    v_cmp_gt_u32 vcc, 1, v61
    s_cbranch_vccnz L9
    buffer_load_dwordx4 v[60:63], v0, s[36:39], s66 offen offset:0 sc1
    v_lshrrev_b32 v4, 4, v0
    v_lshrrev_b32 v2, 3, v4
    s_lshl_b32 s80, s3, 3
    v_add_u32 v2, s80, v2
    v_mul_u32_u24 v2, 3072, v2
    v_bfe_u32 v5, v4, 4, 1
    s_and_b32 s81, s3, 1
    s_lshl_b32 s81, s81, 1
    v_or_b32 v5, s81, v5
    buffer_load_dwordx4 v[64:67], v0, s[36:39], s66 offen offset:1024 sc1
    v_lshlrev_b32 v5, 1, v5
    v_and_b32 v4, 7, v4
    v_xor_b32 v4, v4, v5
    v_lshl_add_u32 v2, v4, 4, v2
    s_lshl_b32 s80, s4, 7
    v_add_u32 v2, s80, v2
    s_add_u32 s85, s60, 7
    s_and_b32 s85, s85, 15
    s_mul_i32 s85, s85, 98304
    buffer_load_dwordx4 v[68:71], v0, s[36:39], s66 offen offset:2048 sc1
    s_add_u32 m0, s14, 1024
    s_add_u32 s84, s60, 8
    s_and_b32 s84, s84, 15
    s_mul_i32 s84, s84, 98304
    buffer_load_dwordx4 v[72:75], v0, s[36:39], s66 offen offset:3072 sc1
    buffer_load_dwordx4 v[76:79], v0, s[36:39], s67 offen offset:0 sc1
    buffer_load_dwordx4 v[80:83], v0, s[36:39], s67 offen offset:1024 sc1
    buffer_load_dwordx4 v[84:87], v0, s[36:39], s67 offen offset:2048 sc1
    buffer_load_dwordx4 v[88:91], v0, s[36:39], s67 offen offset:3072 sc1
    buffer_load_dwordx4 v[92:95], v0, s[36:39], s68 offen offset:0 sc1
    buffer_load_dwordx4 v[96:99], v0, s[36:39], s68 offen offset:1024 sc1
    s_waitcnt vmcnt(9) lgkmcnt(0)
    v_mfma_f32_16x16x32_bf16 v[12:15], v[28:31], v[60:63], v[12:15]
    buffer_load_dwordx4 v[100:103], v0, s[36:39], s68 offen offset:2048 sc1
    ds_read_b64_tr_b16 v[28:29], v124 offset:8192
    v_mfma_f32_16x16x32_bf16 v[16:19], v[32:35], v[60:63], v[16:19]
    ds_read_b64_tr_b16 v[30:31], v124 offset:8704
    ds_read_b64_tr_b16 v[32:33], v125 offset:8192
    v_mfma_f32_16x16x32_bf16 v[20:23], v[36:39], v[60:63], v[20:23]
    ds_read_b64_tr_b16 v[34:35], v125 offset:8704
    ds_read_b64_tr_b16 v[36:37], v126 offset:8192
    v_mfma_f32_16x16x32_bf16 v[24:27], v[40:43], v[60:63], v[24:27]
    buffer_load_dwordx4 v[104:107], v0, s[36:39], s68 offen offset:3072 sc1
    ds_read_b64_tr_b16 v[38:39], v126 offset:8704
    s_waitcnt vmcnt(10)
    v_mfma_f32_16x16x32_bf16 v[12:15], v[44:47], v[64:67], v[12:15]
    ds_read_b64_tr_b16 v[40:41], v127 offset:8192
    ds_read_b64_tr_b16 v[42:43], v127 offset:8704
    v_mfma_f32_16x16x32_bf16 v[16:19], v[48:51], v[64:67], v[16:19]
    ds_read_b64_tr_b16 v[44:45], v124 offset:12288
    buffer_load_dwordx4 v[108:111], v0, s[36:39], s69 offen offset:0 sc1
    v_mfma_f32_16x16x32_bf16 v[20:23], v[52:55], v[64:67], v[20:23]
    ds_read_b64_tr_b16 v[46:47], v124 offset:12800
    ds_read_b64_tr_b16 v[48:49], v125 offset:12288
    v_mfma_f32_16x16x32_bf16 v[24:27], v[56:59], v[64:67], v[24:27]
    ds_read_b64_tr_b16 v[50:51], v125 offset:12800
    ds_read_b64_tr_b16 v[52:53], v126 offset:12288
    ds_read_b64_tr_b16 v[54:55], v126 offset:12800
    buffer_load_dwordx4 v[112:115], v0, s[36:39], s69 offen offset:1024 sc1
    ds_read_b64_tr_b16 v[56:57], v127 offset:12288
    s_waitcnt vmcnt(11) lgkmcnt(9)
    v_mfma_f32_16x16x32_bf16 v[12:15], v[28:31], v[68:71], v[12:15]
    ds_read_b64_tr_b16 v[58:59], v127 offset:12800
    ds_read_b64_tr_b16 v[28:29], v124 offset:16384
    v_mfma_f32_16x16x32_bf16 v[16:19], v[32:35], v[68:71], v[16:19]
    ds_read_b64_tr_b16 v[30:31], v124 offset:16896
    buffer_load_dwordx4 v[116:119], v0, s[36:39], s69 offen offset:2048 sc1
    v_mfma_f32_16x16x32_bf16 v[20:23], v[36:39], v[68:71], v[20:23]
    ds_read_b64_tr_b16 v[32:33], v125 offset:16384
    ds_read_b64_tr_b16 v[34:35], v125 offset:16896
    ds_read_b64_tr_b16 v[36:37], v126 offset:16384
    s_waitcnt lgkmcnt(8)
    v_mfma_f32_16x16x32_bf16 v[24:27], v[40:43], v[68:71], v[24:27]
    ds_read_b64_tr_b16 v[38:39], v126 offset:16896
    buffer_load_dwordx4 v[120:123], v0, s[36:39], s69 offen offset:3072 sc1
    ds_read_b64_tr_b16 v[40:41], v127 offset:16384
    s_waitcnt vmcnt(12)
    v_mfma_f32_16x16x32_bf16 v[12:15], v[44:47], v[72:75], v[12:15]
    ds_read_b64_tr_b16 v[42:43], v127 offset:16896
    ds_read_b64_tr_b16 v[44:45], v124 offset:20480
    v_mfma_f32_16x16x32_bf16 v[16:19], v[48:51], v[72:75], v[16:19]
    buffer_load_dwordx4 v2, s[20:23], s85 offen offset:1024 lds
    ds_read_b64_tr_b16 v[46:47], v124 offset:20992
    s_waitcnt lgkmcnt(6)
    v_mfma_f32_16x16x32_bf16 v[20:23], v[52:55], v[72:75], v[20:23]
    ds_read_b64_tr_b16 v[48:49], v125 offset:20480
    ds_read_b64_tr_b16 v[50:51], v125 offset:20992
    v_mfma_f32_16x16x32_bf16 v[24:27], v[56:59], v[72:75], v[24:27]
    ds_read_b64_tr_b16 v[52:53], v126 offset:20480
    ds_read_b64_tr_b16 v[54:55], v126 offset:20992
    s_waitcnt vmcnt(12)
    v_mfma_f32_16x16x32_bf16 v[12:15], v[28:31], v[76:79], v[12:15]
    ds_read_b64_tr_b16 v[56:57], v127 offset:20480
    ds_read_b64_tr_b16 v[58:59], v127 offset:20992
    v_mfma_f32_16x16x32_bf16 v[16:19], v[32:35], v[76:79], v[16:19]
    buffer_load_dwordx4 v2, s[20:23], s85 offen offset:2048 lds
    ds_read_b64_tr_b16 v[28:29], v124 offset:24576
    s_waitcnt lgkmcnt(7)
    v_mfma_f32_16x16x32_bf16 v[20:23], v[36:39], v[76:79], v[20:23]
    ds_read_b64_tr_b16 v[30:31], v124 offset:25088
    ds_read_b64_tr_b16 v[32:33], v125 offset:24576
    ds_read_b64_tr_b16 v[34:35], v125 offset:25088
    v_mfma_f32_16x16x32_bf16 v[24:27], v[40:43], v[76:79], v[24:27]
    ds_read_b64_tr_b16 v[36:37], v126 offset:24576
    ds_read_b64_tr_b16 v[38:39], v126 offset:25088
    ds_read_b64_tr_b16 v[40:41], v127 offset:24576
    s_waitcnt vmcnt(12)
    v_mfma_f32_16x16x32_bf16 v[12:15], v[44:47], v[80:83], v[12:15]
    ds_read_b64_tr_b16 v[42:43], v127 offset:25088
    ds_read_b64_tr_b16 v[44:45], v124 offset:28672
    s_waitcnt lgkmcnt(9)
    v_mfma_f32_16x16x32_bf16 v[16:19], v[48:51], v[80:83], v[16:19]
    ds_read_b64_tr_b16 v[46:47], v124 offset:29184
    ds_read_b64_tr_b16 v[48:49], v125 offset:28672
    v_mfma_f32_16x16x32_bf16 v[20:23], v[52:55], v[80:83], v[20:23]
    ds_read_b64_tr_b16 v[50:51], v125 offset:29184
    ds_read_b64_tr_b16 v[52:53], v126 offset:28672
    v_mfma_f32_16x16x32_bf16 v[24:27], v[56:59], v[80:83], v[24:27]
    ds_read_b64_tr_b16 v[54:55], v126 offset:29184
    s_add_u32 m0, s14, 9216
    ds_read_b64_tr_b16 v[56:57], v127 offset:28672
    buffer_load_dwordx4 v2, s[20:23], s84 offen offset:1024 lds
    s_add_u32 s85, s60, 9
    s_and_b32 s85, s85, 15
    s_waitcnt vmcnt(12) lgkmcnt(6)
    v_mfma_f32_16x16x32_bf16 v[12:15], v[28:31], v[84:87], v[12:15]
    ds_read_b64_tr_b16 v[58:59], v127 offset:29184
    ds_read_b64_tr_b16 v[28:29], v124 offset:32768
    v_mfma_f32_16x16x32_bf16 v[16:19], v[32:35], v[84:87], v[16:19]
    ds_read_b64_tr_b16 v[30:31], v124 offset:33280
    ds_read_b64_tr_b16 v[32:33], v125 offset:32768
    v_mfma_f32_16x16x32_bf16 v[20:23], v[36:39], v[84:87], v[20:23]
    ds_read_b64_tr_b16 v[34:35], v125 offset:33280
    ds_read_b64_tr_b16 v[36:37], v126 offset:32768
    v_mfma_f32_16x16x32_bf16 v[24:27], v[40:43], v[84:87], v[24:27]
    buffer_load_dwordx4 v2, s[20:23], s84 offen offset:2048 lds
    ds_read_b64_tr_b16 v[38:39], v126 offset:33280
    s_waitcnt vmcnt(12) lgkmcnt(7)
    v_mfma_f32_16x16x32_bf16 v[12:15], v[44:47], v[88:91], v[12:15]
    ds_read_b64_tr_b16 v[40:41], v127 offset:32768
    ds_read_b64_tr_b16 v[42:43], v127 offset:33280
    v_mfma_f32_16x16x32_bf16 v[16:19], v[48:51], v[88:91], v[16:19]
    ds_read_b64_tr_b16 v[44:45], v124 offset:36864
    ds_read_b64_tr_b16 v[46:47], v124 offset:37376
    v_mfma_f32_16x16x32_bf16 v[20:23], v[52:55], v[88:91], v[20:23]
    ds_read_b64_tr_b16 v[48:49], v125 offset:36864
    ds_read_b64_tr_b16 v[50:51], v125 offset:37376
    ds_read_b64_tr_b16 v[52:53], v126 offset:36864
    s_mul_i32 s85, s85, 98304
    s_add_u32 m0, s14, 17408
    s_waitcnt lgkmcnt(8)
    v_mfma_f32_16x16x32_bf16 v[24:27], v[56:59], v[88:91], v[24:27]
    buffer_load_dwordx4 v2, s[20:23], s85 offen offset:1024 lds
    ds_read_b64_tr_b16 v[54:55], v126 offset:37376
    s_waitcnt vmcnt(12)
    v_mfma_f32_16x16x32_bf16 v[12:15], v[28:31], v[92:95], v[12:15]
    ds_read_b64_tr_b16 v[56:57], v127 offset:36864
    ds_read_b64_tr_b16 v[58:59], v127 offset:37376
    v_mfma_f32_16x16x32_bf16 v[16:19], v[32:35], v[92:95], v[16:19]
    ds_read_b64_tr_b16 v[28:29], v124 offset:40960
    ds_read_b64_tr_b16 v[30:31], v124 offset:41472
    s_waitcnt lgkmcnt(6)
    v_mfma_f32_16x16x32_bf16 v[20:23], v[36:39], v[92:95], v[20:23]
    ds_read_b64_tr_b16 v[32:33], v125 offset:40960
    ds_read_b64_tr_b16 v[34:35], v125 offset:41472
    v_mfma_f32_16x16x32_bf16 v[24:27], v[40:43], v[92:95], v[24:27]
    buffer_load_dwordx4 v2, s[20:23], s85 offen offset:2048 lds
    ds_read_b64_tr_b16 v[36:37], v126 offset:40960
    s_waitcnt vmcnt(12)
    v_mfma_f32_16x16x32_bf16 v[12:15], v[44:47], v[96:99], v[12:15]
    ds_read_b64_tr_b16 v[38:39], v126 offset:41472
    ds_read_b64_tr_b16 v[40:41], v127 offset:40960
    v_mfma_f32_16x16x32_bf16 v[16:19], v[48:51], v[96:99], v[16:19]
    ds_read_b64_tr_b16 v[42:43], v127 offset:41472
    ds_read_b64_tr_b16 v[44:45], v124 offset:45056
    ds_read_b64_tr_b16 v[46:47], v124 offset:45568
    ds_read_b64_tr_b16 v[48:49], v125 offset:45056
    s_waitcnt lgkmcnt(9)
    v_mfma_f32_16x16x32_bf16 v[20:23], v[52:55], v[96:99], v[20:23]
    ds_read_b64_tr_b16 v[50:51], v125 offset:45568
    ds_read_b64_tr_b16 v[52:53], v126 offset:45056
    v_mfma_f32_16x16x32_bf16 v[24:27], v[56:59], v[96:99], v[24:27]
    ds_read_b64_tr_b16 v[54:55], v126 offset:45568
    ds_read_b64_tr_b16 v[56:57], v127 offset:45056
    s_waitcnt vmcnt(11)
    v_mfma_f32_16x16x32_bf16 v[12:15], v[28:31], v[100:103], v[12:15]
    ds_read_b64_tr_b16 v[58:59], v127 offset:45568
    ds_read_b64_tr_b16 v[28:29], v124 offset:49152
    s_waitcnt lgkmcnt(9)
    v_mfma_f32_16x16x32_bf16 v[16:19], v[32:35], v[100:103], v[16:19]
    ds_read_b64_tr_b16 v[30:31], v124 offset:49664
    ds_read_b64_tr_b16 v[32:33], v125 offset:49152
    s_add_u32 s84, s60, 10
    s_and_b32 s84, s84, 15
    s_mul_i32 s84, s84, 98304
    v_mfma_f32_16x16x32_bf16 v[20:23], v[36:39], v[100:103], v[20:23]
    ds_read_b64_tr_b16 v[34:35], v125 offset:49664
    ds_read_b64_tr_b16 v[36:37], v126 offset:49152
    v_mfma_f32_16x16x32_bf16 v[24:27], v[40:43], v[100:103], v[24:27]
    ds_read_b64_tr_b16 v[38:39], v126 offset:49664
    ds_read_b64_tr_b16 v[40:41], v127 offset:49152
    s_waitcnt vmcnt(10) lgkmcnt(7)
    v_mfma_f32_16x16x32_bf16 v[12:15], v[44:47], v[104:107], v[12:15]
    ds_read_b64_tr_b16 v[42:43], v127 offset:49664
    ds_read_b64_tr_b16 v[44:45], v124 offset:53248
    v_mfma_f32_16x16x32_bf16 v[16:19], v[48:51], v[104:107], v[16:19]
    ds_read_b64_tr_b16 v[46:47], v124 offset:53760
    ds_read_b64_tr_b16 v[48:49], v125 offset:53248
    v_mfma_f32_16x16x32_bf16 v[20:23], v[52:55], v[104:107], v[20:23]
    ds_read_b64_tr_b16 v[50:51], v125 offset:53760
    ds_read_b64_tr_b16 v[52:53], v126 offset:53248
    v_mfma_f32_16x16x32_bf16 v[24:27], v[56:59], v[104:107], v[24:27]
    ds_read_b64_tr_b16 v[54:55], v126 offset:53760
    ds_read_b64_tr_b16 v[56:57], v127 offset:53248
    s_waitcnt vmcnt(9) lgkmcnt(8)
    v_mfma_f32_16x16x32_bf16 v[12:15], v[28:31], v[108:111], v[12:15]
    ds_read_b64_tr_b16 v[58:59], v127 offset:53760
    ds_read_b64_tr_b16 v[28:29], v124 offset:57344
    s_add_u32 m0, s14, 25600
    s_add_u32 s85, s60, 11
    v_mfma_f32_16x16x32_bf16 v[16:19], v[32:35], v[108:111], v[16:19]
    buffer_load_dwordx4 v2, s[20:23], s84 offen offset:1024 lds
    ds_read_b64_tr_b16 v[30:31], v124 offset:57856
    v_mfma_f32_16x16x32_bf16 v[20:23], v[36:39], v[108:111], v[20:23]
    ds_read_b64_tr_b16 v[32:33], v125 offset:57344
    ds_read_b64_tr_b16 v[34:35], v125 offset:57856
    ds_read_b64_tr_b16 v[36:37], v126 offset:57344
    s_waitcnt lgkmcnt(7)
    v_mfma_f32_16x16x32_bf16 v[24:27], v[40:43], v[108:111], v[24:27]
    ds_read_b64_tr_b16 v[38:39], v126 offset:57856
    ds_read_b64_tr_b16 v[40:41], v127 offset:57344
    s_waitcnt vmcnt(9)
    v_mfma_f32_16x16x32_bf16 v[12:15], v[44:47], v[112:115], v[12:15]
    ds_read_b64_tr_b16 v[42:43], v127 offset:57856
    ds_read_b64_tr_b16 v[44:45], v124 offset:61440
    v_mfma_f32_16x16x32_bf16 v[16:19], v[48:51], v[112:115], v[16:19]
    buffer_load_dwordx4 v2, s[20:23], s84 offen offset:2048 lds
    ds_read_b64_tr_b16 v[46:47], v124 offset:61952
    v_mfma_f32_16x16x32_bf16 v[20:23], v[52:55], v[112:115], v[20:23]
    ds_read_b64_tr_b16 v[48:49], v125 offset:61440
    ds_read_b64_tr_b16 v[50:51], v125 offset:61952
    s_waitcnt lgkmcnt(7)
    v_mfma_f32_16x16x32_bf16 v[24:27], v[56:59], v[112:115], v[24:27]
    ds_read_b64_tr_b16 v[52:53], v126 offset:61440
    ds_read_b64_tr_b16 v[54:55], v126 offset:61952
    ds_read_b64_tr_b16 v[56:57], v127 offset:61440
    s_waitcnt vmcnt(9)
    v_mfma_f32_16x16x32_bf16 v[12:15], v[28:31], v[116:119], v[12:15]
    ds_read_b64_tr_b16 v[58:59], v127 offset:61952
    s_and_b32 s85, s85, 15
    v_mfma_f32_16x16x32_bf16 v[16:19], v[32:35], v[116:119], v[16:19]
    s_mul_i32 s85, s85, 98304
    s_add_u32 m0, s14, 33792
    s_waitcnt lgkmcnt(6)
    v_mfma_f32_16x16x32_bf16 v[20:23], v[36:39], v[116:119], v[20:23]
    buffer_load_dwordx4 v2, s[20:23], s85 offen offset:1024 lds
    s_add_u32 s84, s60, 12
    v_mfma_f32_16x16x32_bf16 v[24:27], v[40:43], v[116:119], v[24:27]
    s_and_b32 s84, s84, 15
    s_mul_i32 s84, s84, 98304
    v_and_b32 v92, 0xf0, v0
    s_waitcnt vmcnt(9)
    v_mfma_f32_16x16x32_bf16 v[12:15], v[44:47], v[120:123], v[12:15]
    v_bfe_u32 v96, v0, 8, 1
    v_lshl_add_u32 v92, v96, 9, v92
    s_waitcnt lgkmcnt(0)
    v_mfma_f32_16x16x32_bf16 v[16:19], v[48:51], v[120:123], v[16:19]
    v_lshrrev_b32 v96, 9, v0
    v_lshl_add_u32 v92, v96, 8, v92
    v_mfma_f32_16x16x32_bf16 v[20:23], v[52:55], v[120:123], v[20:23]
    buffer_load_dwordx4 v2, s[20:23], s85 offen offset:2048 lds
    s_add_u32 m0, s14, 41984
    v_mfma_f32_16x16x32_bf16 v[24:27], v[56:59], v[120:123], v[24:27]
    v_bfe_u32 v93, v0, 4, 4
    v_lshlrev_b32 v93, 2, v93
    v_lshl_add_u32 v93, v96, 6, v93
    v_cvt_pk_bf16_f32 v3, v14, v15
    v_cvt_pk_bf16_f32 v4, v16, v17
    v_cvt_pk_bf16_f32 v5, v18, v19
    v_cvt_pk_bf16_f32 v6, v20, v21
    v_cvt_pk_bf16_f32 v7, v22, v23
    v_cvt_pk_bf16_f32 v8, v24, v25
    v_cvt_pk_bf16_f32 v9, v26, v27
    v_permlane16_swap_b32 v3, v5
    v_permlane16_swap_b32 v6, v8
    buffer_load_dwordx4 v2, s[20:23], s84 offen offset:1024 lds
    v_permlane16_swap_b32 v7, v9
    v_mov_b32 v98, 2
    buffer_load_dwordx4 v2, s[20:23], s84 offen offset:2048 lds
    v_cvt_pk_bf16_f32 v2, v12, v13
    s_nop 1
    v_permlane16_swap_b32 v2, v4
    v_dot2_f32_bf16 v94, v2, s50, 0
    v_dot2_f32_bf16 v95, v2, v2, 0
    v_dot2_f32_bf16 v94, v3, s50, v94
    v_dot2_f32_bf16 v95, v3, v3, v95
    v_dot2_f32_bf16 v94, v4, s50, v94
    v_dot2_f32_bf16 v95, v4, v4, v95
    v_dot2_f32_bf16 v94, v5, s50, v94
    v_dot2_f32_bf16 v95, v5, v5, v95
    v_dot2_f32_bf16 v94, v6, s50, v94
    v_dot2_f32_bf16 v95, v6, v6, v95
    v_dot2_f32_bf16 v94, v7, s50, v94
    s_cmp_eq_u32 s48, 0
    s_cbranch_scc1 L10
    buffer_store_dwordx4 v[2:5], v92, s[36:39], s70 offen
    buffer_store_dwordx4 v[6:9], v92, s[36:39], s71 offen
L11:
    v_dot2_f32_bf16 v95, v7, v7, v95
    v_dot2_f32_bf16 v94, v8, s50, v94
    v_dot2_f32_bf16 v95, v8, v8, v95
    v_dot2_f32_bf16 v94, v9, s50, v94
    v_dot2_f32_bf16 v95, v9, v9, v95
    s_nop 2
    v_permlane32_swap_b32 v94, v95
    v_add_f32 v94, v94, v95
    v_mov_b32 v95, v94
    s_nop 1
    v_permlane16_swap_b32 v94, v95
    v_add_f32 v94, v94, v95
    s_cmp_eq_u32 s48, 0
    s_cbranch_scc1 L12
    buffer_store_dword v94, v93, s[36:39], s72 offen
L13:
    s_waitcnt vmcnt(0)
    s_cmp_eq_u32 s48, 0
    s_cbranch_scc1 L14
    buffer_store_dword v98, off, s[36:39], s74
L15:
    v_lshrrev_b32 v13, 2, v0
    v_and_b32 v13, 0x7c, v13
    v_bfe_u32 v15, v0, 4, 4
    v_lshlrev_b32 v15, 2, v15
    v_bfe_u32 v16, v0, 8, 1
    v_lshl_add_u32 v16, v16, 6, v15
    v_lshrrev_b32 v17, 9, v0
    v_lshl_add_u32 v16, v17, 9, v16
    v_lshrrev_b32 v18, 4, v0
    v_lshrrev_b32 v22, 3, v18
    s_lshl_b32 s80, s3, 3
    v_add_u32 v22, s80, v22
    v_mul_u32_u24 v22, 3072, v22
    v_bfe_u32 v19, v18, 4, 1
    s_and_b32 s81, s3, 1
    s_lshl_b32 s81, s81, 1
    v_or_b32 v19, s81, v19
    v_lshlrev_b32 v19, 1, v19
    v_and_b32 v18, 7, v18
    v_xor_b32 v18, v18, v19
    v_lshl_add_u32 v22, v18, 4, v22
    s_lshl_b32 s80, s4, 7
    v_add_u32 v22, s80, v22
    v_lshrrev_b32 v18, 4, v0
    v_lshrrev_b32 v21, 4, v18
    v_mul_u32_u24 v21, 2048, v21
    v_bfe_u32 v19, v18, 2, 2
    v_lshl_add_u32 v21, v19, 7, v21
    s_barrier
    v_and_b32 v19, 3, v18
    v_lshl_add_u32 v21, v19, 3, v21
    v_bfe_u32 v19, v18, 3, 2
    v_xor_b32 v19, s3, v19
    v_lshl_add_u32 v21, v19, 5, v21
    v_add_u32 v21, 1024, v21
    ds_read_b64_tr_b16 v[152:153], v21 offset:0
    ds_read_b64_tr_b16 v[154:155], v21 offset:512
    ds_read_b64_tr_b16 v[156:157], v21 offset:1024
    ds_read_b64_tr_b16 v[158:159], v21 offset:1536
    ds_read_b64_tr_b16 v[164:165], v21 offset:8192
    ds_read_b64_tr_b16 v[166:167], v21 offset:8704
    ds_read_b64_tr_b16 v[168:169], v21 offset:9216
    ds_read_b64_tr_b16 v[170:171], v21 offset:9728
    ds_read_b64_tr_b16 v[176:177], v21 offset:16384
    ds_read_b64_tr_b16 v[178:179], v21 offset:16896
    ds_read_b64_tr_b16 v[180:181], v21 offset:17408
    ds_read_b64_tr_b16 v[182:183], v21 offset:17920
    ds_read_b64_tr_b16 v[188:189], v21 offset:24576
    ds_read_b64_tr_b16 v[190:191], v21 offset:25088
    v_add_u32 v23, 64512, v21
    v_mov_b32 v24, s50
    v_mov_b32 v25, s50
    v_mov_b32 v26, s50
    v_mov_b32 v27, s50
    s_nop 1
    v_mfma_f32_16x16x32_bf16 v[120:123], a[196:199], v[24:27], 0
    v_mfma_f32_16x16x32_bf16 v[124:127], v[24:27], a[200:203], 0
    v_mfma_f32_16x16x32_bf16 v[120:123], a[208:211], v[24:27], v[120:123]
    ds_read_b64_tr_b16 v[192:193], v21 offset:25600
    ds_read_b64_tr_b16 v[194:195], v21 offset:26112
    v_mfma_f32_16x16x32_bf16 v[124:127], v[24:27], a[212:215], v[124:127]
    ds_read_b64_tr_b16 v[200:201], v21 offset:32768
    ds_read_b64_tr_b16 v[202:203], v21 offset:33280
    v_mfma_f32_16x16x32_bf16 v[120:123], a[220:223], v[24:27], v[120:123]
    ds_read_b64_tr_b16 v[204:205], v21 offset:33792
    ds_read_b64_tr_b16 v[206:207], v21 offset:34304
    v_mfma_f32_16x16x32_bf16 v[124:127], v[24:27], a[224:227], v[124:127]
    ds_read_b64_tr_b16 v[212:213], v21 offset:40960
    ds_read_b64_tr_b16 v[214:215], v21 offset:41472
    v_mfma_f32_16x16x32_bf16 v[120:123], a[232:235], v[24:27], v[120:123]
    ds_read_b64_tr_b16 v[216:217], v21 offset:41984
    ds_read_b64_tr_b16 v[218:219], v21 offset:42496
    v_mfma_f32_16x16x32_bf16 v[124:127], v[24:27], a[236:239], v[124:127]
    s_waitcnt lgkmcnt(0)
    s_barrier
L16:
    buffer_load_dword v21, v13, s[36:39], s75 offen sc1
    s_sub_u32 s49, s49, 1
    s_cbranch_scc1 L_end
    s_waitcnt vmcnt(0)
    v_cmp_gt_u32 vcc, 2, v21
    s_cbranch_vccnz L16
    v_mfma_f32_16x16x32_bf16 v[120:123], a[244:247], v[24:27], v[120:123]
    s_add_u32 m0, s78, 0
    s_add_u32 s85, s60, 13
    v_mfma_f32_16x16x32_bf16 v[124:127], v[24:27], a[248:251], v[124:127]
    buffer_load_dwordx4 v0, s[44:47], m0 offen sc1 lds
    s_add_u32 m0, s78, 2048
    v_mfma_f32_16x16x32_bf16 v[120:123], v[128:131], v[24:27], v[120:123]
    s_and_b32 s85, s85, 15
    s_mul_i32 s85, s85, 98304
    v_mfma_f32_16x16x32_bf16 v[124:127], v[24:27], v[132:135], v[124:127]
    buffer_load_dwordx4 v0, s[44:47], m0 offen sc1 lds
    s_add_u32 m0, s78, 8192
    v_mfma_f32_16x16x32_bf16 v[120:123], v[140:143], v[24:27], v[120:123]
    s_add_u32 s84, s60, 14
    s_and_b32 s84, s84, 15
    v_mfma_f32_16x16x32_bf16 v[124:127], v[24:27], v[144:147], v[124:127]
    buffer_load_dwordx4 v0, s[44:47], m0 offen sc1 lds
    s_add_u32 m0, s78, 10240
    v_mfma_f32_16x16x32_bf16 v[120:123], v[152:155], v[24:27], v[120:123]
    s_mul_i32 s84, s84, 98304
    s_mul_i32 s97, s7, 3072
    v_mfma_f32_16x16x32_bf16 v[124:127], v[24:27], v[156:159], v[124:127]
    s_add_u32 s97, s97, s77
    v_lshlrev_b32 v19, 3, v0
    v_mfma_f32_16x16x32_bf16 v[120:123], v[164:167], v[24:27], v[120:123]
    v_min_u32 v19, 2048, v19
    s_add_u32 s86, s60, 0
    v_mfma_f32_16x16x32_bf16 v[124:127], v[24:27], v[168:171], v[124:127]
    s_and_b32 s86, s86, 15
    buffer_load_dwordx4 v0, s[44:47], m0 offen sc1 lds
    v_mfma_f32_16x16x32_bf16 v[120:123], v[176:179], v[24:27], v[120:123]
    s_add_u32 m0, s78, 16384
    s_mul_i32 s86, s86, 98304
    v_mfma_f32_16x16x32_bf16 v[124:127], v[24:27], v[180:183], v[124:127]
    s_add_u32 s87, s60, 1
    s_and_b32 s87, s87, 15
    v_mfma_f32_16x16x32_bf16 v[120:123], v[188:191], v[24:27], v[120:123]
    s_mul_i32 s87, s87, 98304
    s_lshl_b32 s98, s3, 6
    v_mfma_f32_16x16x32_bf16 v[124:127], v[24:27], v[192:195], v[124:127]
    s_add_u32 s98, s98, 155648
    v_add_u32 v17, s98, v15
    v_mfma_f32_16x16x32_bf16 v[120:123], v[200:203], v[24:27], v[120:123]
    buffer_load_dwordx4 v0, s[44:47], m0 offen sc1 lds
    s_add_u32 m0, s78, 18432
    v_mfma_f32_16x16x32_bf16 v[124:127], v[24:27], v[204:207], v[124:127]
    s_mul_i32 s82, s3, 192
    s_add_u32 s82, s82, 157952
    v_mfma_f32_16x16x32_bf16 v[120:123], v[212:215], v[24:27], v[120:123]
    v_bfe_u32 v21, v0, 7, 1
    v_lshrrev_b32 v20, 4, v0
    v_mfma_f32_16x16x32_bf16 v[124:127], v[24:27], v[216:219], v[124:127]
    v_and_b32 v20, 48, v20
    v_lshl_add_u32 v20, v21, 6, v20
    buffer_load_dwordx4 v0, s[44:47], m0 offen sc1 lds
    s_add_u32 m0, s78, 24576
    buffer_load_dword v92, v16, s[36:39], s73 offen offset:0 sc1
    buffer_load_dword v93, v16, s[36:39], s73 offen offset:128 sc1
    buffer_load_dword v94, v16, s[36:39], s73 offen offset:256 sc1
    buffer_load_dword v95, v16, s[36:39], s73 offen offset:384 sc1
    buffer_load_dwordx4 v0, s[44:47], m0 offen sc1 lds
    s_add_u32 m0, s78, 26624
    s_nop 0
    buffer_load_dwordx4 v0, s[44:47], m0 offen sc1 lds
    s_add_u32 m0, s78, 32768
    s_waitcnt vmcnt(10)
    s_barrier
    ds_read_b128 v[28:31], v0 offset:0
    ds_read_b128 v[32:35], v0 offset:1024
    ds_read_b128 v[36:39], v0 offset:2048
    ds_read_b128 v[40:43], v0 offset:3072
    ds_read_b128 v[44:47], v0 offset:4096
    ds_read_b128 v[48:51], v0 offset:5120
    buffer_load_dwordx4 v0, s[44:47], m0 offen sc1 lds
    ds_read_b128 v[52:55], v0 offset:6144
    ds_read_b128 v[56:59], v0 offset:7168
    s_add_u32 m0, s78, 34816
    s_nop 0
    buffer_load_dwordx4 v0, s[44:47], m0 offen sc1 lds
    s_waitcnt vmcnt(10)
    s_barrier
    s_add_u32 m0, s78, 40960
    s_waitcnt lgkmcnt(7)
    v_mfma_f32_16x16x32_bf16 v[76:79], a[196:199], v[28:31], 0
    v_mfma_f32_16x16x32_bf16 v[96:99], v[28:31], a[200:203], 0
    ds_read_b128 v[28:31], v0 offset:8192
    s_waitcnt lgkmcnt(1)
    v_mfma_f32_16x16x32_bf16 v[80:83], a[196:199], v[32:35], 0
    buffer_load_dwordx4 v0, s[44:47], m0 offen sc1 lds
    s_add_u32 m0, s78, 43008
    v_mfma_f32_16x16x32_bf16 v[100:103], v[32:35], a[200:203], 0
    ds_read_b128 v[32:35], v0 offset:9216
    v_mfma_f32_16x16x32_bf16 v[84:87], a[196:199], v[36:39], 0
    v_mfma_f32_16x16x32_bf16 v[104:107], v[36:39], a[200:203], 0
    ds_read_b128 v[36:39], v0 offset:10240
    v_mfma_f32_16x16x32_bf16 v[88:91], a[196:199], v[40:43], 0
    buffer_load_dwordx4 v0, s[44:47], m0 offen sc1 lds
    v_mfma_f32_16x16x32_bf16 v[108:111], v[40:43], a[200:203], 0
    ds_read_b128 v[40:43], v0 offset:11264
    s_add_u32 m0, s78, 49152
    v_mfma_f32_16x16x32_bf16 v[76:79], a[208:211], v[44:47], v[76:79]
    v_mfma_f32_16x16x32_bf16 v[96:99], v[44:47], a[212:215], v[96:99]
    ds_read_b128 v[44:47], v0 offset:12288
    v_mfma_f32_16x16x32_bf16 v[80:83], a[208:211], v[48:51], v[80:83]
    v_mfma_f32_16x16x32_bf16 v[100:103], v[48:51], a[212:215], v[100:103]
    buffer_load_dwordx4 v0, s[44:47], m0 offen sc1 lds
    ds_read_b128 v[48:51], v0 offset:13312
    v_mfma_f32_16x16x32_bf16 v[84:87], a[208:211], v[52:55], v[84:87]
    s_add_u32 m0, s78, 51200
    v_mfma_f32_16x16x32_bf16 v[104:107], v[52:55], a[212:215], v[104:107]
    ds_read_b128 v[52:55], v0 offset:14336
    v_mfma_f32_16x16x32_bf16 v[88:91], a[208:211], v[56:59], v[88:91]
    v_mfma_f32_16x16x32_bf16 v[108:111], v[56:59], a[212:215], v[108:111]
    ds_read_b128 v[56:59], v0 offset:15360
    buffer_load_dwordx4 v0, s[44:47], m0 offen sc1 lds
    s_waitcnt lgkmcnt(4)
    v_mfma_f32_16x16x32_bf16 v[76:79], a[220:223], v[28:31], v[76:79]
    s_add_u32 m0, s78, 57344
    v_mfma_f32_16x16x32_bf16 v[96:99], v[28:31], a[224:227], v[96:99]
    s_waitcnt vmcnt(6)
    s_barrier
    v_mfma_f32_16x16x32_bf16 v[80:83], a[220:223], v[32:35], v[80:83]
    ds_read_b128 v[28:31], v0 offset:16384
    v_mfma_f32_16x16x32_bf16 v[100:103], v[32:35], a[224:227], v[100:103]
    ds_read_b128 v[32:35], v0 offset:17408
    buffer_load_dwordx4 v0, s[44:47], m0 offen sc1 lds
    v_mfma_f32_16x16x32_bf16 v[84:87], a[220:223], v[36:39], v[84:87]
    s_add_u32 m0, s78, 59392
    v_mfma_f32_16x16x32_bf16 v[104:107], v[36:39], a[224:227], v[104:107]
    ds_read_b128 v[36:39], v0 offset:18432
    v_mfma_f32_16x16x32_bf16 v[88:91], a[220:223], v[40:43], v[88:91]
    v_mfma_f32_16x16x32_bf16 v[108:111], v[40:43], a[224:227], v[108:111]
    ds_read_b128 v[40:43], v0 offset:19456
    s_waitcnt lgkmcnt(4)
    v_mfma_f32_16x16x32_bf16 v[76:79], a[232:235], v[44:47], v[76:79]
    buffer_load_dwordx4 v0, s[44:47], m0 offen sc1 lds
    s_add_u32 m0, s14, 65536
    v_mfma_f32_16x16x32_bf16 v[96:99], v[44:47], a[236:239], v[96:99]
    ds_read_b128 v[44:47], v0 offset:20480
    v_mfma_f32_16x16x32_bf16 v[80:83], a[232:235], v[48:51], v[80:83]
    v_add_f32 v92, v92, v93
    v_mfma_f32_16x16x32_bf16 v[100:103], v[48:51], a[236:239], v[100:103]
    ds_read_b128 v[48:51], v0 offset:21504
    v_add_f32 v94, v94, v95
    v_mfma_f32_16x16x32_bf16 v[84:87], a[232:235], v[52:55], v[84:87]
    v_add_f32 v92, v92, v94
    buffer_load_dwordx4 v22, s[20:23], s85 offen offset:1024 lds
    v_mfma_f32_16x16x32_bf16 v[104:107], v[52:55], a[236:239], v[104:107]
    ds_read_b128 v[52:55], v0 offset:22528
    v_mov_b32 v93, v92
    v_mfma_f32_16x16x32_bf16 v[88:91], a[232:235], v[56:59], v[88:91]
    s_nop 0
    v_permlane32_swap_b32 v92, v93
    v_mfma_f32_16x16x32_bf16 v[108:111], v[56:59], a[236:239], v[108:111]
    ds_read_b128 v[56:59], v0 offset:23552
    v_add_f32 v92, v92, v93
    s_waitcnt lgkmcnt(4)
    v_mfma_f32_16x16x32_bf16 v[76:79], a[244:247], v[28:31], v[76:79]
    v_mov_b32 v93, v92
    buffer_load_dwordx4 v22, s[20:23], s85 offen offset:2048 lds
    v_mfma_f32_16x16x32_bf16 v[96:99], v[28:31], a[248:251], v[96:99]
    ds_read_b128 v[28:31], v0 offset:24576
    s_add_u32 m0, s14, 73728
    v_mfma_f32_16x16x32_bf16 v[80:83], a[244:247], v[32:35], v[80:83]
    s_add_u32 s85, s60, 15
    s_and_b32 s85, s85, 15
    v_mfma_f32_16x16x32_bf16 v[100:103], v[32:35], a[248:251], v[100:103]
    ds_read_b128 v[32:35], v0 offset:25600
    s_mul_i32 s85, s85, 98304
    v_mfma_f32_16x16x32_bf16 v[84:87], a[244:247], v[36:39], v[84:87]
    v_permlane16_swap_b32 v92, v93
    v_mfma_f32_16x16x32_bf16 v[104:107], v[36:39], a[248:251], v[104:107]
    buffer_load_dwordx4 v22, s[20:23], s84 offen offset:1024 lds
    ds_read_b128 v[36:39], v0 offset:26624
    v_mfma_f32_16x16x32_bf16 v[88:91], a[244:247], v[40:43], v[88:91]
    v_mul_f32 v92, 0x3b000000, v92
    v_mul_f32 v93, 0x3b000000, v93
    v_mfma_f32_16x16x32_bf16 v[108:111], v[40:43], a[248:251], v[108:111]
    ds_read_b128 v[40:43], v0 offset:27648
    v_fma_f32 v93, -v92, v92, v93
    s_waitcnt lgkmcnt(4)
    v_mfma_f32_16x16x32_bf16 v[76:79], v[128:131], v[44:47], v[76:79]
    v_max_f32 v93, 0, v93
    v_add_f32 v93, 0x3727c5ac, v93
    v_mfma_f32_16x16x32_bf16 v[96:99], v[44:47], v[132:135], v[96:99]
    buffer_load_dwordx4 v22, s[20:23], s84 offen offset:2048 lds
    ds_read_b128 v[44:47], v0 offset:28672
    v_mfma_f32_16x16x32_bf16 v[80:83], v[128:131], v[48:51], v[80:83]
    s_add_u32 m0, s14, 81920
    v_rsq_f32 v93, v93
    v_mfma_f32_16x16x32_bf16 v[100:103], v[48:51], v[132:135], v[100:103]
    s_mov_b64 exec, 0xffff
    ds_write_b32 v17, v92
    ds_write_b32 v17, v93 offset:512
    s_mov_b64 exec, -1
    v_mfma_f32_16x16x32_bf16 v[84:87], v[128:131], v[52:55], v[84:87]
    ds_read_b128 v[48:51], v0 offset:29696
    v_mfma_f32_16x16x32_bf16 v[104:107], v[52:55], v[132:135], v[104:107]
    buffer_load_dwordx4 v22, s[20:23], s85 offen offset:1024 lds
    ds_read_b128 v[52:55], v0 offset:30720
    v_mfma_f32_16x16x32_bf16 v[88:91], v[128:131], v[56:59], v[88:91]
    v_mfma_f32_16x16x32_bf16 v[108:111], v[56:59], v[132:135], v[108:111]
    ds_read_b128 v[56:59], v0 offset:31744
    s_waitcnt lgkmcnt(6)
    v_mfma_f32_16x16x32_bf16 v[76:79], v[140:143], v[28:31], v[76:79]
    v_mfma_f32_16x16x32_bf16 v[96:99], v[28:31], v[144:147], v[96:99]
    buffer_load_dwordx4 v22, s[20:23], s85 offen offset:2048 lds
    s_mov_b32 m0, 158720
    v_mfma_f32_16x16x32_bf16 v[80:83], v[140:143], v[32:35], v[80:83]
    v_mfma_f32_16x16x32_bf16 v[100:103], v[32:35], v[144:147], v[100:103]
    s_waitcnt vmcnt(6)
    s_barrier
    v_mfma_f32_16x16x32_bf16 v[84:87], v[140:143], v[36:39], v[84:87]
    ds_read_b128 v[28:31], v0 offset:32768
    ds_read_b128 v[32:35], v0 offset:33792
    v_mfma_f32_16x16x32_bf16 v[104:107], v[36:39], v[144:147], v[104:107]
    ds_read_b128 v[36:39], v0 offset:34816
    buffer_load_dword v19, s[36:39], s97 offen lds
    v_mfma_f32_16x16x32_bf16 v[88:91], v[140:143], v[40:43], v[88:91]
    s_add_u32 m0, s62, 90112
    v_mfma_f32_16x16x32_bf16 v[108:111], v[40:43], v[144:147], v[108:111]
    ds_read_b128 v[40:43], v0 offset:35840
    s_waitcnt lgkmcnt(4)
    v_mfma_f32_16x16x32_bf16 v[76:79], v[152:155], v[44:47], v[76:79]
    buffer_load_dwordx4 v22, s[20:23], s86 offen lds
    s_add_u32 m0, s62, 94208
    v_mfma_f32_16x16x32_bf16 v[96:99], v[44:47], v[156:159], v[96:99]
    ds_read_b128 v[44:47], v0 offset:36864
    s_add_u32 s86, s60, 2
    v_mfma_f32_16x16x32_bf16 v[80:83], v[152:155], v[48:51], v[80:83]
    s_and_b32 s86, s86, 15
    s_mul_i32 s86, s86, 98304
    v_mfma_f32_16x16x32_bf16 v[100:103], v[48:51], v[156:159], v[100:103]
    ds_read_b128 v[48:51], v0 offset:37888
    v_mfma_f32_16x16x32_bf16 v[84:87], v[152:155], v[52:55], v[84:87]
    buffer_load_dwordx4 v22, s[20:23], s87 offen lds
    v_mfma_f32_16x16x32_bf16 v[104:107], v[52:55], v[156:159], v[104:107]
    ds_read_b128 v[52:55], v0 offset:38912
    s_add_u32 m0, s62, 98304
    v_mfma_f32_16x16x32_bf16 v[88:91], v[152:155], v[56:59], v[88:91]
    s_add_u32 s87, s60, 3
    s_and_b32 s87, s87, 15
    v_mfma_f32_16x16x32_bf16 v[108:111], v[56:59], v[156:159], v[108:111]
    ds_read_b128 v[56:59], v0 offset:39936
    s_barrier
    s_waitcnt lgkmcnt(4)
    v_mfma_f32_16x16x32_bf16 v[76:79], v[164:167], v[28:31], v[76:79]
    s_mul_i32 s87, s87, 98304
    buffer_load_dwordx4 v22, s[20:23], s86 offen lds
    v_mfma_f32_16x16x32_bf16 v[96:99], v[28:31], v[168:171], v[96:99]
    ds_read_b128 v[28:31], v0 offset:40960
    s_add_u32 m0, s62, 102400
    v_mfma_f32_16x16x32_bf16 v[80:83], v[164:167], v[32:35], v[80:83]
    s_add_u32 s86, s60, 4
    s_and_b32 s86, s86, 15
    v_mfma_f32_16x16x32_bf16 v[100:103], v[32:35], v[168:171], v[100:103]
    ds_read_b128 v[32:35], v0 offset:41984
    s_mul_i32 s86, s86, 98304
    v_mfma_f32_16x16x32_bf16 v[84:87], v[164:167], v[36:39], v[84:87]
    v_mfma_f32_16x16x32_bf16 v[104:107], v[36:39], v[168:171], v[104:107]
    buffer_load_dwordx4 v22, s[20:23], s87 offen lds
    ds_read_b128 v[36:39], v0 offset:43008
    v_mfma_f32_16x16x32_bf16 v[88:91], v[164:167], v[40:43], v[88:91]
    s_add_u32 m0, s62, 106496
    s_add_u32 s87, s60, 5
    v_mfma_f32_16x16x32_bf16 v[108:111], v[40:43], v[168:171], v[108:111]
    ds_read_b128 v[40:43], v0 offset:44032
    s_and_b32 s87, s87, 15
    s_waitcnt lgkmcnt(4)
    v_mfma_f32_16x16x32_bf16 v[76:79], v[176:179], v[44:47], v[76:79]
    s_mul_i32 s87, s87, 98304
    v_mfma_f32_16x16x32_bf16 v[96:99], v[44:47], v[180:183], v[96:99]
    buffer_load_dwordx4 v22, s[20:23], s86 offen lds
    ds_read_b128 v[44:47], v0 offset:45056
    v_mfma_f32_16x16x32_bf16 v[80:83], v[176:179], v[48:51], v[80:83]
    s_add_u32 m0, s62, 110592
    s_add_u32 s86, s60, 6
    v_mfma_f32_16x16x32_bf16 v[100:103], v[48:51], v[180:183], v[100:103]
    ds_read_b128 v[48:51], v0 offset:46080
    s_and_b32 s86, s86, 15
    v_mfma_f32_16x16x32_bf16 v[84:87], v[176:179], v[52:55], v[84:87]
    s_mul_i32 s86, s86, 98304
    v_mfma_f32_16x16x32_bf16 v[104:107], v[52:55], v[180:183], v[104:107]
    ds_read_b128 v[52:55], v0 offset:47104
    buffer_load_dwordx4 v22, s[20:23], s87 offen lds
    v_mfma_f32_16x16x32_bf16 v[88:91], v[176:179], v[56:59], v[88:91]
    s_add_u32 m0, s62, 114688
    s_add_u32 s87, s60, 7
    v_mfma_f32_16x16x32_bf16 v[108:111], v[56:59], v[180:183], v[108:111]
    ds_read_b128 v[56:59], v0 offset:48128
    s_and_b32 s87, s87, 15
    s_waitcnt lgkmcnt(4)
    v_mfma_f32_16x16x32_bf16 v[76:79], v[188:191], v[28:31], v[76:79]
    s_mul_i32 s87, s87, 98304
    v_mfma_f32_16x16x32_bf16 v[96:99], v[28:31], v[192:195], v[96:99]
    buffer_load_dwordx4 v22, s[20:23], s86 offen lds
    v_mfma_f32_16x16x32_bf16 v[80:83], v[188:191], v[32:35], v[80:83]
    s_add_u32 m0, s62, 118784
    s_add_u32 s86, s60, 8
    v_mfma_f32_16x16x32_bf16 v[100:103], v[32:35], v[192:195], v[100:103]
    s_and_b32 s86, s86, 15
    s_mul_i32 s86, s86, 98304
    v_mfma_f32_16x16x32_bf16 v[84:87], v[188:191], v[36:39], v[84:87]
    v_mfma_f32_16x16x32_bf16 v[104:107], v[36:39], v[192:195], v[104:107]
    v_mfma_f32_16x16x32_bf16 v[88:91], v[188:191], v[40:43], v[88:91]
    buffer_load_dwordx4 v22, s[20:23], s87 offen lds
    s_add_u32 m0, s62, 122880
    v_mfma_f32_16x16x32_bf16 v[108:111], v[40:43], v[192:195], v[108:111]
    s_add_u32 s87, s60, 9
    s_and_b32 s87, s87, 15
    s_waitcnt lgkmcnt(0)
    v_mfma_f32_16x16x32_bf16 v[76:79], v[200:203], v[44:47], v[76:79]
    s_mul_i32 s87, s87, 98304
    v_mfma_f32_16x16x32_bf16 v[96:99], v[44:47], v[204:207], v[96:99]
    v_mfma_f32_16x16x32_bf16 v[80:83], v[200:203], v[48:51], v[80:83]
    buffer_load_dwordx4 v22, s[20:23], s86 offen lds
    s_add_u32 m0, s62, 126976
    v_mfma_f32_16x16x32_bf16 v[100:103], v[48:51], v[204:207], v[100:103]
    s_add_u32 s86, s60, 10
    s_and_b32 s86, s86, 15
    v_mfma_f32_16x16x32_bf16 v[84:87], v[200:203], v[52:55], v[84:87]
    s_waitcnt vmcnt(10)
    s_barrier
    v_mfma_f32_16x16x32_bf16 v[104:107], v[52:55], v[204:207], v[104:107]
    ds_read_b64_tr_b16 v[224:225], v23 offset:0
    ds_read_b64_tr_b16 v[226:227], v23 offset:512
    v_mfma_f32_16x16x32_bf16 v[88:91], v[200:203], v[56:59], v[88:91]
    ds_read_b64_tr_b16 v[228:229], v23 offset:1024
    buffer_load_dwordx4 v22, s[20:23], s87 offen lds
    v_mfma_f32_16x16x32_bf16 v[108:111], v[56:59], v[204:207], v[108:111]
    ds_read_b64_tr_b16 v[230:231], v23 offset:1536
    ds_read_b64_tr_b16 v[236:237], v23 offset:8192
    ds_read_b64_tr_b16 v[238:239], v23 offset:8704
    ds_read_b64_tr_b16 v[240:241], v23 offset:9216
    ds_read_b64_tr_b16 v[242:243], v23 offset:9728
    ds_read_b64_tr_b16 v[248:249], v23 offset:16384
    ds_read_b64_tr_b16 v[250:251], v23 offset:16896
    ds_read_b64_tr_b16 v[252:253], v23 offset:17408
    ds_read_b64_tr_b16 v[254:255], v23 offset:17920
    ds_read_b128 v[28:31], v0 offset:49152
    ds_read_b128 v[32:35], v0 offset:50176
    s_mul_i32 s86, s86, 98304
    s_add_u32 m0, s62, 131072
    s_add_u32 s87, s60, 11
    buffer_load_dwordx4 v22, s[20:23], s86 offen lds
    s_and_b32 s87, s87, 15
    s_mul_i32 s87, s87, 98304
    s_add_u32 m0, s62, 135168
    s_add_u32 s86, s60, 12
    s_and_b32 s86, s86, 15
    s_mul_i32 s86, s86, 98304
    v_lshrrev_b32 v23, 4, v0
    ds_read_b128 v[36:39], v0 offset:51200
    s_waitcnt lgkmcnt(13)
    v_mfma_f32_16x16x32_bf16 v[120:123], v[224:227], v[24:27], v[120:123]
    ds_read_b128 v[40:43], v0 offset:52224
    ds_read_b128 v[44:47], v0 offset:53248
    s_waitcnt lgkmcnt(13)
    v_mfma_f32_16x16x32_bf16 v[124:127], v[24:27], v[228:231], v[124:127]
    buffer_load_dwordx4 v22, s[20:23], s87 offen lds
    ds_read_b128 v[48:51], v0 offset:54272
    s_waitcnt lgkmcnt(9)
    v_mfma_f32_16x16x32_bf16 v[120:123], v[236:239], v[24:27], v[120:123]
    ds_read_b128 v[52:55], v0 offset:55296
    ds_read_b128 v[56:59], v0 offset:56320
    s_waitcnt lgkmcnt(6)
    v_mfma_f32_16x16x32_bf16 v[76:79], v[212:215], v[28:31], v[76:79]
    s_add_u32 m0, s62, 139264
    s_add_u32 s87, s60, 13
    v_mfma_f32_16x16x32_bf16 v[96:99], v[28:31], v[216:219], v[96:99]
    ds_read_b128 v[28:31], v0 offset:57344
    s_and_b32 s87, s87, 15
    v_mfma_f32_16x16x32_bf16 v[80:83], v[212:215], v[32:35], v[80:83]
    buffer_load_dwordx4 v22, s[20:23], s86 offen lds
    s_mul_i32 s87, s87, 98304
    v_mfma_f32_16x16x32_bf16 v[100:103], v[32:35], v[216:219], v[100:103]
    ds_read_b128 v[32:35], v0 offset:58368
    s_add_u32 m0, s62, 143360
    s_waitcnt lgkmcnt(5)
    v_mfma_f32_16x16x32_bf16 v[84:87], v[212:215], v[36:39], v[84:87]
    s_add_u32 s86, s60, 14
    s_and_b32 s86, s86, 15
    v_mfma_f32_16x16x32_bf16 v[104:107], v[36:39], v[216:219], v[104:107]
    ds_read_b128 v[36:39], v0 offset:59392
    s_mul_i32 s86, s86, 98304
    v_mfma_f32_16x16x32_bf16 v[88:91], v[212:215], v[40:43], v[88:91]
    buffer_load_dwordx4 v22, s[20:23], s87 offen lds
    s_add_u32 m0, s62, 147456
    v_mfma_f32_16x16x32_bf16 v[108:111], v[40:43], v[216:219], v[108:111]
    ds_read_b128 v[40:43], v0 offset:60416
    s_add_u32 s87, s60, 15
    v_mfma_f32_16x16x32_bf16 v[76:79], v[224:227], v[44:47], v[76:79]
    s_and_b32 s87, s87, 15
    s_mul_i32 s87, s87, 98304
    v_mfma_f32_16x16x32_bf16 v[96:99], v[44:47], v[228:231], v[96:99]
    ds_read_b128 v[44:47], v0 offset:61440
    s_waitcnt lgkmcnt(4)
    v_mfma_f32_16x16x32_bf16 v[80:83], v[224:227], v[48:51], v[80:83]
    buffer_load_dwordx4 v22, s[20:23], s86 offen lds
    s_add_u32 m0, s62, 151552
    v_mfma_f32_16x16x32_bf16 v[100:103], v[48:51], v[228:231], v[100:103]
    ds_read_b128 v[48:51], v0 offset:62464
    v_mfma_f32_16x16x32_bf16 v[84:87], v[224:227], v[52:55], v[84:87]
    v_mfma_f32_16x16x32_bf16 v[104:107], v[52:55], v[228:231], v[104:107]
    ds_read_b128 v[52:55], v0 offset:63488
    v_mfma_f32_16x16x32_bf16 v[88:91], v[224:227], v[56:59], v[88:91]
    buffer_load_dwordx4 v22, s[20:23], s87 offen lds
    v_mfma_f32_16x16x32_bf16 v[108:111], v[56:59], v[228:231], v[108:111]
    ds_read_b128 v[56:59], v0 offset:64512
    v_and_b32 v22, 15, v23
    v_mfma_f32_16x16x32_bf16 v[124:127], v[24:27], v[240:243], v[124:127]
    v_lshlrev_b32 v22, 2, v22
    v_add_u32 v22, 155648, v22
    v_mfma_f32_16x16x32_bf16 v[76:79], v[236:239], v[28:31], v[76:79]
    ds_read2_b32 v[12:13], v22 offset0:0 offset1:128
    ds_read2_b32 v[14:15], v22 offset0:16 offset1:144
    v_mfma_f32_16x16x32_bf16 v[96:99], v[28:31], v[240:243], v[96:99]
    ds_read2_b32 v[16:17], v22 offset0:32 offset1:160
    ds_read2_b32 v[18:19], v22 offset0:48 offset1:176
    s_waitcnt lgkmcnt(6)
    v_mfma_f32_16x16x32_bf16 v[80:83], v[236:239], v[32:35], v[80:83]
    v_and_b32 v23, 48, v23
    v_add_u32 v23, 155648, v23
    v_mfma_f32_16x16x32_bf16 v[100:103], v[32:35], v[240:243], v[100:103]
    v_mfma_f32_16x16x32_bf16 v[84:87], v[236:239], v[36:39], v[84:87]
    v_mfma_f32_16x16x32_bf16 v[104:107], v[36:39], v[240:243], v[104:107]
    ds_read_b128 v[36:39], v23 offset:0
    v_mfma_f32_16x16x32_bf16 v[88:91], v[236:239], v[40:43], v[88:91]
    v_mfma_f32_16x16x32_bf16 v[108:111], v[40:43], v[240:243], v[108:111]
    ds_read_b128 v[40:43], v23 offset:512
    v_mfma_f32_16x16x32_bf16 v[120:123], v[248:251], v[24:27], v[120:123]
    v_mfma_f32_16x16x32_bf16 v[124:127], v[24:27], v[252:255], v[124:127]
    v_mfma_f32_16x16x32_bf16 v[76:79], v[248:251], v[44:47], v[76:79]
    v_mfma_f32_16x16x32_bf16 v[96:99], v[44:47], v[252:255], v[96:99]
    ds_read_b128 v[44:47], v23 offset:64
    v_mfma_f32_16x16x32_bf16 v[80:83], v[248:251], v[48:51], v[80:83]
    v_mfma_f32_16x16x32_bf16 v[100:103], v[48:51], v[252:255], v[100:103]
    ds_read_b128 v[48:51], v23 offset:576
    s_waitcnt lgkmcnt(3)
    v_mfma_f32_16x16x32_bf16 v[84:87], v[248:251], v[52:55], v[84:87]
    v_mfma_f32_16x16x32_bf16 v[104:107], v[52:55], v[252:255], v[104:107]
    v_mov_b32 v53, s50
    v_mfma_f32_16x16x32_bf16 v[88:91], v[248:251], v[56:59], v[88:91]
    v_mfma_f32_16x16x32_bf16 v[108:111], v[56:59], v[252:255], v[108:111]
    v_lshrrev_b32 v58, 4, v0
    v_and_b32 v56, 48, v58
    v_add_u32 v56, s82, v56
    ds_write_b128 v56, v[120:123] offset:64
    v_and_b32 v57, 15, v58
    v_lshl_add_u32 v57, v57, 2, s82
    ds_write_b32 v57, v124 offset:128
    v_pk_fma_f32 v[76:77], v[120:121], v[12:13], v[76:77] op_sel_hi:[1,0,1] neg_lo:[0,1,0] neg_hi:[0,1,0]
    v_pk_fma_f32 v[78:79], v[122:123], v[12:13], v[78:79] op_sel_hi:[1,0,1] neg_lo:[0,1,0] neg_hi:[0,1,0]
    v_pk_mul_f32 v[76:77], v[76:77], v[12:13] op_sel:[0,1] op_sel_hi:[1,1]
    v_pk_mul_f32 v[78:79], v[78:79], v[12:13] op_sel:[0,1] op_sel_hi:[1,1]
    v_cvt_pk_bf16_f32 v76, v76, v77
    v_cvt_pk_bf16_f32 v77, v78, v79
    v_pk_fma_f32 v[80:81], v[120:121], v[14:15], v[80:81] op_sel_hi:[1,0,1] neg_lo:[0,1,0] neg_hi:[0,1,0]
    v_pk_fma_f32 v[82:83], v[122:123], v[14:15], v[82:83] op_sel_hi:[1,0,1] neg_lo:[0,1,0] neg_hi:[0,1,0]
    v_mfma_f32_16x16x16_bf16 v[60:63], v[10:11], v[76:77], 0
    v_lshrrev_b32 v58, 4, v0
    v_and_b32 v59, 3, v58
    v_pk_mul_f32 v[80:81], v[80:81], v[14:15] op_sel:[0,1] op_sel_hi:[1,1]
    v_pk_mul_f32 v[82:83], v[82:83], v[14:15] op_sel:[0,1] op_sel_hi:[1,1]
    v_cvt_pk_bf16_f32 v80, v80, v81
    v_cvt_pk_bf16_f32 v81, v82, v83
    v_pk_fma_f32 v[84:85], v[120:121], v[16:17], v[84:85] op_sel_hi:[1,0,1] neg_lo:[0,1,0] neg_hi:[0,1,0]
    v_pk_fma_f32 v[86:87], v[122:123], v[16:17], v[86:87] op_sel_hi:[1,0,1] neg_lo:[0,1,0] neg_hi:[0,1,0]
    v_mfma_f32_16x16x16_bf16 v[64:67], v[10:11], v[80:81], 0
    v_cmp_eq_u32 vcc, 0, v59
    v_mov_b32 v56, 0x3f80
    v_pk_mul_f32 v[84:85], v[84:85], v[16:17] op_sel:[0,1] op_sel_hi:[1,1]
    v_pk_mul_f32 v[86:87], v[86:87], v[16:17] op_sel:[0,1] op_sel_hi:[1,1]
    v_cvt_pk_bf16_f32 v84, v84, v85
    v_cvt_pk_bf16_f32 v85, v86, v87
    v_pk_fma_f32 v[88:89], v[120:121], v[18:19], v[88:89] op_sel_hi:[1,0,1] neg_lo:[0,1,0] neg_hi:[0,1,0]
    v_pk_fma_f32 v[90:91], v[122:123], v[18:19], v[90:91] op_sel_hi:[1,0,1] neg_lo:[0,1,0] neg_hi:[0,1,0]
    v_mfma_f32_16x16x16_bf16 v[68:71], v[10:11], v[84:85], 0
    v_cndmask_b32 v52, 0, v53, vcc
    v_cmp_eq_u32 vcc, 1, v59
    v_pk_mul_f32 v[88:89], v[88:89], v[18:19] op_sel:[0,1] op_sel_hi:[1,1]
    v_pk_mul_f32 v[90:91], v[90:91], v[18:19] op_sel:[0,1] op_sel_hi:[1,1]
    v_cvt_pk_bf16_f32 v88, v88, v89
    v_cvt_pk_bf16_f32 v89, v90, v91
    v_pk_fma_f32 v[96:97], v[36:37], v[124:125], v[96:97] op_sel_hi:[1,0,1] neg_lo:[0,1,0] neg_hi:[0,1,0]
    v_pk_fma_f32 v[98:99], v[38:39], v[124:125], v[98:99] op_sel_hi:[1,0,1] neg_lo:[0,1,0] neg_hi:[0,1,0]
    v_mfma_f32_16x16x16_bf16 v[72:75], v[10:11], v[88:89], 0
    ds_read_b128 v[36:39], v23 offset:128
    v_cndmask_b32 v54, 0, v53, vcc
    s_waitcnt lgkmcnt(3)
    v_pk_mul_f32 v[96:97], v[96:97], v[40:41]
    v_pk_mul_f32 v[98:99], v[98:99], v[42:43]
    ds_read_b128 v[40:43], v23 offset:640
    v_cvt_pk_bf16_f32 v28, v96, v97
    v_cvt_pk_bf16_f32 v29, v98, v99
    v_pk_fma_f32 v[100:101], v[44:45], v[124:125], v[100:101] op_sel_hi:[1,0,1] neg_lo:[0,1,0] neg_hi:[0,1,0]
    v_pk_fma_f32 v[102:103], v[46:47], v[124:125], v[102:103] op_sel_hi:[1,0,1] neg_lo:[0,1,0] neg_hi:[0,1,0]
    ds_read_b128 v[44:47], v23 offset:192
    v_pk_mul_f32 v[100:101], v[100:101], v[48:49]
    v_pk_mul_f32 v[102:103], v[102:103], v[50:51]
    ds_read_b128 v[48:51], v23 offset:704
    v_cvt_pk_bf16_f32 v30, v100, v101
    v_cvt_pk_bf16_f32 v31, v102, v103
    v_mov_b32 v53, v52
    v_mov_b32 v55, v54
    v_and_b32 v59, 1, v58
    v_lshlrev_b32 v59, 4, v59
    v_lshlrev_b32 v59, v59, v56
    v_bfe_u32 v58, v58, 1, 1
    v_cndmask_b32 v59, 0, v59, s[56:57]
    v_cmp_eq_u32 vcc, 0, v58
    v_max3_f32 v12, v60, v61, v62
    v_max3_f32 v16, -v60, -v61, -v62
    v_cndmask_b32 v56, 0, v59, vcc
    v_cndmask_b32 v57, v59, 0, vcc
    v_max_f32 v12, v12, v63
    v_max_f32_e64 v16, v16, -v63
    s_waitcnt lgkmcnt(3)
    v_pk_fma_f32 v[104:105], v[36:37], v[124:125], v[104:105] op_sel_hi:[1,0,1] neg_lo:[0,1,0] neg_hi:[0,1,0]
    v_pk_fma_f32 v[106:107], v[38:39], v[124:125], v[106:107] op_sel_hi:[1,0,1] neg_lo:[0,1,0] neg_hi:[0,1,0]
    v_max3_f32 v13, v64, v65, v66
    v_max3_f32 v17, -v64, -v65, -v66
    s_waitcnt lgkmcnt(2)
    v_pk_mul_f32 v[104:105], v[104:105], v[40:41]
    v_pk_mul_f32 v[106:107], v[106:107], v[42:43]
    v_cvt_pk_bf16_f32 v32, v104, v105
    v_cvt_pk_bf16_f32 v33, v106, v107
    s_waitcnt lgkmcnt(1)
    v_pk_fma_f32 v[108:109], v[44:45], v[124:125], v[108:109] op_sel_hi:[1,0,1] neg_lo:[0,1,0] neg_hi:[0,1,0]
    v_pk_fma_f32 v[110:111], v[46:47], v[124:125], v[110:111] op_sel_hi:[1,0,1] neg_lo:[0,1,0] neg_hi:[0,1,0]
    s_waitcnt lgkmcnt(0)
    v_pk_mul_f32 v[108:109], v[108:109], v[48:49]
    v_pk_mul_f32 v[110:111], v[110:111], v[50:51]
    v_cvt_pk_bf16_f32 v34, v108, v109
    v_cvt_pk_bf16_f32 v35, v110, v111
    v_max_f32 v13, v13, v67
    v_max_f32_e64 v17, v17, -v67
    v_max3_f32 v14, v68, v69, v70
    v_max3_f32 v18, -v68, -v69, -v70
    v_max_f32 v14, v14, v71
    v_max_f32_e64 v18, v18, -v71
    v_max3_f32 v15, v72, v73, v74
    v_max3_f32 v19, -v72, -v73, -v74
    v_max_f32 v15, v15, v75
    v_max_f32_e64 v19, v19, -v75
    v_permlane32_swap_b32 v12, v13
    v_permlane32_swap_b32 v14, v15
    v_max_f32 v12, v12, v13
    v_max_f32 v14, v14, v15
    v_permlane32_swap_b32 v16, v17
    s_nop 0
    v_permlane16_swap_b32 v12, v14
    v_max_f32 v12, v12, v14
    v_mul_f32 v12, s52, v12
    v_mov_b32 v14, v12
    v_permlane32_swap_b32 v18, v19
    s_nop 0
    v_permlane16_swap_b32 v12, v14
    v_mov_b32 v13, v12
    v_mov_b32 v15, v14
    v_max_f32 v16, v16, v17
    v_permlane32_swap_b32 v12, v13
    v_permlane32_swap_b32 v14, v15
    v_max_f32 v18, v18, v19
    v_pk_fma_f32 v[76:77], v[60:61], s[52:53], v[12:13] op_sel:[0,0,0] op_sel_hi:[1,1,0] neg_lo:[0,0,1] neg_hi:[0,0,1]
    v_pk_fma_f32 v[78:79], v[62:63], s[52:53], v[12:13] op_sel:[0,0,0] op_sel_hi:[1,1,0] neg_lo:[0,0,1] neg_hi:[0,0,1]
    v_permlane16_swap_b32 v16, v18
    v_max_f32 v16, v16, v18
    v_mul_f32 v16, s52, v16
    v_mov_b32 v18, v16
    v_exp_f32 v76, v76
    s_nop 0
    v_permlane16_swap_b32 v16, v18
    v_mov_b32 v17, v16
    v_mov_b32 v19, v18
    v_exp_f32 v77, v77
    v_permlane32_swap_b32 v16, v17
    v_permlane32_swap_b32 v18, v19
    v_pk_fma_f32 v[80:81], v[60:61], s[52:53], v[16:17] op_sel:[0,0,0] op_sel_hi:[1,1,0] neg_lo:[0,1,1] neg_hi:[0,1,1]
    v_pk_fma_f32 v[82:83], v[62:63], s[52:53], v[16:17] op_sel:[0,0,0] op_sel_hi:[1,1,0] neg_lo:[0,1,1] neg_hi:[0,1,1]
    v_exp_f32 v78, v78
    v_exp_f32 v79, v79
    v_exp_f32 v80, v80
    v_exp_f32 v81, v81
    v_exp_f32 v82, v82
    v_exp_f32 v83, v83
    v_cvt_pk_bf16_f32 v36, v76, v77
    v_cvt_pk_bf16_f32 v37, v78, v79
    v_cvt_pk_bf16_f32 v38, v80, v81
    v_cvt_pk_bf16_f32 v39, v82, v83
    v_pk_fma_f32 v[84:85], v[64:65], s[52:53], v[12:13] op_sel:[0,0,1] op_sel_hi:[1,1,1] neg_lo:[0,0,1] neg_hi:[0,0,1]
    v_pk_fma_f32 v[88:89], v[64:65], s[52:53], v[16:17] op_sel:[0,0,1] op_sel_hi:[1,1,1] neg_lo:[0,1,1] neg_hi:[0,1,1]
    v_pk_fma_f32 v[86:87], v[66:67], s[52:53], v[12:13] op_sel:[0,0,1] op_sel_hi:[1,1,1] neg_lo:[0,0,1] neg_hi:[0,0,1]
    v_pk_fma_f32 v[90:91], v[66:67], s[52:53], v[16:17] op_sel:[0,0,1] op_sel_hi:[1,1,1] neg_lo:[0,1,1] neg_hi:[0,1,1]
    v_exp_f32 v84, v84
    v_mfma_f32_16x16x32_bf16 v[60:63], v[52:55], v[36:39], 0
    v_exp_f32 v85, v85
    v_exp_f32 v86, v86
    v_exp_f32 v87, v87
    v_exp_f32 v88, v88
    v_exp_f32 v89, v89
    v_exp_f32 v90, v90
    v_exp_f32 v91, v91
    v_cvt_pk_bf16_f32 v40, v84, v85
    v_cvt_pk_bf16_f32 v41, v86, v87
    v_cvt_pk_bf16_f32 v42, v88, v89
    v_cvt_pk_bf16_f32 v43, v90, v91
    v_pk_fma_f32 v[92:93], v[68:69], s[52:53], v[14:15] op_sel:[0,0,0] op_sel_hi:[1,1,0] neg_lo:[0,0,1] neg_hi:[0,0,1]
    v_pk_fma_f32 v[96:97], v[68:69], s[52:53], v[18:19] op_sel:[0,0,0] op_sel_hi:[1,1,0] neg_lo:[0,1,1] neg_hi:[0,1,1]
    v_mfma_f32_16x16x32_bf16 v[64:67], v[52:55], v[40:43], 0
    v_exp_f32 v92, v92
    v_pk_fma_f32 v[94:95], v[70:71], s[52:53], v[14:15] op_sel:[0,0,0] op_sel_hi:[1,1,0] neg_lo:[0,0,1] neg_hi:[0,0,1]
    v_pk_fma_f32 v[98:99], v[70:71], s[52:53], v[18:19] op_sel:[0,0,0] op_sel_hi:[1,1,0] neg_lo:[0,1,1] neg_hi:[0,1,1]
    v_exp_f32 v93, v93
    v_exp_f32 v94, v94
    v_exp_f32 v95, v95
    v_exp_f32 v96, v96
    v_exp_f32 v97, v97
    v_exp_f32 v98, v98
    v_exp_f32 v99, v99
    v_cvt_pk_bf16_f32 v44, v92, v93
    v_cvt_pk_bf16_f32 v45, v94, v95
    v_cvt_pk_bf16_f32 v46, v96, v97
    v_cvt_pk_bf16_f32 v47, v98, v99
    v_pk_fma_f32 v[100:101], v[72:73], s[52:53], v[14:15] op_sel:[0,0,1] op_sel_hi:[1,1,1] neg_lo:[0,0,1] neg_hi:[0,0,1]
    v_pk_fma_f32 v[104:105], v[72:73], s[52:53], v[18:19] op_sel:[0,0,1] op_sel_hi:[1,1,1] neg_lo:[0,1,1] neg_hi:[0,1,1]
    v_pk_fma_f32 v[102:103], v[74:75], s[52:53], v[14:15] op_sel:[0,0,1] op_sel_hi:[1,1,1] neg_lo:[0,0,1] neg_hi:[0,0,1]
    v_pk_fma_f32 v[106:107], v[74:75], s[52:53], v[18:19] op_sel:[0,0,1] op_sel_hi:[1,1,1] neg_lo:[0,1,1] neg_hi:[0,1,1]
    v_exp_f32 v100, v100
    v_mfma_f32_16x16x32_bf16 v[68:71], v[52:55], v[44:47], 0
    v_exp_f32 v101, v101
    v_exp_f32 v102, v102
    v_exp_f32 v103, v103
    v_exp_f32 v104, v104
    v_exp_f32 v105, v105
    v_exp_f32 v106, v106
    v_exp_f32 v107, v107
    v_cvt_pk_bf16_f32 v48, v100, v101
    v_cvt_pk_bf16_f32 v49, v102, v103
    v_cvt_pk_bf16_f32 v50, v104, v105
    v_cvt_pk_bf16_f32 v51, v106, v107
    v_rcp_f32 v60, v60
    s_nop 0
    v_mfma_f32_16x16x32_bf16 v[72:75], v[52:55], v[48:51], 0
    v_rcp_f32 v61, v61
    v_rcp_f32 v64, v64
    v_pk_mul_f32 v[76:77], v[76:77], v[60:61] op_sel_hi:[1,0]
    v_pk_mul_f32 v[78:79], v[78:79], v[60:61] op_sel_hi:[1,0]
    v_pk_mul_f32 v[80:81], v[80:81], v[60:61] op_sel:[0,1] op_sel_hi:[1,1]
    v_pk_mul_f32 v[82:83], v[82:83], v[60:61] op_sel:[0,1] op_sel_hi:[1,1]
    v_cvt_pk_bf16_f32 v36, v76, v77
    v_cvt_pk_bf16_f32 v37, v78, v79
    v_cvt_pk_bf16_f32 v38, v80, v81
    v_cvt_pk_bf16_f32 v39, v82, v83
    v_mfma_f32_16x16x16_bf16 v[76:79], v[36:37], v[56:57], 0
    v_rcp_f32 v65, v65
    v_mfma_f32_16x16x16_bf16 v[80:83], v[38:39], v[56:57], 0
    v_rcp_f32 v68, v68
    v_pk_mul_f32 v[84:85], v[84:85], v[64:65] op_sel_hi:[1,0]
    v_pk_mul_f32 v[86:87], v[86:87], v[64:65] op_sel_hi:[1,0]
    v_pk_mul_f32 v[88:89], v[88:89], v[64:65] op_sel:[0,1] op_sel_hi:[1,1]
    v_pk_mul_f32 v[90:91], v[90:91], v[64:65] op_sel:[0,1] op_sel_hi:[1,1]
    v_cvt_pk_bf16_f32 v40, v84, v85
    v_cvt_pk_bf16_f32 v41, v86, v87
    v_cvt_pk_bf16_f32 v42, v88, v89
    v_cvt_pk_bf16_f32 v43, v90, v91
    v_mfma_f32_16x16x16_bf16 v[84:87], v[40:41], v[56:57], 0
    v_rcp_f32 v69, v69
    v_mfma_f32_16x16x16_bf16 v[88:91], v[42:43], v[56:57], 0
    v_rcp_f32 v72, v72
    v_pk_mul_f32 v[92:93], v[92:93], v[68:69] op_sel_hi:[1,0]
    v_pk_mul_f32 v[94:95], v[94:95], v[68:69] op_sel_hi:[1,0]
    v_pk_mul_f32 v[96:97], v[96:97], v[68:69] op_sel:[0,1] op_sel_hi:[1,1]
    v_pk_mul_f32 v[98:99], v[98:99], v[68:69] op_sel:[0,1] op_sel_hi:[1,1]
    v_cvt_pk_bf16_f32 v44, v92, v93
    v_cvt_pk_bf16_f32 v45, v94, v95
    v_cvt_pk_bf16_f32 v46, v96, v97
    v_cvt_pk_bf16_f32 v47, v98, v99
    v_mfma_f32_16x16x16_bf16 v[92:95], v[44:45], v[56:57], 0
    v_rcp_f32 v73, v73
    v_mfma_f32_16x16x16_bf16 v[96:99], v[46:47], v[56:57], 0
    s_mul_i32 s82, s7, 3072
    s_add_u32 s82, s82, s77
    v_pk_mul_f32 v[100:101], v[100:101], v[72:73] op_sel_hi:[1,0]
    v_pk_mul_f32 v[102:103], v[102:103], v[72:73] op_sel_hi:[1,0]
    v_pk_mul_f32 v[104:105], v[104:105], v[72:73] op_sel:[0,1] op_sel_hi:[1,1]
    v_pk_mul_f32 v[106:107], v[106:107], v[72:73] op_sel:[0,1] op_sel_hi:[1,1]
    v_cvt_pk_bf16_f32 v48, v100, v101
    v_cvt_pk_bf16_f32 v49, v102, v103
    v_cvt_pk_bf16_f32 v50, v104, v105
    v_cvt_pk_bf16_f32 v51, v106, v107
    v_mfma_f32_16x16x16_bf16 v[100:103], v[48:49], v[56:57], 0
    v_cvt_pk_bf16_f32 v60, v76, v77
    v_cvt_pk_bf16_f32 v61, v78, v79
    v_mfma_f32_16x16x16_bf16 v[104:107], v[50:51], v[56:57], 0
    v_cvt_pk_bf16_f32 v64, v80, v81
    v_cvt_pk_bf16_f32 v65, v82, v83
    v_cvt_pk_bf16_f32 v62, v84, v85
    v_cvt_pk_bf16_f32 v63, v86, v87
    v_cvt_pk_bf16_f32 v66, v88, v89
    v_cvt_pk_bf16_f32 v67, v90, v91
    v_mfma_f32_16x16x32_bf16 v[108:111], v[60:63], v[28:31], 0
    v_cvt_pk_bf16_f32 v68, v92, v93
    v_cvt_pk_bf16_f32 v69, v94, v95
    v_mfma_f32_16x16x32_bf16 v[116:119], v[60:63], v[24:27], 0
    v_cvt_pk_bf16_f32 v72, v96, v97
    v_cvt_pk_bf16_f32 v73, v98, v99
    v_mfma_f32_16x16x32_bf16 v[112:115], v[64:67], v[28:31], 0
    v_cvt_pk_bf16_f32 v70, v100, v101
    v_cvt_pk_bf16_f32 v71, v102, v103
    v_mfma_f32_16x16x32_bf16 v[120:123], v[64:67], v[24:27], 0
    v_cvt_pk_bf16_f32 v74, v104, v105
    v_cvt_pk_bf16_f32 v75, v106, v107
    v_mfma_f32_16x16x32_bf16 v[108:111], v[68:71], v[32:35], v[108:111]
    v_mfma_f32_16x16x32_bf16 v[116:119], v[68:71], v[24:27], v[116:119]
    v_mfma_f32_16x16x32_bf16 v[112:115], v[72:75], v[32:35], v[112:115]
    v_mfma_f32_16x16x32_bf16 v[120:123], v[72:75], v[24:27], v[120:123]
    s_nop 7
    v_cndmask_b32 v116, v116, v120, s[54:55]
    v_cndmask_b32 v117, v117, v121, s[54:55]
    v_cndmask_b32 v118, v118, v122, s[54:55]
    v_cndmask_b32 v119, v119, v123, s[54:55]
    s_cmp_eq_u32 s48, 0
    s_cbranch_scc1 L17
    buffer_store_dwordx4 v[108:111], v0, s[36:39], s82 offen
    buffer_store_dwordx4 v[112:115], v0, s[36:39], s82 offen offset:1024
L18:
    s_mov_b32 exec_lo, 0x01010101
    s_mov_b32 exec_hi, 0x01010101
    s_cmp_eq_u32 s48, 0
    s_cbranch_scc1 L19
    buffer_store_dwordx4 v[116:119], v20, s[36:39], s82 offen offset:2048
L20:
    s_mov_b64 exec, -1
    s_waitcnt vmcnt(3)
    s_barrier
    ds_read_b128 v[76:79], v0 offset:0
    ds_read_b128 v[80:83], v0 offset:1024
    ds_read_b128 v[84:87], v0 offset:2048
    ds_read_b128 v[88:91], v0 offset:3072
    ds_read_b128 v[92:95], v0 offset:4096
    ds_read_b128 v[96:99], v0 offset:5120
    ds_read_b128 v[100:103], v0 offset:6144
    ds_read_b128 v[104:107], v0 offset:7168
    v_mov_b32 v58, 3
    v_bfe_u32 v59, v0, 4, 2
    v_lshlrev_b32 v21, 7, v59
    s_lshl_b32 s89, s7, 7
    s_sub_u32 s88, s74, s89
    s_lshl_b32 s89, s4, 2
    s_add_u32 s89, s89, s3
    s_lshl_b32 s89, s89, 3
    s_add_u32 s89, s89, s6
    s_lshl_b32 s90, s89, 10
    s_add_u32 s90, s90, 8978432
    s_lshl_b32 s91, s89, 7
    s_add_u32 s91, s91, 9502720
    v_add_u32 v59, s7, v59
    v_add_u32 v59, 1, v59
    v_and_b32 v59, 3, v59
    v_mul_u32_u24 v59, 3072, v59
    v_add_u32 v59, v59, v20
    v_bfe_u32 v56, v0, 4, 3
    v_cmp_gt_u32 vcc, 3, v56
    v_mov_b32 v56, 0x7ff00000
    s_add_u32 s92, s7, 1
    v_cndmask_b32 v59, v56, v59, vcc
    s_and_b32 s92, s92, 3
    s_mul_i32 s92, s92, 3072
    s_add_u32 s92, s92, s77
    s_add_u32 s93, s7, 2
    s_and_b32 s93, s93, 3
    s_mul_i32 s93, s93, 3072
    s_add_u32 s93, s93, s77
    s_add_u32 s94, s7, 3
    s_and_b32 s94, s94, 3
    s_mul_i32 s94, s94, 3072
    s_add_u32 s94, s94, s77
    v_lshrrev_b32 v126, 4, v0
    v_lshrrev_b32 v124, 4, v126
    v_mul_u32_u24 v124, 1024, v124
    v_bfe_u32 v127, v126, 2, 2
    v_lshl_add_u32 v124, v127, 7, v124
    v_and_b32 v127, 3, v126
    v_lshl_add_u32 v124, v127, 3, v124
    v_bfe_u32 v127, v126, 3, 2
    v_xor_b32 v127, s3, v127
    v_lshl_add_u32 v124, v127, 5, v124
    v_add_u32 v124, 90112, v124
    ds_read_b64_tr_b16 a[192:193], v124 offset:0
    ds_read_b64_tr_b16 a[194:195], v124 offset:512
    ds_read_b64_tr_b16 a[204:205], v124 offset:4096
    ds_read_b64_tr_b16 a[206:207], v124 offset:4608
    ds_read_b64_tr_b16 a[216:217], v124 offset:8192
    ds_read_b64_tr_b16 a[218:219], v124 offset:8704
    ds_read_b64_tr_b16 a[228:229], v124 offset:12288
    ds_read_b64_tr_b16 a[230:231], v124 offset:12800
    ds_read_b64_tr_b16 a[240:241], v124 offset:16384
    ds_read_b64_tr_b16 a[242:243], v124 offset:16896
    ds_read_b64_tr_b16 a[252:253], v124 offset:20480
    ds_read_b64_tr_b16 a[254:255], v124 offset:20992
    ds_read_b64_tr_b16 v[136:137], v124 offset:24576
    ds_read_b64_tr_b16 v[138:139], v124 offset:25088
    v_lshrrev_b32 v18, 4, v0
    s_mul_i32 s82, s3, 192
    s_add_u32 s82, s82, 157952
    v_and_b32 v16, 48, v18
    v_add_u32 v16, s82, v16
    v_and_b32 v17, 15, v18
    v_lshl_add_u32 v17, v17, 2, s82
    v_lshrrev_b32 v126, 4, v0
    s_lshl_b32 s80, s3, 3
    v_bfe_u32 v127, v126, 4, 1
    s_and_b32 s81, s3, 1
    s_lshl_b32 s81, s81, 1
    v_or_b32 v127, s81, v127
    v_lshlrev_b32 v127, 1, v127
    ds_read_b64_tr_b16 v[148:149], v124 offset:28672
    s_waitcnt lgkmcnt(13)
    v_mfma_f32_16x16x32_bf16 v[12:15], a[192:195], v[24:27], 0
    ds_read_b64_tr_b16 v[150:151], v124 offset:29184
    ds_read_b64_tr_b16 v[160:161], v124 offset:32768
    v_mfma_f32_16x16x32_bf16 v[60:63], a[192:195], v[76:79], 0
    ds_read_b128 v[76:79], v0 offset:8192
    ds_read_b64_tr_b16 v[162:163], v124 offset:33280
    v_mfma_f32_16x16x32_bf16 v[64:67], a[192:195], v[80:83], 0
    ds_read_b128 v[80:83], v0 offset:9216
    ds_read_b64_tr_b16 v[172:173], v124 offset:36864
    v_mfma_f32_16x16x32_bf16 v[68:71], a[192:195], v[84:87], 0
    s_waitcnt vmcnt(0)
    s_cmp_eq_u32 s48, 0
    s_cbranch_scc1 L21
    buffer_store_dword v58, off, s[36:39], s74
L22:
    v_mfma_f32_16x16x32_bf16 v[72:75], a[192:195], v[88:91], 0
    ds_read_b128 v[84:87], v0 offset:10240
    ds_read_b128 v[88:91], v0 offset:11264
    s_waitcnt lgkmcnt(9)
    v_mfma_f32_16x16x32_bf16 v[12:15], a[204:207], v[24:27], v[12:15]
    ds_read_b64_tr_b16 v[174:175], v124 offset:37376
    ds_read_b64_tr_b16 v[184:185], v124 offset:40960
    v_mfma_f32_16x16x32_bf16 v[60:63], a[204:207], v[92:95], v[60:63]
    ds_read_b128 v[92:95], v0 offset:12288
    ds_read_b64_tr_b16 v[186:187], v124 offset:41472
    v_mfma_f32_16x16x32_bf16 v[64:67], a[204:207], v[96:99], v[64:67]
    ds_read_b128 v[96:99], v0 offset:13312
    ds_read_b64_tr_b16 v[196:197], v124 offset:45056
    v_mfma_f32_16x16x32_bf16 v[68:71], a[204:207], v[100:103], v[68:71]
    ds_read_b128 v[100:103], v0 offset:14336
    ds_read_b64_tr_b16 v[198:199], v124 offset:45568
    v_mfma_f32_16x16x32_bf16 v[72:75], a[204:207], v[104:107], v[72:75]
    ds_read_b128 v[104:107], v0 offset:15360
    ds_read_b64_tr_b16 v[208:209], v124 offset:49152
    v_mfma_f32_16x16x32_bf16 v[12:15], a[216:219], v[24:27], v[12:15]
    ds_read_b64_tr_b16 v[210:211], v124 offset:49664
    ds_read_b64_tr_b16 v[220:221], v124 offset:53248
    s_waitcnt lgkmcnt(14)
    v_mfma_f32_16x16x32_bf16 v[60:63], a[216:219], v[76:79], v[60:63]
    ds_read_b128 v[76:79], v0 offset:16384
    ds_read_b64_tr_b16 v[222:223], v124 offset:53760
    v_mfma_f32_16x16x32_bf16 v[64:67], a[216:219], v[80:83], v[64:67]
    ds_read_b128 v[80:83], v0 offset:17408
    s_waitcnt lgkmcnt(13)
    v_mfma_f32_16x16x32_bf16 v[68:71], a[216:219], v[84:87], v[68:71]
    ds_read_b128 v[84:87], v0 offset:18432
    ds_read_b64_tr_b16 v[232:233], v124 offset:57344
    v_mfma_f32_16x16x32_bf16 v[72:75], a[216:219], v[88:91], v[72:75]
    ds_read_b128 v[88:91], v0 offset:19456
    ds_read_b64_tr_b16 v[234:235], v124 offset:57856
    v_mfma_f32_16x16x32_bf16 v[12:15], a[228:231], v[24:27], v[12:15]
    buffer_load_dword v57, v21, s[36:39], s88 offen sc1
    ds_read_b64_tr_b16 v[244:245], v124 offset:61440
    s_waitcnt lgkmcnt(12)
    v_mfma_f32_16x16x32_bf16 v[60:63], a[228:231], v[92:95], v[60:63]
    ds_read_b128 v[92:95], v0 offset:20480
    ds_read_b64_tr_b16 v[246:247], v124 offset:61952
    v_mfma_f32_16x16x32_bf16 v[64:67], a[228:231], v[96:99], v[64:67]
    ds_read_b128 v[96:99], v0 offset:21504
    v_lshrrev_b32 v124, 3, v126
    v_mfma_f32_16x16x32_bf16 v[68:71], a[228:231], v[100:103], v[68:71]
    ds_read_b128 v[100:103], v0 offset:22528
    v_add_u32 v124, s80, v124
    s_waitcnt lgkmcnt(10)
    v_mfma_f32_16x16x32_bf16 v[72:75], a[228:231], v[104:107], v[72:75]
    ds_read_b128 v[104:107], v0 offset:23552
    v_mul_u32_u24 v124, 1024, v124
    v_mfma_f32_16x16x32_bf16 v[12:15], a[240:243], v[24:27], v[12:15]
    v_and_b32 v126, 7, v126
    v_xor_b32 v126, v126, v127
    v_mfma_f32_16x16x32_bf16 v[60:63], a[240:243], v[76:79], v[60:63]
    ds_read_b128 v[76:79], v0 offset:24576
    v_lshl_add_u32 v124, v126, 4, v124
    s_waitcnt lgkmcnt(7)
    v_mfma_f32_16x16x32_bf16 v[64:67], a[240:243], v[80:83], v[64:67]
    ds_read_b128 v[80:83], v0 offset:25600
    s_lshl_b32 s80, s4, 7
    v_mfma_f32_16x16x32_bf16 v[68:71], a[240:243], v[84:87], v[68:71]
    ds_read_b128 v[84:87], v0 offset:26624
    v_add_u32 v124, s80, v124
    v_mfma_f32_16x16x32_bf16 v[72:75], a[240:243], v[88:91], v[72:75]
    ds_read_b128 v[88:91], v0 offset:27648
    v_mfma_f32_16x16x32_bf16 v[12:15], a[252:255], v[24:27], v[12:15]
    s_waitcnt lgkmcnt(5)
    v_mfma_f32_16x16x32_bf16 v[60:63], a[252:255], v[92:95], v[60:63]
    ds_read_b128 v[92:95], v0 offset:28672
    v_mfma_f32_16x16x32_bf16 v[64:67], a[252:255], v[96:99], v[64:67]
    ds_read_b128 v[96:99], v0 offset:29696
    v_mfma_f32_16x16x32_bf16 v[68:71], a[252:255], v[100:103], v[68:71]
    ds_read_b128 v[100:103], v0 offset:30720
    s_waitcnt lgkmcnt(6)
    v_mfma_f32_16x16x32_bf16 v[72:75], a[252:255], v[104:107], v[72:75]
    ds_read_b128 v[104:107], v0 offset:31744
    v_mfma_f32_16x16x32_bf16 v[12:15], v[136:139], v[24:27], v[12:15]
    v_mfma_f32_16x16x32_bf16 v[60:63], v[136:139], v[76:79], v[60:63]
    ds_read_b128 v[76:79], v0 offset:32768
    s_waitcnt lgkmcnt(5)
    v_mfma_f32_16x16x32_bf16 v[64:67], v[136:139], v[80:83], v[64:67]
    ds_read_b128 v[80:83], v0 offset:33792
    v_mfma_f32_16x16x32_bf16 v[68:71], v[136:139], v[84:87], v[68:71]
    ds_read_b128 v[84:87], v0 offset:34816
    v_mfma_f32_16x16x32_bf16 v[72:75], v[136:139], v[88:91], v[72:75]
    ds_read_b128 v[88:91], v0 offset:35840
    s_waitcnt vmcnt(0)
    s_cmp_lg_u32 s3, s7
    s_cbranch_scc1 L23
    v_cmp_gt_u32 vcc, 3, v57
    s_cbranch_vccz L24
L25:
    buffer_load_dword v57, v21, s[36:39], s88 offen sc1
    s_sub_u32 s49, s49, 1
    s_cbranch_scc1 L_end
    s_waitcnt vmcnt(0)
    v_cmp_gt_u32 vcc, 3, v57
    s_cbranch_vccnz L25
L24:
    buffer_load_dwordx4 v[28:31], v0, s[36:39], s92 offen offset:0 sc1
    buffer_load_dwordx4 v[32:35], v0, s[36:39], s92 offen offset:1024 sc1
    buffer_load_dwordx4 v[36:39], v0, s[36:39], s93 offen offset:0 sc1
    buffer_load_dwordx4 v[40:43], v0, s[36:39], s93 offen offset:1024 sc1
    buffer_load_dwordx4 v[44:47], v0, s[36:39], s94 offen offset:0 sc1
    buffer_load_dwordx4 v[48:51], v0, s[36:39], s94 offen offset:1024 sc1
    buffer_load_dwordx4 v[120:123], v59, s[36:39], s77 offen offset:2048 sc1
L23:
    v_mfma_f32_16x16x32_bf16 v[12:15], v[148:151], v[24:27], v[12:15]
    s_waitcnt lgkmcnt(2)
    v_mfma_f32_16x16x32_bf16 v[60:63], v[148:151], v[92:95], v[60:63]
    ds_read_b128 v[92:95], v0 offset:36864
    v_mfma_f32_16x16x32_bf16 v[64:67], v[148:151], v[96:99], v[64:67]
    ds_read_b128 v[96:99], v0 offset:37888
    v_mfma_f32_16x16x32_bf16 v[68:71], v[148:151], v[100:103], v[68:71]
    ds_read_b128 v[100:103], v0 offset:38912
    v_mfma_f32_16x16x32_bf16 v[72:75], v[148:151], v[104:107], v[72:75]
    ds_read_b128 v[104:107], v0 offset:39936
    v_mfma_f32_16x16x32_bf16 v[12:15], v[160:163], v[24:27], v[12:15]
    v_mfma_f32_16x16x32_bf16 v[60:63], v[160:163], v[76:79], v[60:63]
    ds_read_b128 v[76:79], v0 offset:40960
    v_mfma_f32_16x16x32_bf16 v[64:67], v[160:163], v[80:83], v[64:67]
    ds_read_b128 v[80:83], v0 offset:41984
    s_waitcnt lgkmcnt(6)
    v_mfma_f32_16x16x32_bf16 v[68:71], v[160:163], v[84:87], v[68:71]
    ds_read_b128 v[84:87], v0 offset:43008
    v_mfma_f32_16x16x32_bf16 v[72:75], v[160:163], v[88:91], v[72:75]
    ds_read_b128 v[88:91], v0 offset:44032
    v_mfma_f32_16x16x32_bf16 v[12:15], v[172:175], v[24:27], v[12:15]
    s_waitcnt lgkmcnt(5)
    v_mfma_f32_16x16x32_bf16 v[60:63], v[172:175], v[92:95], v[60:63]
    ds_read_b128 v[92:95], v0 offset:45056
    v_mfma_f32_16x16x32_bf16 v[64:67], v[172:175], v[96:99], v[64:67]
    ds_read_b128 v[96:99], v0 offset:46080
    v_mfma_f32_16x16x32_bf16 v[68:71], v[172:175], v[100:103], v[68:71]
    ds_read_b128 v[100:103], v0 offset:47104
    s_waitcnt lgkmcnt(6)
    v_mfma_f32_16x16x32_bf16 v[72:75], v[172:175], v[104:107], v[72:75]
    ds_read_b128 v[104:107], v0 offset:48128
    v_mfma_f32_16x16x32_bf16 v[12:15], v[184:187], v[24:27], v[12:15]
    v_mfma_f32_16x16x32_bf16 v[60:63], v[184:187], v[76:79], v[60:63]
    ds_read_b128 v[76:79], v0 offset:49152
    s_waitcnt lgkmcnt(5)
    v_mfma_f32_16x16x32_bf16 v[64:67], v[184:187], v[80:83], v[64:67]
    ds_read_b128 v[80:83], v0 offset:50176
    v_mfma_f32_16x16x32_bf16 v[68:71], v[184:187], v[84:87], v[68:71]
    ds_read_b128 v[84:87], v0 offset:51200
    v_mfma_f32_16x16x32_bf16 v[72:75], v[184:187], v[88:91], v[72:75]
    ds_read_b128 v[88:91], v0 offset:52224
    v_mfma_f32_16x16x32_bf16 v[12:15], v[196:199], v[24:27], v[12:15]
    s_waitcnt lgkmcnt(5)
    v_mfma_f32_16x16x32_bf16 v[60:63], v[196:199], v[92:95], v[60:63]
    ds_read_b128 v[92:95], v0 offset:53248
    v_mfma_f32_16x16x32_bf16 v[64:67], v[196:199], v[96:99], v[64:67]
    ds_read_b128 v[96:99], v0 offset:54272
    v_mfma_f32_16x16x32_bf16 v[68:71], v[196:199], v[100:103], v[68:71]
    ds_read_b128 v[100:103], v0 offset:55296
    s_waitcnt lgkmcnt(6)
    v_mfma_f32_16x16x32_bf16 v[72:75], v[196:199], v[104:107], v[72:75]
    ds_read_b128 v[104:107], v0 offset:56320
    v_mfma_f32_16x16x32_bf16 v[12:15], v[208:211], v[24:27], v[12:15]
    v_mfma_f32_16x16x32_bf16 v[60:63], v[208:211], v[76:79], v[60:63]
    ds_read_b128 v[76:79], v0 offset:57344
    s_waitcnt lgkmcnt(5)
    v_mfma_f32_16x16x32_bf16 v[64:67], v[208:211], v[80:83], v[64:67]
    ds_read_b128 v[80:83], v0 offset:58368
    v_mfma_f32_16x16x32_bf16 v[68:71], v[208:211], v[84:87], v[68:71]
    ds_read_b128 v[84:87], v0 offset:59392
    v_mfma_f32_16x16x32_bf16 v[72:75], v[208:211], v[88:91], v[72:75]
    ds_read_b128 v[88:91], v0 offset:60416
    v_mfma_f32_16x16x32_bf16 v[12:15], v[220:223], v[24:27], v[12:15]
    s_waitcnt lgkmcnt(5)
    v_mfma_f32_16x16x32_bf16 v[60:63], v[220:223], v[92:95], v[60:63]
    ds_read_b128 v[92:95], v0 offset:61440
    v_mfma_f32_16x16x32_bf16 v[64:67], v[220:223], v[96:99], v[64:67]
    ds_read_b128 v[96:99], v0 offset:62464
    v_mfma_f32_16x16x32_bf16 v[68:71], v[220:223], v[100:103], v[68:71]
    ds_read_b128 v[100:103], v0 offset:63488
    s_waitcnt lgkmcnt(6)
    v_mfma_f32_16x16x32_bf16 v[72:75], v[220:223], v[104:107], v[72:75]
    ds_read_b128 v[104:107], v0 offset:64512
    s_barrier
    v_mfma_f32_16x16x32_bf16 v[12:15], v[232:235], v[24:27], v[12:15]
    v_mfma_f32_16x16x32_bf16 v[60:63], v[232:235], v[76:79], v[60:63]
    s_waitcnt lgkmcnt(4)
    v_mfma_f32_16x16x32_bf16 v[64:67], v[232:235], v[80:83], v[64:67]
    v_mfma_f32_16x16x32_bf16 v[68:71], v[232:235], v[84:87], v[68:71]
    v_mfma_f32_16x16x32_bf16 v[72:75], v[232:235], v[88:91], v[72:75]
    v_mfma_f32_16x16x32_bf16 v[12:15], v[244:247], v[24:27], v[12:15]
    s_waitcnt lgkmcnt(1)
    v_mfma_f32_16x16x32_bf16 v[60:63], v[244:247], v[92:95], v[60:63]
    v_mfma_f32_16x16x32_bf16 v[64:67], v[244:247], v[96:99], v[64:67]
    s_nop 4
    ds_write_b128 v16, v[12:15]
    v_mfma_f32_16x16x32_bf16 v[68:71], v[244:247], v[100:103], v[68:71]
    s_waitcnt lgkmcnt(1)
    v_mfma_f32_16x16x32_bf16 v[72:75], v[244:247], v[104:107], v[72:75]
    s_cmp_lg_u32 s3, s7
    s_cbranch_scc1 L26
    s_waitcnt vmcnt(3)
    v_pk_add_f32 v[108:109], v[108:109], v[28:29]
    v_pk_add_f32 v[110:111], v[110:111], v[30:31]
    v_pk_add_f32 v[112:113], v[112:113], v[32:33]
    v_pk_add_f32 v[114:115], v[114:115], v[34:35]
    v_pk_add_f32 v[108:109], v[108:109], v[36:37]
    v_pk_add_f32 v[110:111], v[110:111], v[38:39]
    v_pk_add_f32 v[112:113], v[112:113], v[40:41]
    v_pk_add_f32 v[114:115], v[114:115], v[42:43]
    s_waitcnt vmcnt(0)
    v_pk_add_f32 v[108:109], v[108:109], v[44:45]
    v_pk_add_f32 v[110:111], v[110:111], v[46:47]
    v_pk_add_f32 v[112:113], v[112:113], v[48:49]
    v_pk_add_f32 v[114:115], v[114:115], v[50:51]
    v_add_f32_dpp v120, v120, v120 quad_perm:[1,0,3,2] row_mask:0xf bank_mask:0xf
    v_add_f32_dpp v121, v121, v121 quad_perm:[1,0,3,2] row_mask:0xf bank_mask:0xf
    v_add_f32_dpp v122, v122, v122 quad_perm:[1,0,3,2] row_mask:0xf bank_mask:0xf
    v_add_f32_dpp v123, v123, v123 quad_perm:[1,0,3,2] row_mask:0xf bank_mask:0xf
    v_cvt_pk_bf16_f32 v108, v108, v109
    v_cvt_pk_bf16_f32 v109, v110, v111
    v_cvt_pk_bf16_f32 v110, v112, v113
    v_cvt_pk_bf16_f32 v111, v114, v115
    buffer_store_dwordx4 v[108:111], v0, s[36:39], s90 offen sc1
    v_add_f32_dpp v120, v120, v120 quad_perm:[2,3,0,1] row_mask:0xf bank_mask:0xf
    v_add_f32_dpp v121, v121, v121 quad_perm:[2,3,0,1] row_mask:0xf bank_mask:0xf
    v_add_f32_dpp v122, v122, v122 quad_perm:[2,3,0,1] row_mask:0xf bank_mask:0xf
    v_add_f32_dpp v123, v123, v123 quad_perm:[2,3,0,1] row_mask:0xf bank_mask:0xf
    v_pk_add_f32 v[120:121], v[120:121], v[116:117]
    v_pk_add_f32 v[122:123], v[122:123], v[118:119]
    s_mov_b32 exec_lo, 0x01010101
    s_mov_b32 exec_hi, 0x01010101
    buffer_store_dwordx4 v[120:123], v20, s[36:39], s91 offen sc1
    s_mov_b64 exec, -1
L26:
    ds_read2_b32 v[12:13], v22 offset0:0 offset1:128
    ds_read2_b32 v[14:15], v22 offset0:16 offset1:144
    ds_read2_b32 v[16:17], v22 offset0:32 offset1:160
    ds_read2_b32 v[18:19], v22 offset0:48 offset1:176
    v_lshrrev_b32 v30, 4, v0
    s_mul_i32 s82, s3, 192
    s_add_u32 s82, s82, 157952
    v_and_b32 v28, 48, v30
    v_add_u32 v28, s82, v28
    ds_read_b128 v[116:119], v28
    v_and_b32 v29, 15, v30
    v_lshl_add_u32 v29, v29, 2, s82
    v_bfe_u32 v59, v0, 4, 3
    v_lshl_add_u32 v58, v59, 7, v20
    s_lshl_b32 s84, s4, 2
    s_add_u32 s84, s84, s3
    s_lshl_b32 s85, s84, 10
    s_add_u32 s85, s85, 9502720
    s_lshl_b32 s84, s84, 13
    s_add_u32 s84, s84, 8978432
    s_add_u32 s81, s84, 4096
    v_and_b32 v22, 0xf0, v0
    v_bfe_u32 v23, v0, 8, 1
    v_lshl_add_u32 v22, v23, 14, v22
    v_lshrrev_b32 v23, 9, v0
    v_lshl_add_u32 v22, v23, 8, v22
    v_mov_b32 v59, v124
    s_waitcnt lgkmcnt(0)
    v_pk_fma_f32 v[60:61], v[116:117], v[12:13], v[60:61] op_sel_hi:[1,0,1] neg_lo:[0,1,0] neg_hi:[0,1,0]
    v_pk_fma_f32 v[62:63], v[118:119], v[12:13], v[62:63] op_sel_hi:[1,0,1] neg_lo:[0,1,0] neg_hi:[0,1,0]
    v_pk_mul_f32 v[60:61], v[60:61], v[12:13] op_sel:[0,1] op_sel_hi:[1,1]
    v_pk_mul_f32 v[62:63], v[62:63], v[12:13] op_sel:[0,1] op_sel_hi:[1,1]
    v_cvt_pk_bf16_f32 v28, v60, v61
    v_cvt_pk_bf16_f32 v29, v62, v63
    v_pk_fma_f32 v[64:65], v[116:117], v[14:15], v[64:65] op_sel_hi:[1,0,1] neg_lo:[0,1,0] neg_hi:[0,1,0]
    v_pk_fma_f32 v[66:67], v[118:119], v[14:15], v[66:67] op_sel_hi:[1,0,1] neg_lo:[0,1,0] neg_hi:[0,1,0]
    v_mfma_f32_16x16x16_bf16 v[60:63], v[10:11], v[28:29], 0
    v_pk_mul_f32 v[64:65], v[64:65], v[14:15] op_sel:[0,1] op_sel_hi:[1,1]
    v_pk_mul_f32 v[66:67], v[66:67], v[14:15] op_sel:[0,1] op_sel_hi:[1,1]
    v_cvt_pk_bf16_f32 v30, v64, v65
    v_cvt_pk_bf16_f32 v31, v66, v67
    v_pk_fma_f32 v[68:69], v[116:117], v[16:17], v[68:69] op_sel_hi:[1,0,1] neg_lo:[0,1,0] neg_hi:[0,1,0]
    v_pk_fma_f32 v[70:71], v[118:119], v[16:17], v[70:71] op_sel_hi:[1,0,1] neg_lo:[0,1,0] neg_hi:[0,1,0]
    v_mfma_f32_16x16x16_bf16 v[64:67], v[10:11], v[30:31], 0
    s_nop 0
    v_max3_f32 v12, v60, v61, v62
    v_max_f32 v12, v12, v63
    v_pk_mul_f32 v[68:69], v[68:69], v[16:17] op_sel:[0,1] op_sel_hi:[1,1]
    v_pk_mul_f32 v[70:71], v[70:71], v[16:17] op_sel:[0,1] op_sel_hi:[1,1]
    v_cvt_pk_bf16_f32 v32, v68, v69
    v_cvt_pk_bf16_f32 v33, v70, v71
    v_pk_fma_f32 v[72:73], v[116:117], v[18:19], v[72:73] op_sel_hi:[1,0,1] neg_lo:[0,1,0] neg_hi:[0,1,0]
    v_pk_fma_f32 v[74:75], v[118:119], v[18:19], v[74:75] op_sel_hi:[1,0,1] neg_lo:[0,1,0] neg_hi:[0,1,0]
    v_mfma_f32_16x16x16_bf16 v[68:71], v[10:11], v[32:33], 0
    v_max3_f32 v16, -v60, -v61, -v62
    v_max_f32_e64 v16, v16, -v63
    v_pk_mul_f32 v[72:73], v[72:73], v[18:19] op_sel:[0,1] op_sel_hi:[1,1]
    v_pk_mul_f32 v[74:75], v[74:75], v[18:19] op_sel:[0,1] op_sel_hi:[1,1]
    v_cvt_pk_bf16_f32 v34, v72, v73
    v_cvt_pk_bf16_f32 v35, v74, v75
    v_max3_f32 v13, v64, v65, v66
    v_max3_f32 v17, -v64, -v65, -v66
    v_mfma_f32_16x16x16_bf16 v[72:75], v[10:11], v[34:35], 0
    v_max_f32 v13, v13, v67
    v_max_f32_e64 v17, v17, -v67
    v_max3_f32 v14, v68, v69, v70
    v_max3_f32 v18, -v68, -v69, -v70
    v_max_f32 v14, v14, v71
    v_max_f32_e64 v18, v18, -v71
    v_permlane32_swap_b32 v12, v13
    s_nop 0
    v_max3_f32 v15, v72, v73, v74
    v_max3_f32 v19, -v72, -v73, -v74
    v_max_f32 v15, v15, v75
    v_max_f32_e64 v19, v19, -v75
    v_max_f32 v12, v12, v13
    v_permlane32_swap_b32 v14, v15
    v_max_f32 v14, v14, v15
    v_permlane32_swap_b32 v16, v17
    s_nop 0
    v_permlane16_swap_b32 v12, v14
    v_max_f32 v12, v12, v14
    v_mul_f32 v12, s52, v12
    v_mov_b32 v14, v12
    v_permlane32_swap_b32 v18, v19
    s_nop 0
    v_permlane16_swap_b32 v12, v14
    v_mov_b32 v13, v12
    v_mov_b32 v15, v14
    v_max_f32 v16, v16, v17
    v_permlane32_swap_b32 v12, v13
    v_permlane32_swap_b32 v14, v15
    v_max_f32 v18, v18, v19
    v_pk_fma_f32 v[76:77], v[60:61], s[52:53], v[12:13] op_sel:[0,0,0] op_sel_hi:[1,1,0] neg_lo:[0,0,1] neg_hi:[0,0,1]
    v_pk_fma_f32 v[78:79], v[62:63], s[52:53], v[12:13] op_sel:[0,0,0] op_sel_hi:[1,1,0] neg_lo:[0,0,1] neg_hi:[0,0,1]
    v_permlane16_swap_b32 v16, v18
    v_max_f32 v16, v16, v18
    v_mul_f32 v16, s52, v16
    v_mov_b32 v18, v16
    v_exp_f32 v76, v76
    s_nop 0
    v_permlane16_swap_b32 v16, v18
    v_mov_b32 v17, v16
    v_mov_b32 v19, v18
    v_exp_f32 v77, v77
    v_permlane32_swap_b32 v16, v17
    v_permlane32_swap_b32 v18, v19
    v_pk_fma_f32 v[80:81], v[60:61], s[52:53], v[16:17] op_sel:[0,0,0] op_sel_hi:[1,1,0] neg_lo:[0,1,1] neg_hi:[0,1,1]
    v_pk_fma_f32 v[82:83], v[62:63], s[52:53], v[16:17] op_sel:[0,0,0] op_sel_hi:[1,1,0] neg_lo:[0,1,1] neg_hi:[0,1,1]
    v_exp_f32 v78, v78
    v_exp_f32 v79, v79
    v_exp_f32 v80, v80
    v_exp_f32 v81, v81
    v_exp_f32 v82, v82
    v_exp_f32 v83, v83
    v_cvt_pk_bf16_f32 v36, v76, v77
    v_cvt_pk_bf16_f32 v37, v78, v79
    v_cvt_pk_bf16_f32 v38, v80, v81
    v_cvt_pk_bf16_f32 v39, v82, v83
    v_pk_fma_f32 v[84:85], v[64:65], s[52:53], v[12:13] op_sel:[0,0,1] op_sel_hi:[1,1,1] neg_lo:[0,0,1] neg_hi:[0,0,1]
    v_pk_fma_f32 v[88:89], v[64:65], s[52:53], v[16:17] op_sel:[0,0,1] op_sel_hi:[1,1,1] neg_lo:[0,1,1] neg_hi:[0,1,1]
    v_pk_fma_f32 v[86:87], v[66:67], s[52:53], v[12:13] op_sel:[0,0,1] op_sel_hi:[1,1,1] neg_lo:[0,0,1] neg_hi:[0,0,1]
    v_pk_fma_f32 v[90:91], v[66:67], s[52:53], v[16:17] op_sel:[0,0,1] op_sel_hi:[1,1,1] neg_lo:[0,1,1] neg_hi:[0,1,1]
    v_exp_f32 v84, v84
    v_mfma_f32_16x16x32_bf16 v[60:63], v[52:55], v[36:39], 0
    v_exp_f32 v85, v85
    v_exp_f32 v86, v86
    v_exp_f32 v87, v87
    v_exp_f32 v88, v88
    v_exp_f32 v89, v89
    v_exp_f32 v90, v90
    v_exp_f32 v91, v91
    v_cvt_pk_bf16_f32 v40, v84, v85
    v_cvt_pk_bf16_f32 v41, v86, v87
    v_cvt_pk_bf16_f32 v42, v88, v89
    v_cvt_pk_bf16_f32 v43, v90, v91
    v_pk_fma_f32 v[92:93], v[68:69], s[52:53], v[14:15] op_sel:[0,0,0] op_sel_hi:[1,1,0] neg_lo:[0,0,1] neg_hi:[0,0,1]
    v_pk_fma_f32 v[96:97], v[68:69], s[52:53], v[18:19] op_sel:[0,0,0] op_sel_hi:[1,1,0] neg_lo:[0,1,1] neg_hi:[0,1,1]
    v_mfma_f32_16x16x32_bf16 v[64:67], v[52:55], v[40:43], 0
    v_exp_f32 v92, v92
    v_pk_fma_f32 v[94:95], v[70:71], s[52:53], v[14:15] op_sel:[0,0,0] op_sel_hi:[1,1,0] neg_lo:[0,0,1] neg_hi:[0,0,1]
    v_pk_fma_f32 v[98:99], v[70:71], s[52:53], v[18:19] op_sel:[0,0,0] op_sel_hi:[1,1,0] neg_lo:[0,1,1] neg_hi:[0,1,1]
    v_exp_f32 v93, v93
    v_exp_f32 v94, v94
    v_exp_f32 v95, v95
    v_exp_f32 v96, v96
    v_exp_f32 v97, v97
    v_exp_f32 v98, v98
    v_exp_f32 v99, v99
    v_cvt_pk_bf16_f32 v44, v92, v93
    v_cvt_pk_bf16_f32 v45, v94, v95
    v_cvt_pk_bf16_f32 v46, v96, v97
    v_cvt_pk_bf16_f32 v47, v98, v99
    v_pk_fma_f32 v[100:101], v[72:73], s[52:53], v[14:15] op_sel:[0,0,1] op_sel_hi:[1,1,1] neg_lo:[0,0,1] neg_hi:[0,0,1]
    v_pk_fma_f32 v[104:105], v[72:73], s[52:53], v[18:19] op_sel:[0,0,1] op_sel_hi:[1,1,1] neg_lo:[0,1,1] neg_hi:[0,1,1]
    v_pk_fma_f32 v[102:103], v[74:75], s[52:53], v[14:15] op_sel:[0,0,1] op_sel_hi:[1,1,1] neg_lo:[0,0,1] neg_hi:[0,0,1]
    v_pk_fma_f32 v[106:107], v[74:75], s[52:53], v[18:19] op_sel:[0,0,1] op_sel_hi:[1,1,1] neg_lo:[0,1,1] neg_hi:[0,1,1]
    v_exp_f32 v100, v100
    v_mfma_f32_16x16x32_bf16 v[68:71], v[52:55], v[44:47], 0
    v_exp_f32 v101, v101
    v_exp_f32 v102, v102
    v_exp_f32 v103, v103
    v_exp_f32 v104, v104
    v_exp_f32 v105, v105
    v_exp_f32 v106, v106
    v_exp_f32 v107, v107
    v_cvt_pk_bf16_f32 v48, v100, v101
    v_cvt_pk_bf16_f32 v49, v102, v103
    v_cvt_pk_bf16_f32 v50, v104, v105
    v_cvt_pk_bf16_f32 v51, v106, v107
    v_rcp_f32 v60, v60
    s_nop 0
    v_mfma_f32_16x16x32_bf16 v[72:75], v[52:55], v[48:51], 0
    v_rcp_f32 v61, v61
    v_rcp_f32 v64, v64
    v_pk_mul_f32 v[76:77], v[76:77], v[60:61] op_sel_hi:[1,0]
    v_pk_mul_f32 v[78:79], v[78:79], v[60:61] op_sel_hi:[1,0]
    v_pk_mul_f32 v[80:81], v[80:81], v[60:61] op_sel:[0,1] op_sel_hi:[1,1]
    v_pk_mul_f32 v[82:83], v[82:83], v[60:61] op_sel:[0,1] op_sel_hi:[1,1]
    v_cvt_pk_bf16_f32 v36, v76, v77
    v_cvt_pk_bf16_f32 v37, v78, v79
    v_cvt_pk_bf16_f32 v38, v80, v81
    v_cvt_pk_bf16_f32 v39, v82, v83
    v_rcp_f32 v65, v65
    v_rcp_f32 v68, v68
    v_pk_mul_f32 v[84:85], v[84:85], v[64:65] op_sel_hi:[1,0]
    v_pk_mul_f32 v[86:87], v[86:87], v[64:65] op_sel_hi:[1,0]
    v_pk_mul_f32 v[88:89], v[88:89], v[64:65] op_sel:[0,1] op_sel_hi:[1,1]
    v_pk_mul_f32 v[90:91], v[90:91], v[64:65] op_sel:[0,1] op_sel_hi:[1,1]
    v_cvt_pk_bf16_f32 v40, v84, v85
    v_cvt_pk_bf16_f32 v41, v86, v87
    v_cvt_pk_bf16_f32 v42, v88, v89
    v_cvt_pk_bf16_f32 v43, v90, v91
    v_rcp_f32 v69, v69
    v_rcp_f32 v72, v72
    v_pk_mul_f32 v[92:93], v[92:93], v[68:69] op_sel_hi:[1,0]
    v_pk_mul_f32 v[94:95], v[94:95], v[68:69] op_sel_hi:[1,0]
    v_pk_mul_f32 v[96:97], v[96:97], v[68:69] op_sel:[0,1] op_sel_hi:[1,1]
    v_pk_mul_f32 v[98:99], v[98:99], v[68:69] op_sel:[0,1] op_sel_hi:[1,1]
    v_cvt_pk_bf16_f32 v44, v92, v93
    v_cvt_pk_bf16_f32 v45, v94, v95
    v_cvt_pk_bf16_f32 v46, v96, v97
    v_cvt_pk_bf16_f32 v47, v98, v99
    v_rcp_f32 v73, v73
    s_nop 0
    v_pk_mul_f32 v[100:101], v[100:101], v[72:73] op_sel_hi:[1,0]
    v_pk_mul_f32 v[102:103], v[102:103], v[72:73] op_sel_hi:[1,0]
    v_pk_mul_f32 v[104:105], v[104:105], v[72:73] op_sel:[0,1] op_sel_hi:[1,1]
    v_pk_mul_f32 v[106:107], v[106:107], v[72:73] op_sel:[0,1] op_sel_hi:[1,1]
    v_cvt_pk_bf16_f32 v48, v100, v101
    v_cvt_pk_bf16_f32 v49, v102, v103
    v_cvt_pk_bf16_f32 v50, v104, v105
    v_cvt_pk_bf16_f32 v51, v106, v107
L27:
    buffer_load_dwordx4 v[76:79], v0, s[36:39], s84 offen offset:0 sc1
    buffer_load_dwordx4 v[80:83], v0, s[36:39], s84 offen offset:1024 sc1
    buffer_load_dwordx4 v[84:87], v0, s[36:39], s84 offen offset:2048 sc1
    buffer_load_dwordx4 v[88:91], v0, s[36:39], s84 offen offset:3072 sc1
    buffer_load_dwordx4 v[92:95], v0, s[36:39], s81 offen offset:0 sc1
    buffer_load_dwordx4 v[96:99], v0, s[36:39], s81 offen offset:1024 sc1
    buffer_load_dwordx4 v[100:103], v0, s[36:39], s81 offen offset:2048 sc1
    buffer_load_dwordx4 v[104:107], v0, s[36:39], s81 offen offset:3072 sc1
    buffer_load_dwordx4 v[108:111], v58, s[36:39], s85 offen sc1
    s_waitcnt vmcnt(6)
    v_max3_u32 v21, v76, v80, v84
    s_waitcnt vmcnt(2)
    v_max3_u32 v21, v21, v88, v92
    v_max3_u32 v21, v21, v96, v100
    s_waitcnt vmcnt(0)
    v_max3_u32 v21, v21, v104, v108
    v_cmp_eq_u32 vcc, -1, v21
    s_cbranch_vccnz L28
    v_mfma_f32_16x16x32_bf16 v[60:63], v[76:79], v[36:39], 0
    s_add_u32 s86, s60, 0
    s_and_b32 s86, s86, 15
    v_mfma_f32_16x16x32_bf16 v[64:67], v[76:79], v[40:43], 0
    s_mul_i32 s86, s86, 32768
    s_add_u32 m0, s62, 90112
    v_mfma_f32_16x16x32_bf16 v[68:71], v[76:79], v[44:47], 0
    buffer_load_dwordx4 v59, s[24:27], s86 offen lds
    s_add_u32 s87, s60, 1
    v_mfma_f32_16x16x32_bf16 v[72:75], v[76:79], v[48:51], 0
    s_and_b32 s87, s87, 15
    s_mul_i32 s87, s87, 32768
    v_mfma_f32_16x16x32_bf16 v[60:63], v[80:83], v[36:39], v[60:63]
    s_add_u32 m0, s62, 94208
    s_add_u32 s86, s60, 2
    v_mfma_f32_16x16x32_bf16 v[64:67], v[80:83], v[40:43], v[64:67]
    buffer_load_dwordx4 v59, s[24:27], s87 offen lds
    s_and_b32 s86, s86, 15
    v_mfma_f32_16x16x32_bf16 v[68:71], v[80:83], v[44:47], v[68:71]
    s_mul_i32 s86, s86, 32768
    s_add_u32 m0, s62, 98304
    v_mfma_f32_16x16x32_bf16 v[72:75], v[80:83], v[48:51], v[72:75]
    buffer_load_dwordx4 v59, s[24:27], s86 offen lds
    s_add_u32 s87, s60, 3
    v_mfma_f32_16x16x32_bf16 v[60:63], v[84:87], v[36:39], v[60:63]
    s_and_b32 s87, s87, 15
    s_mul_i32 s87, s87, 32768
    v_mfma_f32_16x16x32_bf16 v[64:67], v[84:87], v[40:43], v[64:67]
    s_add_u32 m0, s62, 102400
    s_add_u32 s86, s60, 4
    v_mfma_f32_16x16x32_bf16 v[68:71], v[84:87], v[44:47], v[68:71]
    buffer_load_dwordx4 v59, s[24:27], s87 offen lds
    s_and_b32 s86, s86, 15
    v_mfma_f32_16x16x32_bf16 v[72:75], v[84:87], v[48:51], v[72:75]
    s_mul_i32 s86, s86, 32768
    s_add_u32 m0, s62, 106496
    v_mfma_f32_16x16x32_bf16 v[60:63], v[88:91], v[36:39], v[60:63]
    buffer_load_dwordx4 v59, s[24:27], s86 offen lds
    s_add_u32 s87, s60, 5
    v_mfma_f32_16x16x32_bf16 v[64:67], v[88:91], v[40:43], v[64:67]
    s_and_b32 s87, s87, 15
    s_mul_i32 s87, s87, 32768
    v_mfma_f32_16x16x32_bf16 v[68:71], v[88:91], v[44:47], v[68:71]
    s_add_u32 m0, s62, 110592
    s_add_u32 s86, s60, 6
    v_mfma_f32_16x16x32_bf16 v[72:75], v[88:91], v[48:51], v[72:75]
    buffer_load_dwordx4 v59, s[24:27], s87 offen lds
    s_and_b32 s86, s86, 15
    v_mfma_f32_16x16x32_bf16 v[60:63], v[92:95], v[36:39], v[60:63]
    s_mul_i32 s86, s86, 32768
    s_add_u32 m0, s62, 114688
    v_mfma_f32_16x16x32_bf16 v[64:67], v[92:95], v[40:43], v[64:67]
    buffer_load_dwordx4 v59, s[24:27], s86 offen lds
    s_add_u32 s87, s60, 7
    v_mfma_f32_16x16x32_bf16 v[68:71], v[92:95], v[44:47], v[68:71]
    s_and_b32 s87, s87, 15
    s_mul_i32 s87, s87, 32768
    v_mfma_f32_16x16x32_bf16 v[72:75], v[92:95], v[48:51], v[72:75]
    s_add_u32 m0, s62, 118784
    s_add_u32 s86, s60, 8
    v_mfma_f32_16x16x32_bf16 v[60:63], v[96:99], v[36:39], v[60:63]
    buffer_load_dwordx4 v59, s[24:27], s87 offen lds
    s_and_b32 s86, s86, 15
    v_mfma_f32_16x16x32_bf16 v[64:67], v[96:99], v[40:43], v[64:67]
    s_mul_i32 s86, s86, 32768
    s_add_u32 m0, s62, 122880
    v_mfma_f32_16x16x32_bf16 v[68:71], v[96:99], v[44:47], v[68:71]
    buffer_load_dwordx4 v59, s[24:27], s86 offen lds
    s_add_u32 s87, s60, 9
    v_mfma_f32_16x16x32_bf16 v[72:75], v[96:99], v[48:51], v[72:75]
    s_and_b32 s87, s87, 15
    s_mul_i32 s87, s87, 32768
    v_mfma_f32_16x16x32_bf16 v[60:63], v[100:103], v[36:39], v[60:63]
    s_add_u32 m0, s62, 126976
    s_add_u32 s86, s60, 10
    v_mfma_f32_16x16x32_bf16 v[64:67], v[100:103], v[40:43], v[64:67]
    buffer_load_dwordx4 v59, s[24:27], s87 offen lds
    s_and_b32 s86, s86, 15
    v_mfma_f32_16x16x32_bf16 v[68:71], v[100:103], v[44:47], v[68:71]
    s_mul_i32 s86, s86, 32768
    s_add_u32 m0, s62, 131072
    v_mfma_f32_16x16x32_bf16 v[72:75], v[100:103], v[48:51], v[72:75]
    buffer_load_dwordx4 v59, s[24:27], s86 offen lds
    s_add_u32 s87, s60, 11
    v_mfma_f32_16x16x32_bf16 v[60:63], v[104:107], v[36:39], v[60:63]
    s_and_b32 s87, s87, 15
    s_mul_i32 s87, s87, 32768
    v_mfma_f32_16x16x32_bf16 v[64:67], v[104:107], v[40:43], v[64:67]
    s_add_u32 m0, s62, 135168
    s_add_u32 s86, s60, 12
    v_mfma_f32_16x16x32_bf16 v[68:71], v[104:107], v[44:47], v[68:71]
    buffer_load_dwordx4 v59, s[24:27], s87 offen lds
    s_and_b32 s86, s86, 15
    v_mfma_f32_16x16x32_bf16 v[72:75], v[104:107], v[48:51], v[72:75]
    s_mul_i32 s86, s86, 32768
    s_add_u32 m0, s62, 139264
    s_add_u32 s87, s60, 13
    s_and_b32 s87, s87, 15
    buffer_load_dwordx4 v59, s[24:27], s86 offen lds
    s_mul_i32 s87, s87, 32768
    s_add_u32 m0, s62, 143360
    s_add_u32 s86, s60, 14
    s_and_b32 s86, s86, 15
    s_mul_i32 s86, s86, 32768
    v_add_f32_dpp v108, v108, v108 quad_perm:[1,0,3,2] row_mask:0xf bank_mask:0xf
    v_add_f32_dpp v109, v109, v109 quad_perm:[1,0,3,2] row_mask:0xf bank_mask:0xf
    buffer_load_dwordx4 v59, s[24:27], s87 offen lds
    s_add_u32 m0, s62, 147456
    s_add_u32 s87, s60, 15
    s_and_b32 s87, s87, 15
    s_mul_i32 s87, s87, 32768
    v_add_f32_dpp v110, v110, v110 quad_perm:[1,0,3,2] row_mask:0xf bank_mask:0xf
    v_add_f32_dpp v111, v111, v111 quad_perm:[1,0,3,2] row_mask:0xf bank_mask:0xf
    v_add_f32_dpp v108, v108, v108 quad_perm:[2,3,0,1] row_mask:0xf bank_mask:0xf
    buffer_load_dwordx4 v59, s[24:27], s86 offen lds
    s_add_u32 m0, s62, 151552
    v_add_f32_dpp v109, v109, v109 quad_perm:[2,3,0,1] row_mask:0xf bank_mask:0xf
    v_add_f32_dpp v110, v110, v110 quad_perm:[2,3,0,1] row_mask:0xf bank_mask:0xf
    v_add_f32_dpp v111, v111, v111 quad_perm:[2,3,0,1] row_mask:0xf bank_mask:0xf
    v_add_f32_dpp v108, v108, v108 row_half_mirror row_mask:0xf bank_mask:0xf
    v_add_f32_dpp v109, v109, v109 row_half_mirror row_mask:0xf bank_mask:0xf
    v_add_f32_dpp v110, v110, v110 row_half_mirror row_mask:0xf bank_mask:0xf
    buffer_load_dwordx4 v59, s[24:27], s87 offen lds
    v_add_f32_dpp v111, v111, v111 row_half_mirror row_mask:0xf bank_mask:0xf
    v_cvt_pk_bf16_f32 v108, v108, v109
    v_cvt_pk_bf16_f32 v109, v110, v111
    v_mov_b32 v110, v108
    v_mov_b32 v111, v109
    s_nop 0
    v_mov_b32_dpp v110, v108 row_ror:8 row_mask:0xf bank_mask:0x3
    v_mov_b32_dpp v111, v109 row_ror:8 row_mask:0xf bank_mask:0x3
    v_mov_b32_dpp v108, v108 row_ror:8 row_mask:0xf bank_mask:0xc
    v_mov_b32_dpp v109, v109 row_ror:8 row_mask:0xf bank_mask:0xc
    s_nop 1
    v_mfma_f32_16x16x32_bf16 v[112:115], v[108:111], v[36:39], 0
    v_mfma_f32_16x16x32_bf16 v[116:119], v[108:111], v[40:43], 0
    v_mfma_f32_16x16x32_bf16 v[120:123], v[108:111], v[44:47], 0
    s_nop 5
    v_add_f32 v112, 0x358637bd, v112
    v_rcp_f32 v112, v112
    v_mfma_f32_16x16x32_bf16 v[124:127], v[108:111], v[48:51], 0
    v_add_f32 v116, 0x358637bd, v116
    v_rcp_f32 v116, v116
    v_add_f32 v120, 0x358637bd, v120
    v_rcp_f32 v120, v120
    v_pk_mul_f32 v[60:61], v[60:61], v[112:113] op_sel_hi:[1,0]
    v_pk_mul_f32 v[62:63], v[62:63], v[112:113] op_sel_hi:[1,0]
    s_nop 1
    v_add_f32 v124, 0x358637bd, v124
    v_rcp_f32 v124, v124
    v_cvt_pk_bf16_f32 v28, v60, v61
    v_cvt_pk_bf16_f32 v29, v62, v63
    v_pk_mul_f32 v[64:65], v[64:65], v[116:117] op_sel_hi:[1,0]
    v_pk_mul_f32 v[66:67], v[66:67], v[116:117] op_sel_hi:[1,0]
    v_cvt_pk_bf16_f32 v30, v64, v65
    v_cvt_pk_bf16_f32 v31, v66, v67
    v_pk_mul_f32 v[68:69], v[68:69], v[120:121] op_sel_hi:[1,0]
    v_pk_mul_f32 v[70:71], v[70:71], v[120:121] op_sel_hi:[1,0]
    v_cvt_pk_bf16_f32 v32, v68, v69
    v_cvt_pk_bf16_f32 v33, v70, v71
    v_pk_mul_f32 v[72:73], v[72:73], v[124:125] op_sel_hi:[1,0]
    v_pk_mul_f32 v[74:75], v[74:75], v[124:125] op_sel_hi:[1,0]
    v_cvt_pk_bf16_f32 v34, v72, v73
    v_cvt_pk_bf16_f32 v35, v74, v75
    v_permlane16_swap_b32 v28, v30
    v_permlane16_swap_b32 v29, v31
    v_permlane16_swap_b32 v32, v34
    v_permlane16_swap_b32 v33, v35
    s_cmp_eq_u32 s48, 0
    s_cbranch_scc1 L29
    buffer_store_dwordx4 v[28:31], v22, s[36:39], s64 offen
    buffer_store_dwordx4 v[32:35], v22, s[36:39], s65 offen
L30:
    v_mov_b32 v23, 4
    v_lshrrev_b32 v58, 4, v0
    v_lshrrev_b32 v124, 4, v58
    v_mul_u32_u24 v124, 1024, v124
    v_bfe_u32 v59, v58, 2, 2
    v_lshl_add_u32 v124, v59, 7, v124
    v_and_b32 v59, 3, v58
    v_lshl_add_u32 v124, v59, 3, v124
    v_bfe_u32 v59, v58, 3, 2
    v_lshl_add_u32 v124, v59, 5, v124
    v_add_u32 v124, 90112, v124
    v_xor_b32 v125, 32, v124
    v_xor_b32 v126, 64, v124
    v_xor_b32 v127, 96, v124
    v_permlane16_swap_b32 v2, v4
    v_permlane16_swap_b32 v3, v5
    v_permlane16_swap_b32 v6, v8
    v_permlane16_swap_b32 v7, v9
    v_lshlrev_b32 v12, 16, v2
    v_and_b32 v13, 0xffff0000, v2
    v_lshlrev_b32 v14, 16, v3
    v_and_b32 v15, 0xffff0000, v3
    v_lshlrev_b32 v16, 16, v4
    v_and_b32 v17, 0xffff0000, v4
    v_lshlrev_b32 v18, 16, v5
    v_and_b32 v19, 0xffff0000, v5
    v_lshlrev_b32 v20, 16, v6
    v_and_b32 v21, 0xffff0000, v6
    v_lshlrev_b32 v22, 16, v7
    v_lshlrev_b32 v24, 16, v8
    v_and_b32 v25, 0xffff0000, v8
    v_lshlrev_b32 v26, 16, v9
    v_and_b32 v27, 0xffff0000, v9
    v_lshrrev_b32 v60, 2, v0
    v_and_b32 v60, 0x7c, v60
    s_waitcnt vmcnt(0)
    s_cmp_eq_u32 s48, 0
    s_cbranch_scc1 L31
    buffer_store_dword v23, off, s[36:39], s74
L32:
    v_and_b32 v23, 0xffff0000, v7
    s_barrier
    ds_read_b64_tr_b16 v[28:29], v124 offset:0
    ds_read_b64_tr_b16 v[30:31], v124 offset:512
    ds_read_b64_tr_b16 v[32:33], v125 offset:0
    ds_read_b64_tr_b16 v[34:35], v125 offset:512
    ds_read_b64_tr_b16 v[36:37], v126 offset:0
    ds_read_b64_tr_b16 v[38:39], v126 offset:512
    ds_read_b64_tr_b16 v[40:41], v127 offset:0
    ds_read_b64_tr_b16 v[42:43], v127 offset:512
    ds_read_b64_tr_b16 v[44:45], v124 offset:4096
    ds_read_b64_tr_b16 v[46:47], v124 offset:4608
    ds_read_b64_tr_b16 v[48:49], v125 offset:4096
    ds_read_b64_tr_b16 v[50:51], v125 offset:4608
    ds_read_b64_tr_b16 v[52:53], v126 offset:4096
    ds_read_b64_tr_b16 v[54:55], v126 offset:4608
    ds_read_b64_tr_b16 v[56:57], v127 offset:4096
    ds_read_b64_tr_b16 v[58:59], v127 offset:4608
L33:
    buffer_load_dword v61, v60, s[36:39], s75 offen sc1
    s_sub_u32 s49, s49, 1
    s_cbranch_scc1 L_end
    s_waitcnt vmcnt(0)
    v_cmp_gt_u32 vcc, 4, v61
    s_cbranch_vccnz L33
    buffer_load_dwordx4 v[60:63], v0, s[36:39], s66 offen offset:0 sc1
    buffer_load_dwordx4 v[64:67], v0, s[36:39], s66 offen offset:1024 sc1
    buffer_load_dwordx4 v[68:71], v0, s[36:39], s66 offen offset:2048 sc1
    buffer_load_dwordx4 v[72:75], v0, s[36:39], s66 offen offset:3072 sc1
    buffer_load_dwordx4 v[76:79], v0, s[36:39], s67 offen offset:0 sc1
    buffer_load_dwordx4 v[80:83], v0, s[36:39], s67 offen offset:1024 sc1
    buffer_load_dwordx4 v[84:87], v0, s[36:39], s67 offen offset:2048 sc1
    buffer_load_dwordx4 v[88:91], v0, s[36:39], s67 offen offset:3072 sc1
    buffer_load_dwordx4 v[92:95], v0, s[36:39], s68 offen offset:0 sc1
    buffer_load_dwordx4 v[96:99], v0, s[36:39], s68 offen offset:1024 sc1
    s_waitcnt vmcnt(9) lgkmcnt(0)
    v_mfma_f32_16x16x32_bf16 v[12:15], v[28:31], v[60:63], v[12:15]
    buffer_load_dwordx4 v[100:103], v0, s[36:39], s68 offen offset:2048 sc1
    ds_read_b64_tr_b16 v[28:29], v124 offset:8192
    v_mfma_f32_16x16x32_bf16 v[16:19], v[32:35], v[60:63], v[16:19]
    ds_read_b64_tr_b16 v[30:31], v124 offset:8704
    ds_read_b64_tr_b16 v[32:33], v125 offset:8192
    v_mfma_f32_16x16x32_bf16 v[20:23], v[36:39], v[60:63], v[20:23]
    ds_read_b64_tr_b16 v[34:35], v125 offset:8704
    ds_read_b64_tr_b16 v[36:37], v126 offset:8192
    v_mfma_f32_16x16x32_bf16 v[24:27], v[40:43], v[60:63], v[24:27]
    buffer_load_dwordx4 v[104:107], v0, s[36:39], s68 offen offset:3072 sc1
    ds_read_b64_tr_b16 v[38:39], v126 offset:8704
    s_waitcnt vmcnt(10)
    v_mfma_f32_16x16x32_bf16 v[12:15], v[44:47], v[64:67], v[12:15]
    ds_read_b64_tr_b16 v[40:41], v127 offset:8192
    ds_read_b64_tr_b16 v[42:43], v127 offset:8704
    v_mfma_f32_16x16x32_bf16 v[16:19], v[48:51], v[64:67], v[16:19]
    ds_read_b64_tr_b16 v[44:45], v124 offset:12288
    buffer_load_dwordx4 v[108:111], v0, s[36:39], s69 offen offset:0 sc1
    v_mfma_f32_16x16x32_bf16 v[20:23], v[52:55], v[64:67], v[20:23]
    ds_read_b64_tr_b16 v[46:47], v124 offset:12800
    ds_read_b64_tr_b16 v[48:49], v125 offset:12288
    v_mfma_f32_16x16x32_bf16 v[24:27], v[56:59], v[64:67], v[24:27]
    ds_read_b64_tr_b16 v[50:51], v125 offset:12800
    ds_read_b64_tr_b16 v[52:53], v126 offset:12288
    ds_read_b64_tr_b16 v[54:55], v126 offset:12800
    buffer_load_dwordx4 v[112:115], v0, s[36:39], s69 offen offset:1024 sc1
    ds_read_b64_tr_b16 v[56:57], v127 offset:12288
    s_waitcnt vmcnt(11) lgkmcnt(9)
    v_mfma_f32_16x16x32_bf16 v[12:15], v[28:31], v[68:71], v[12:15]
    ds_read_b64_tr_b16 v[58:59], v127 offset:12800
    ds_read_b64_tr_b16 v[28:29], v124 offset:16384
    v_mfma_f32_16x16x32_bf16 v[16:19], v[32:35], v[68:71], v[16:19]
    ds_read_b64_tr_b16 v[30:31], v124 offset:16896
    buffer_load_dwordx4 v[116:119], v0, s[36:39], s69 offen offset:2048 sc1
    v_mfma_f32_16x16x32_bf16 v[20:23], v[36:39], v[68:71], v[20:23]
    ds_read_b64_tr_b16 v[32:33], v125 offset:16384
    ds_read_b64_tr_b16 v[34:35], v125 offset:16896
    ds_read_b64_tr_b16 v[36:37], v126 offset:16384
    s_waitcnt lgkmcnt(8)
    v_mfma_f32_16x16x32_bf16 v[24:27], v[40:43], v[68:71], v[24:27]
    ds_read_b64_tr_b16 v[38:39], v126 offset:16896
    buffer_load_dwordx4 v[120:123], v0, s[36:39], s69 offen offset:3072 sc1
    ds_read_b64_tr_b16 v[40:41], v127 offset:16384
    s_waitcnt vmcnt(12)
    v_mfma_f32_16x16x32_bf16 v[12:15], v[44:47], v[72:75], v[12:15]
    ds_read_b64_tr_b16 v[42:43], v127 offset:16896
    ds_read_b64_tr_b16 v[44:45], v124 offset:20480
    v_mfma_f32_16x16x32_bf16 v[16:19], v[48:51], v[72:75], v[16:19]
    ds_read_b64_tr_b16 v[46:47], v124 offset:20992
    ds_read_b64_tr_b16 v[48:49], v125 offset:20480
    s_waitcnt lgkmcnt(7)
    v_mfma_f32_16x16x32_bf16 v[20:23], v[52:55], v[72:75], v[20:23]
    ds_read_b64_tr_b16 v[50:51], v125 offset:20992
    ds_read_b64_tr_b16 v[52:53], v126 offset:20480
    v_mfma_f32_16x16x32_bf16 v[24:27], v[56:59], v[72:75], v[24:27]
    ds_read_b64_tr_b16 v[54:55], v126 offset:20992
    ds_read_b64_tr_b16 v[56:57], v127 offset:20480
    s_waitcnt vmcnt(11)
    v_mfma_f32_16x16x32_bf16 v[12:15], v[28:31], v[76:79], v[12:15]
    ds_read_b64_tr_b16 v[58:59], v127 offset:20992
    ds_read_b64_tr_b16 v[28:29], v124 offset:24576
    v_mfma_f32_16x16x32_bf16 v[16:19], v[32:35], v[76:79], v[16:19]
    ds_read_b64_tr_b16 v[30:31], v124 offset:25088
    ds_read_b64_tr_b16 v[32:33], v125 offset:24576
    s_waitcnt lgkmcnt(8)
    v_mfma_f32_16x16x32_bf16 v[20:23], v[36:39], v[76:79], v[20:23]
    ds_read_b64_tr_b16 v[34:35], v125 offset:25088
    ds_read_b64_tr_b16 v[36:37], v126 offset:24576
    v_mfma_f32_16x16x32_bf16 v[24:27], v[40:43], v[76:79], v[24:27]
    ds_read_b64_tr_b16 v[38:39], v126 offset:25088
    ds_read_b64_tr_b16 v[40:41], v127 offset:24576
    s_waitcnt vmcnt(10)
    v_mfma_f32_16x16x32_bf16 v[12:15], v[44:47], v[80:83], v[12:15]
    ds_read_b64_tr_b16 v[42:43], v127 offset:25088
    ds_read_b64_tr_b16 v[44:45], v124 offset:28672
    s_waitcnt lgkmcnt(8)
    v_mfma_f32_16x16x32_bf16 v[16:19], v[48:51], v[80:83], v[16:19]
    ds_read_b64_tr_b16 v[46:47], v124 offset:29184
    ds_read_b64_tr_b16 v[48:49], v125 offset:28672
    v_mfma_f32_16x16x32_bf16 v[20:23], v[52:55], v[80:83], v[20:23]
    ds_read_b64_tr_b16 v[50:51], v125 offset:29184
    ds_read_b64_tr_b16 v[52:53], v126 offset:28672
    v_mfma_f32_16x16x32_bf16 v[24:27], v[56:59], v[80:83], v[24:27]
    ds_read_b64_tr_b16 v[54:55], v126 offset:29184
    ds_read_b64_tr_b16 v[56:57], v127 offset:28672
    s_waitcnt vmcnt(9) lgkmcnt(8)
    v_mfma_f32_16x16x32_bf16 v[12:15], v[28:31], v[84:87], v[12:15]
    ds_read_b64_tr_b16 v[58:59], v127 offset:29184
    ds_read_b64_tr_b16 v[28:29], v124 offset:32768
    v_mfma_f32_16x16x32_bf16 v[16:19], v[32:35], v[84:87], v[16:19]
    ds_read_b64_tr_b16 v[30:31], v124 offset:33280
    ds_read_b64_tr_b16 v[32:33], v125 offset:32768
    v_mfma_f32_16x16x32_bf16 v[20:23], v[36:39], v[84:87], v[20:23]
    ds_read_b64_tr_b16 v[34:35], v125 offset:33280
    ds_read_b64_tr_b16 v[36:37], v126 offset:32768
    s_waitcnt lgkmcnt(8)
    v_mfma_f32_16x16x32_bf16 v[24:27], v[40:43], v[84:87], v[24:27]
    ds_read_b64_tr_b16 v[38:39], v126 offset:33280
    ds_read_b64_tr_b16 v[40:41], v127 offset:32768
    s_waitcnt vmcnt(8)
    v_mfma_f32_16x16x32_bf16 v[12:15], v[44:47], v[88:91], v[12:15]
    ds_read_b64_tr_b16 v[42:43], v127 offset:33280
    ds_read_b64_tr_b16 v[44:45], v124 offset:36864
    v_mfma_f32_16x16x32_bf16 v[16:19], v[48:51], v[88:91], v[16:19]
    ds_read_b64_tr_b16 v[46:47], v124 offset:37376
    ds_read_b64_tr_b16 v[48:49], v125 offset:36864
    s_waitcnt lgkmcnt(8)
    v_mfma_f32_16x16x32_bf16 v[20:23], v[52:55], v[88:91], v[20:23]
    ds_read_b64_tr_b16 v[50:51], v125 offset:37376
    ds_read_b64_tr_b16 v[52:53], v126 offset:36864
    v_mfma_f32_16x16x32_bf16 v[24:27], v[56:59], v[88:91], v[24:27]
    ds_read_b64_tr_b16 v[54:55], v126 offset:37376
    ds_read_b64_tr_b16 v[56:57], v127 offset:36864
    s_waitcnt vmcnt(7)
    v_mfma_f32_16x16x32_bf16 v[12:15], v[28:31], v[92:95], v[12:15]
    ds_read_b64_tr_b16 v[58:59], v127 offset:37376
    ds_read_b64_tr_b16 v[28:29], v124 offset:40960
    s_waitcnt lgkmcnt(8)
    v_mfma_f32_16x16x32_bf16 v[16:19], v[32:35], v[92:95], v[16:19]
    ds_read_b64_tr_b16 v[30:31], v124 offset:41472
    ds_read_b64_tr_b16 v[32:33], v125 offset:40960
    v_mfma_f32_16x16x32_bf16 v[20:23], v[36:39], v[92:95], v[20:23]
    ds_read_b64_tr_b16 v[34:35], v125 offset:41472
    ds_read_b64_tr_b16 v[36:37], v126 offset:40960
    v_mfma_f32_16x16x32_bf16 v[24:27], v[40:43], v[92:95], v[24:27]
    ds_read_b64_tr_b16 v[38:39], v126 offset:41472
    ds_read_b64_tr_b16 v[40:41], v127 offset:40960
    s_waitcnt vmcnt(6) lgkmcnt(8)
    v_mfma_f32_16x16x32_bf16 v[12:15], v[44:47], v[96:99], v[12:15]
    ds_read_b64_tr_b16 v[42:43], v127 offset:41472
    ds_read_b64_tr_b16 v[44:45], v124 offset:45056
    v_mfma_f32_16x16x32_bf16 v[16:19], v[48:51], v[96:99], v[16:19]
    ds_read_b64_tr_b16 v[46:47], v124 offset:45568
    ds_read_b64_tr_b16 v[48:49], v125 offset:45056
    v_mfma_f32_16x16x32_bf16 v[20:23], v[52:55], v[96:99], v[20:23]
    ds_read_b64_tr_b16 v[50:51], v125 offset:45568
    ds_read_b64_tr_b16 v[52:53], v126 offset:45056
    v_and_b32 v92, 0xf0, v0
    s_waitcnt lgkmcnt(8)
    v_mfma_f32_16x16x32_bf16 v[24:27], v[56:59], v[96:99], v[24:27]
    ds_read_b64_tr_b16 v[54:55], v126 offset:45568
    ds_read_b64_tr_b16 v[56:57], v127 offset:45056
    s_waitcnt vmcnt(5)
    v_mfma_f32_16x16x32_bf16 v[12:15], v[28:31], v[100:103], v[12:15]
    ds_read_b64_tr_b16 v[58:59], v127 offset:45568
    ds_read_b64_tr_b16 v[28:29], v124 offset:49152
    v_mfma_f32_16x16x32_bf16 v[16:19], v[32:35], v[100:103], v[16:19]
    ds_read_b64_tr_b16 v[30:31], v124 offset:49664
    ds_read_b64_tr_b16 v[32:33], v125 offset:49152
    s_waitcnt lgkmcnt(8)
    v_mfma_f32_16x16x32_bf16 v[20:23], v[36:39], v[100:103], v[20:23]
    ds_read_b64_tr_b16 v[34:35], v125 offset:49664
    ds_read_b64_tr_b16 v[36:37], v126 offset:49152
    v_mfma_f32_16x16x32_bf16 v[24:27], v[40:43], v[100:103], v[24:27]
    ds_read_b64_tr_b16 v[38:39], v126 offset:49664
    ds_read_b64_tr_b16 v[40:41], v127 offset:49152
    s_waitcnt vmcnt(4)
    v_mfma_f32_16x16x32_bf16 v[12:15], v[44:47], v[104:107], v[12:15]
    ds_read_b64_tr_b16 v[42:43], v127 offset:49664
    ds_read_b64_tr_b16 v[44:45], v124 offset:53248
    s_waitcnt lgkmcnt(8)
    v_mfma_f32_16x16x32_bf16 v[16:19], v[48:51], v[104:107], v[16:19]
    ds_read_b64_tr_b16 v[46:47], v124 offset:53760
    ds_read_b64_tr_b16 v[48:49], v125 offset:53248
    v_mfma_f32_16x16x32_bf16 v[20:23], v[52:55], v[104:107], v[20:23]
    ds_read_b64_tr_b16 v[50:51], v125 offset:53760
    ds_read_b64_tr_b16 v[52:53], v126 offset:53248
    v_bfe_u32 v96, v0, 8, 1
    v_mfma_f32_16x16x32_bf16 v[24:27], v[56:59], v[104:107], v[24:27]
    ds_read_b64_tr_b16 v[54:55], v126 offset:53760
    ds_read_b64_tr_b16 v[56:57], v127 offset:53248
    s_waitcnt vmcnt(3) lgkmcnt(8)
    v_mfma_f32_16x16x32_bf16 v[12:15], v[28:31], v[108:111], v[12:15]
    ds_read_b64_tr_b16 v[58:59], v127 offset:53760
    ds_read_b64_tr_b16 v[28:29], v124 offset:57344
    v_mfma_f32_16x16x32_bf16 v[16:19], v[32:35], v[108:111], v[16:19]
    ds_read_b64_tr_b16 v[30:31], v124 offset:57856
    ds_read_b64_tr_b16 v[32:33], v125 offset:57344
    v_mfma_f32_16x16x32_bf16 v[20:23], v[36:39], v[108:111], v[20:23]
    ds_read_b64_tr_b16 v[34:35], v125 offset:57856
    ds_read_b64_tr_b16 v[36:37], v126 offset:57344
    v_lshl_add_u32 v92, v96, 9, v92
    s_waitcnt lgkmcnt(8)
    v_mfma_f32_16x16x32_bf16 v[24:27], v[40:43], v[108:111], v[24:27]
    ds_read_b64_tr_b16 v[38:39], v126 offset:57856
    ds_read_b64_tr_b16 v[40:41], v127 offset:57344
    s_waitcnt vmcnt(2)
    v_mfma_f32_16x16x32_bf16 v[12:15], v[44:47], v[112:115], v[12:15]
    ds_read_b64_tr_b16 v[42:43], v127 offset:57856
    ds_read_b64_tr_b16 v[44:45], v124 offset:61440
    v_mfma_f32_16x16x32_bf16 v[16:19], v[48:51], v[112:115], v[16:19]
    ds_read_b64_tr_b16 v[46:47], v124 offset:61952
    ds_read_b64_tr_b16 v[48:49], v125 offset:61440
    s_waitcnt lgkmcnt(8)
    v_mfma_f32_16x16x32_bf16 v[20:23], v[52:55], v[112:115], v[20:23]
    ds_read_b64_tr_b16 v[50:51], v125 offset:61952
    ds_read_b64_tr_b16 v[52:53], v126 offset:61440
    v_mfma_f32_16x16x32_bf16 v[24:27], v[56:59], v[112:115], v[24:27]
    ds_read_b64_tr_b16 v[54:55], v126 offset:61952
    ds_read_b64_tr_b16 v[56:57], v127 offset:61440
    s_waitcnt vmcnt(1)
    v_mfma_f32_16x16x32_bf16 v[12:15], v[28:31], v[116:119], v[12:15]
    ds_read_b64_tr_b16 v[58:59], v127 offset:61952
    v_lshrrev_b32 v96, 9, v0
    s_waitcnt lgkmcnt(7)
    v_mfma_f32_16x16x32_bf16 v[16:19], v[32:35], v[116:119], v[16:19]
    v_lshl_add_u32 v92, v96, 8, v92
    v_bfe_u32 v93, v0, 4, 4
    v_mfma_f32_16x16x32_bf16 v[20:23], v[36:39], v[116:119], v[20:23]
    v_lshlrev_b32 v93, 2, v93
    v_lshl_add_u32 v93, v96, 6, v93
    v_mov_b32 v98, 5
    v_mfma_f32_16x16x32_bf16 v[24:27], v[40:43], v[116:119], v[24:27]
    s_waitcnt vmcnt(0) lgkmcnt(1)
    v_mfma_f32_16x16x32_bf16 v[12:15], v[44:47], v[120:123], v[12:15]
    v_mfma_f32_16x16x32_bf16 v[16:19], v[48:51], v[120:123], v[16:19]
    v_mfma_f32_16x16x32_bf16 v[20:23], v[52:55], v[120:123], v[20:23]
    s_nop 5
    v_cvt_pk_bf16_f32 v2, v12, v13
    v_cvt_pk_bf16_f32 v3, v14, v15
    s_waitcnt lgkmcnt(0)
    v_mfma_f32_16x16x32_bf16 v[24:27], v[56:59], v[120:123], v[24:27]
    v_cvt_pk_bf16_f32 v4, v16, v17
    v_cvt_pk_bf16_f32 v5, v18, v19
    v_cvt_pk_bf16_f32 v6, v20, v21
    v_cvt_pk_bf16_f32 v7, v22, v23
    v_permlane16_swap_b32 v2, v4
    v_permlane16_swap_b32 v3, v5
    s_nop 1
    v_cvt_pk_bf16_f32 v8, v24, v25
    v_cvt_pk_bf16_f32 v9, v26, v27
    v_dot2_f32_bf16 v94, v2, s50, 0
    v_permlane16_swap_b32 v6, v8
    v_permlane16_swap_b32 v7, v9
    s_cmp_eq_u32 s48, 0
    s_cbranch_scc1 L34
    buffer_store_dwordx4 v[2:5], v92, s[36:39], s70 offen
    buffer_store_dwordx4 v[6:9], v92, s[36:39], s71 offen
L35:
    v_dot2_f32_bf16 v95, v2, v2, 0
    v_dot2_f32_bf16 v94, v3, s50, v94
    v_dot2_f32_bf16 v95, v3, v3, v95
    v_dot2_f32_bf16 v94, v4, s50, v94
    v_dot2_f32_bf16 v95, v4, v4, v95
    v_dot2_f32_bf16 v94, v5, s50, v94
    v_dot2_f32_bf16 v95, v5, v5, v95
    v_dot2_f32_bf16 v94, v6, s50, v94
    v_dot2_f32_bf16 v95, v6, v6, v95
    v_dot2_f32_bf16 v94, v7, s50, v94
    v_dot2_f32_bf16 v95, v7, v7, v95
    v_dot2_f32_bf16 v94, v8, s50, v94
    v_dot2_f32_bf16 v95, v8, v8, v95
    v_dot2_f32_bf16 v94, v9, s50, v94
    v_dot2_f32_bf16 v95, v9, v9, v95
    s_nop 2
    v_permlane32_swap_b32 v94, v95
    v_add_f32 v94, v94, v95
    v_mov_b32 v95, v94
    s_nop 1
    v_permlane16_swap_b32 v94, v95
    v_add_f32 v94, v94, v95
    s_cmp_eq_u32 s48, 0
    s_cbranch_scc1 L36
    buffer_store_dword v94, v93, s[36:39], s72 offen
L37:
    s_waitcnt vmcnt(0)
    s_cmp_eq_u32 s48, 0
    s_cbranch_scc1 L38
    buffer_store_dword v98, off, s[36:39], s74
L39:
    v_lshrrev_b32 v13, 2, v0
    v_and_b32 v13, 0x7c, v13
    v_bfe_u32 v15, v0, 4, 4
    v_lshlrev_b32 v15, 2, v15
    v_bfe_u32 v16, v0, 8, 1
    v_lshl_add_u32 v16, v16, 6, v15
    v_lshrrev_b32 v17, 9, v0
    v_lshl_add_u32 v16, v17, 9, v16
    s_add_u32 s88, s5, 1
    s_lshr_b32 s89, s88, 2
    s_sub_u32 s89, s4, s89
    s_and_b32 s89, s89, 7
    s_lshl_b32 s89, s89, 11
    s_lshl_b32 s90, s88, 14
    s_add_u32 s90, s90, s89
    s_lshl_b32 s89, s3, 6
    s_and_b32 s89, s89, 128
    s_add_u32 s90, s90, s89
    s_add_u32 s90, s90, 8388480
    s_lshl_b32 s91, s88, 10
    s_lshl_b32 s88, s4, 7
    s_add_u32 s91, s91, s88
    s_lshr_b32 s89, s89, 2
    s_add_u32 s91, s91, s89
    s_add_u32 s91, s91, 8929248
    s_bitcmp1_b32 s3, 0
    s_cselect_b32 s90, s90, 0x7ff00000
    s_cselect_b32 s91, s91, 0x7ff00000
L40:
    buffer_load_dword v21, v13, s[36:39], s75 offen sc1
    s_sub_u32 s49, s49, 1
    s_cbranch_scc1 L_end
    s_waitcnt vmcnt(0)
    v_cmp_gt_u32 vcc, 5, v21
    s_cbranch_vccnz L40
    s_add_u32 m0, s78, 0
    v_lshrrev_b32 v18, 4, v0
    buffer_load_dwordx4 v0, s[44:47], m0 offen sc1 lds
    s_add_u32 m0, s78, 2048
    v_lshrrev_b32 v22, 3, v18
    s_lshl_b32 s80, s3, 3
    v_add_u32 v22, s80, v22
    v_mul_u32_u24 v22, 1024, v22
    buffer_load_dwordx4 v0, s[44:47], m0 offen sc1 lds
    s_add_u32 m0, s78, 8192
    v_bfe_u32 v19, v18, 4, 1
    s_and_b32 s81, s3, 1
    s_lshl_b32 s81, s81, 1
    v_or_b32 v19, s81, v19
    buffer_load_dwordx4 v0, s[44:47], m0 offen sc1 lds
    s_add_u32 m0, s78, 10240
    v_lshlrev_b32 v19, 1, v19
    v_and_b32 v18, 7, v18
    v_xor_b32 v18, v18, v19
    v_lshl_add_u32 v22, v18, 4, v22
    s_lshl_b32 s80, s4, 7
    v_add_u32 v22, s80, v22
    v_add_u32 v127, 159744, v0
    v_and_b32 v126, 0xf0, v0
    v_bfe_u32 v125, v0, 8, 1
    v_lshl_add_u32 v126, v125, 14, v126
    v_lshrrev_b32 v125, 9, v0
    v_lshl_add_u32 v126, v125, 8, v126
    s_lshl_b32 s97, s61, 14
    s_add_u32 s97, s97, 8323072
    v_add_u32 v19, s97, v0
    buffer_load_dwordx4 v0, s[44:47], m0 offen sc1 lds
    s_add_u32 m0, s78, 16384
    v_add_u32 v125, 65536, v0
    v_add_u32 v18, s62, v125
    s_lshl_b32 s97, s61, 10
    s_add_u32 s97, s97, 8929280
    s_lshl_b32 s98, s3, 6
    s_add_u32 s98, s98, 155648
    v_add_u32 v17, s98, v15
    s_add_u32 s86, s60, 0
    s_and_b32 s86, s86, 15
    s_mul_i32 s86, s86, 32768
    s_add_u32 s87, s60, 1
    s_and_b32 s87, s87, 15
    s_mul_i32 s87, s87, 32768
    v_lshrrev_b32 v14, 4, v0
    s_mul_i32 s82, s3, 192
    buffer_load_dwordx4 v0, s[44:47], m0 offen sc1 lds
    s_add_u32 m0, s78, 18432
    s_add_u32 s82, s82, 157184
    v_and_b32 v12, 48, v14
    v_add_u32 v12, s82, v12
    v_and_b32 v13, 15, v14
    v_lshl_add_u32 v13, v13, 2, s82
    v_mov_b32 v24, s50
    v_mov_b32 v25, s50
    v_mov_b32 v26, s50
    v_mov_b32 v27, s50
    v_lshrrev_b32 v23, 4, v0
    buffer_load_dwordx4 v0, s[44:47], m0 offen sc1 lds
    s_add_u32 m0, s78, 24576
    buffer_load_dword v116, v16, s[36:39], s73 offen offset:0 sc1
    buffer_load_dword v117, v16, s[36:39], s73 offen offset:128 sc1
    buffer_load_dword v118, v16, s[36:39], s73 offen offset:256 sc1
    buffer_load_dword v119, v16, s[36:39], s73 offen offset:384 sc1
    s_mov_b64 exec, s[54:55]
    buffer_store_dwordx4 v[2:5], v92, s[36:39], s90 offen sc1
    buffer_store_dwordx4 v[6:9], v92, s[36:39], s90 offen offset:1024 sc1
    buffer_store_dword v94, v93, s[36:39], s91 offen sc1
    s_mov_b64 exec, -1
    buffer_load_dwordx4 v0, s[44:47], m0 offen sc1 lds
    s_add_u32 m0, s78, 26624
    s_nop 0
    buffer_load_dwordx4 v0, s[44:47], m0 offen sc1 lds
    s_add_u32 m0, s78, 32768
    s_waitcnt vmcnt(13)
    s_barrier
    ds_read_b128 v[28:31], v0 offset:0
    ds_read_b128 v[32:35], v0 offset:1024
    ds_read_b128 v[36:39], v0 offset:2048
    ds_read_b128 v[40:43], v0 offset:3072
    ds_read_b128 v[44:47], v0 offset:4096
    ds_read_b128 v[48:51], v0 offset:5120
    ds_read_b128 v[52:55], v0 offset:6144
    ds_read_b128 v[56:59], v0 offset:7168
    buffer_load_dwordx4 v0, s[44:47], m0 offen sc1 lds
    s_add_u32 m0, s78, 34816
    s_waitcnt vmcnt(12)
    s_barrier
    buffer_load_dwordx4 v0, s[44:47], m0 offen sc1 lds
    s_add_u32 m0, s78, 40960
    s_waitcnt lgkmcnt(7)
    v_mfma_f32_16x16x32_bf16 v[76:79], a[4:7], v[28:31], 0
    v_mfma_f32_16x16x32_bf16 v[96:99], v[28:31], a[8:11], 0
    v_mfma_f32_16x16x32_bf16 v[60:63], a[0:3], v[28:31], 0
    ds_read_b128 v[28:31], v0 offset:8192
    s_waitcnt lgkmcnt(1)
    v_mfma_f32_16x16x32_bf16 v[80:83], a[4:7], v[32:35], 0
    buffer_load_dwordx4 v0, s[44:47], m0 offen sc1 lds
    s_add_u32 m0, s78, 43008
    v_mfma_f32_16x16x32_bf16 v[100:103], v[32:35], a[8:11], 0
    v_mfma_f32_16x16x32_bf16 v[64:67], a[0:3], v[32:35], 0
    ds_read_b128 v[32:35], v0 offset:9216
    v_mfma_f32_16x16x32_bf16 v[84:87], a[4:7], v[36:39], 0
    v_mfma_f32_16x16x32_bf16 v[104:107], v[36:39], a[8:11], 0
    buffer_load_dwordx4 v0, s[44:47], m0 offen sc1 lds
    v_mfma_f32_16x16x32_bf16 v[68:71], a[0:3], v[36:39], 0
    ds_read_b128 v[36:39], v0 offset:10240
    s_add_u32 m0, s78, 49152
    v_mfma_f32_16x16x32_bf16 v[88:91], a[4:7], v[40:43], 0
    v_mfma_f32_16x16x32_bf16 v[108:111], v[40:43], a[8:11], 0
    v_mfma_f32_16x16x32_bf16 v[72:75], a[0:3], v[40:43], 0
    ds_read_b128 v[40:43], v0 offset:11264
    v_mfma_f32_16x16x32_bf16 v[76:79], a[16:19], v[44:47], v[76:79]
    buffer_load_dwordx4 v0, s[44:47], m0 offen sc1 lds
    s_add_u32 m0, s78, 51200
    v_mfma_f32_16x16x32_bf16 v[96:99], v[44:47], a[20:23], v[96:99]
    v_mfma_f32_16x16x32_bf16 v[60:63], a[12:15], v[44:47], v[60:63]
    ds_read_b128 v[44:47], v0 offset:12288
    v_mfma_f32_16x16x32_bf16 v[80:83], a[16:19], v[48:51], v[80:83]
    v_mfma_f32_16x16x32_bf16 v[100:103], v[48:51], a[20:23], v[100:103]
    buffer_load_dwordx4 v0, s[44:47], m0 offen sc1 lds
    v_mfma_f32_16x16x32_bf16 v[64:67], a[12:15], v[48:51], v[64:67]
    ds_read_b128 v[48:51], v0 offset:13312
    s_add_u32 m0, s78, 57344
    v_mfma_f32_16x16x32_bf16 v[84:87], a[16:19], v[52:55], v[84:87]
    v_mfma_f32_16x16x32_bf16 v[104:107], v[52:55], a[20:23], v[104:107]
    v_mfma_f32_16x16x32_bf16 v[68:71], a[12:15], v[52:55], v[68:71]
    ds_read_b128 v[52:55], v0 offset:14336
    v_mfma_f32_16x16x32_bf16 v[88:91], a[16:19], v[56:59], v[88:91]
    buffer_load_dwordx4 v0, s[44:47], m0 offen sc1 lds
    s_add_u32 m0, s78, 59392
    v_mfma_f32_16x16x32_bf16 v[108:111], v[56:59], a[20:23], v[108:111]
    v_mfma_f32_16x16x32_bf16 v[72:75], a[12:15], v[56:59], v[72:75]
    ds_read_b128 v[56:59], v0 offset:15360
    s_waitcnt vmcnt(7)
    s_barrier
    s_waitcnt lgkmcnt(3)
    v_mfma_f32_16x16x32_bf16 v[76:79], a[28:31], v[28:31], v[76:79]
    v_mfma_f32_16x16x32_bf16 v[96:99], v[28:31], a[32:35], v[96:99]
    buffer_load_dwordx4 v0, s[44:47], m0 offen sc1 lds
    v_add_f32 v116, v116, v117
    v_mfma_f32_16x16x32_bf16 v[60:63], a[24:27], v[28:31], v[60:63]
    ds_read_b128 v[28:31], v0 offset:16384
    v_add_f32 v118, v118, v119
    v_mfma_f32_16x16x32_bf16 v[80:83], a[28:31], v[32:35], v[80:83]
    v_add_f32 v116, v116, v118
    v_mov_b32 v117, v116
    v_mfma_f32_16x16x32_bf16 v[100:103], v[32:35], a[32:35], v[100:103]
    s_nop 0
    v_permlane32_swap_b32 v116, v117
    v_mfma_f32_16x16x32_bf16 v[64:67], a[24:27], v[32:35], v[64:67]
    ds_read_b128 v[32:35], v0 offset:17408
    v_add_f32 v116, v116, v117
    v_mfma_f32_16x16x32_bf16 v[84:87], a[28:31], v[36:39], v[84:87]
    v_mov_b32 v117, v116
    s_add_u32 m0, s62, 90112
    v_mfma_f32_16x16x32_bf16 v[104:107], v[36:39], a[32:35], v[104:107]
    v_permlane16_swap_b32 v116, v117
    v_mfma_f32_16x16x32_bf16 v[68:71], a[24:27], v[36:39], v[68:71]
    ds_read_b128 v[36:39], v0 offset:18432
    v_mul_f32 v116, 0x3b000000, v116
    v_mfma_f32_16x16x32_bf16 v[88:91], a[28:31], v[40:43], v[88:91]
    v_mul_f32 v117, 0x3b000000, v117
    v_fma_f32 v117, -v116, v116, v117
    v_mfma_f32_16x16x32_bf16 v[108:111], v[40:43], a[32:35], v[108:111]
    v_max_f32 v117, 0, v117
    v_add_f32 v117, 0x3727c5ac, v117
    v_mfma_f32_16x16x32_bf16 v[72:75], a[24:27], v[40:43], v[72:75]
    ds_read_b128 v[40:43], v0 offset:19456
    v_rsq_f32 v117, v117
    v_mfma_f32_16x16x32_bf16 v[76:79], a[40:43], v[44:47], v[76:79]
    s_mov_b64 exec, 0xffff
    ds_write_b32 v17, v116
    ds_write_b32 v17, v117 offset:512
    s_mov_b64 exec, -1
    v_mfma_f32_16x16x32_bf16 v[96:99], v[44:47], a[44:47], v[96:99]
    v_add_u32 v17, 155904, v15
    v_mfma_f32_16x16x32_bf16 v[60:63], a[36:39], v[44:47], v[60:63]
    ds_read_b128 v[44:47], v0 offset:20480
    s_waitcnt lgkmcnt(5)
    v_mfma_f32_16x16x32_bf16 v[80:83], a[40:43], v[48:51], v[80:83]
    v_mfma_f32_16x16x32_bf16 v[100:103], v[48:51], a[44:47], v[100:103]
    v_mfma_f32_16x16x32_bf16 v[64:67], a[36:39], v[48:51], v[64:67]
    ds_read_b128 v[48:51], v0 offset:21504
    v_mfma_f32_16x16x32_bf16 v[84:87], a[40:43], v[52:55], v[84:87]
    v_mfma_f32_16x16x32_bf16 v[104:107], v[52:55], a[44:47], v[104:107]
    v_mfma_f32_16x16x32_bf16 v[68:71], a[36:39], v[52:55], v[68:71]
    ds_read_b128 v[52:55], v0 offset:22528
    v_mfma_f32_16x16x32_bf16 v[88:91], a[40:43], v[56:59], v[88:91]
    v_mfma_f32_16x16x32_bf16 v[108:111], v[56:59], a[44:47], v[108:111]
    v_mfma_f32_16x16x32_bf16 v[72:75], a[36:39], v[56:59], v[72:75]
    ds_read_b128 v[56:59], v0 offset:23552
    v_mfma_f32_16x16x32_bf16 v[76:79], a[52:55], v[28:31], v[76:79]
    v_mfma_f32_16x16x32_bf16 v[96:99], v[28:31], a[56:59], v[96:99]
    v_mfma_f32_16x16x32_bf16 v[60:63], a[48:51], v[28:31], v[60:63]
    ds_read_b128 v[28:31], v0 offset:24576
    v_mfma_f32_16x16x32_bf16 v[80:83], a[52:55], v[32:35], v[80:83]
    v_mfma_f32_16x16x32_bf16 v[100:103], v[32:35], a[56:59], v[100:103]
    v_mfma_f32_16x16x32_bf16 v[64:67], a[48:51], v[32:35], v[64:67]
    ds_read_b128 v[32:35], v0 offset:25600
    s_waitcnt lgkmcnt(3)
    v_mfma_f32_16x16x32_bf16 v[84:87], a[52:55], v[36:39], v[84:87]
    v_mfma_f32_16x16x32_bf16 v[104:107], v[36:39], a[56:59], v[104:107]
    v_mfma_f32_16x16x32_bf16 v[68:71], a[48:51], v[36:39], v[68:71]
    ds_read_b128 v[36:39], v0 offset:26624
    v_mfma_f32_16x16x32_bf16 v[88:91], a[52:55], v[40:43], v[88:91]
    v_mfma_f32_16x16x32_bf16 v[108:111], v[40:43], a[56:59], v[108:111]
    v_mfma_f32_16x16x32_bf16 v[72:75], a[48:51], v[40:43], v[72:75]
    ds_read_b128 v[40:43], v0 offset:27648
    v_mfma_f32_16x16x32_bf16 v[76:79], a[64:67], v[44:47], v[76:79]
    v_mfma_f32_16x16x32_bf16 v[96:99], v[44:47], a[68:71], v[96:99]
    v_mfma_f32_16x16x32_bf16 v[60:63], a[60:63], v[44:47], v[60:63]
    ds_read_b128 v[44:47], v0 offset:28672
    v_mfma_f32_16x16x32_bf16 v[80:83], a[64:67], v[48:51], v[80:83]
    v_mfma_f32_16x16x32_bf16 v[100:103], v[48:51], a[68:71], v[100:103]
    v_mfma_f32_16x16x32_bf16 v[64:67], a[60:63], v[48:51], v[64:67]
    ds_read_b128 v[48:51], v0 offset:29696
    v_mfma_f32_16x16x32_bf16 v[84:87], a[64:67], v[52:55], v[84:87]
    v_mfma_f32_16x16x32_bf16 v[104:107], v[52:55], a[68:71], v[104:107]
    v_mfma_f32_16x16x32_bf16 v[68:71], a[60:63], v[52:55], v[68:71]
    ds_read_b128 v[52:55], v0 offset:30720
    s_waitcnt lgkmcnt(3)
    v_mfma_f32_16x16x32_bf16 v[88:91], a[64:67], v[56:59], v[88:91]
    v_mfma_f32_16x16x32_bf16 v[108:111], v[56:59], a[68:71], v[108:111]
    v_mfma_f32_16x16x32_bf16 v[72:75], a[60:63], v[56:59], v[72:75]
    ds_read_b128 v[56:59], v0 offset:31744
    s_waitcnt vmcnt(0)
    s_barrier
    v_mfma_f32_16x16x32_bf16 v[76:79], a[76:79], v[28:31], v[76:79]
    buffer_load_dwordx4 v22, s[16:19], s86 offen lds
    s_add_u32 m0, s62, 94208
    v_mfma_f32_16x16x32_bf16 v[96:99], v[28:31], a[80:83], v[96:99]
    s_add_u32 s86, s60, 2
    s_and_b32 s86, s86, 15
    v_mfma_f32_16x16x32_bf16 v[60:63], a[72:75], v[28:31], v[60:63]
    ds_read_b128 v[28:31], v0 offset:32768
    s_mul_i32 s86, s86, 32768
    v_mfma_f32_16x16x32_bf16 v[80:83], a[76:79], v[32:35], v[80:83]
    v_mfma_f32_16x16x32_bf16 v[100:103], v[32:35], a[80:83], v[100:103]
    buffer_load_dwordx4 v22, s[16:19], s87 offen lds
    v_mfma_f32_16x16x32_bf16 v[64:67], a[72:75], v[32:35], v[64:67]
    ds_read_b128 v[32:35], v0 offset:33792
    s_add_u32 m0, s62, 98304
    v_mfma_f32_16x16x32_bf16 v[84:87], a[76:79], v[36:39], v[84:87]
    s_add_u32 s87, s60, 3
    s_and_b32 s87, s87, 15
    v_mfma_f32_16x16x32_bf16 v[104:107], v[36:39], a[80:83], v[104:107]
    s_mul_i32 s87, s87, 32768
    v_mfma_f32_16x16x32_bf16 v[68:71], a[72:75], v[36:39], v[68:71]
    ds_read_b128 v[36:39], v0 offset:34816
    v_mfma_f32_16x16x32_bf16 v[88:91], a[76:79], v[40:43], v[88:91]
    buffer_load_dwordx4 v22, s[16:19], s86 offen lds
    s_add_u32 m0, s62, 102400
    v_mfma_f32_16x16x32_bf16 v[108:111], v[40:43], a[80:83], v[108:111]
    s_add_u32 s86, s60, 4
    s_and_b32 s86, s86, 15
    v_mfma_f32_16x16x32_bf16 v[72:75], a[72:75], v[40:43], v[72:75]
    ds_read_b128 v[40:43], v0 offset:35840
    s_mul_i32 s86, s86, 32768
    s_waitcnt lgkmcnt(3)
    v_mfma_f32_16x16x32_bf16 v[76:79], a[88:91], v[44:47], v[76:79]
    v_mfma_f32_16x16x32_bf16 v[96:99], v[44:47], a[92:95], v[96:99]
    buffer_load_dwordx4 v22, s[16:19], s87 offen lds
    s_add_u32 m0, s62, 106496
    v_mfma_f32_16x16x32_bf16 v[60:63], a[84:87], v[44:47], v[60:63]
    ds_read_b128 v[44:47], v0 offset:36864
    s_add_u32 s87, s60, 5
    v_mfma_f32_16x16x32_bf16 v[80:83], a[88:91], v[48:51], v[80:83]
    s_and_b32 s87, s87, 15
    s_mul_i32 s87, s87, 32768
    v_mfma_f32_16x16x32_bf16 v[100:103], v[48:51], a[92:95], v[100:103]
    v_mfma_f32_16x16x32_bf16 v[64:67], a[84:87], v[48:51], v[64:67]
    ds_read_b128 v[48:51], v0 offset:37888
    buffer_load_dwordx4 v22, s[16:19], s86 offen lds
    v_mfma_f32_16x16x32_bf16 v[84:87], a[88:91], v[52:55], v[84:87]
    s_add_u32 m0, s62, 110592
    s_add_u32 s86, s60, 6
    v_mfma_f32_16x16x32_bf16 v[104:107], v[52:55], a[92:95], v[104:107]
    s_and_b32 s86, s86, 15
    s_mul_i32 s86, s86, 32768
    v_mfma_f32_16x16x32_bf16 v[68:71], a[84:87], v[52:55], v[68:71]
    ds_read_b128 v[52:55], v0 offset:38912
    v_mfma_f32_16x16x32_bf16 v[88:91], a[88:91], v[56:59], v[88:91]
    v_mfma_f32_16x16x32_bf16 v[108:111], v[56:59], a[92:95], v[108:111]
    buffer_load_dwordx4 v22, s[16:19], s87 offen lds
    s_add_u32 m0, s62, 114688
    v_mfma_f32_16x16x32_bf16 v[72:75], a[84:87], v[56:59], v[72:75]
    ds_read_b128 v[56:59], v0 offset:39936
    s_barrier
    v_mfma_f32_16x16x32_bf16 v[76:79], a[100:103], v[28:31], v[76:79]
    ds_read_b128 v[116:119], v12
    ds_read_b128 v[120:123], v12 offset:64
    v_mfma_f32_16x16x32_bf16 v[96:99], v[28:31], a[104:107], v[96:99]
    ds_read_b32 v124, v13 offset:128
    s_add_u32 s87, s60, 7
    v_mfma_f32_16x16x32_bf16 v[60:63], a[96:99], v[28:31], v[60:63]
    ds_read_b128 v[28:31], v0 offset:40960
    buffer_load_dwordx4 v22, s[16:19], s86 offen lds
    s_waitcnt lgkmcnt(6)
    v_mfma_f32_16x16x32_bf16 v[80:83], a[100:103], v[32:35], v[80:83]
    s_and_b32 s87, s87, 15
    s_mul_i32 s87, s87, 32768
    v_mfma_f32_16x16x32_bf16 v[100:103], v[32:35], a[104:107], v[100:103]
    s_add_u32 m0, s62, 118784
    s_add_u32 s86, s60, 8
    v_mfma_f32_16x16x32_bf16 v[64:67], a[96:99], v[32:35], v[64:67]
    ds_read_b128 v[32:35], v0 offset:41984
    s_and_b32 s86, s86, 15
    v_mfma_f32_16x16x32_bf16 v[84:87], a[100:103], v[36:39], v[84:87]
    s_mul_i32 s86, s86, 32768
    buffer_load_dwordx4 v22, s[16:19], s87 offen lds
    v_mfma_f32_16x16x32_bf16 v[104:107], v[36:39], a[104:107], v[104:107]
    s_add_u32 m0, s62, 65536
    s_add_u32 s87, s60, 9
    v_mfma_f32_16x16x32_bf16 v[68:71], a[96:99], v[36:39], v[68:71]
    ds_read_b128 v[36:39], v0 offset:43008
    s_and_b32 s87, s87, 15
    v_mfma_f32_16x16x32_bf16 v[88:91], a[100:103], v[40:43], v[88:91]
    s_mul_i32 s87, s87, 32768
    v_mfma_f32_16x16x32_bf16 v[108:111], v[40:43], a[104:107], v[108:111]
    v_mfma_f32_16x16x32_bf16 v[72:75], a[96:99], v[40:43], v[72:75]
    buffer_load_dwordx4 v19, s[36:39], m0 offen sc1 lds
    ds_read_b128 v[40:43], v0 offset:44032
    v_mfma_f32_16x16x32_bf16 v[76:79], a[112:115], v[44:47], v[76:79]
    s_add_u32 m0, s62, 69632
    v_mfma_f32_16x16x32_bf16 v[96:99], v[44:47], a[116:119], v[96:99]
    buffer_load_dwordx4 v19, s[36:39], m0 offen sc1 lds
    s_add_u32 m0, s62, 73728
    v_mfma_f32_16x16x32_bf16 v[60:63], a[108:111], v[44:47], v[60:63]
    ds_read_b128 v[44:47], v0 offset:45056
    v_mfma_f32_16x16x32_bf16 v[80:83], a[112:115], v[48:51], v[80:83]
    buffer_load_dwordx4 v19, s[36:39], m0 offen sc1 lds
    s_add_u32 m0, s62, 77824
    v_mfma_f32_16x16x32_bf16 v[100:103], v[48:51], a[116:119], v[100:103]
    v_mfma_f32_16x16x32_bf16 v[64:67], a[108:111], v[48:51], v[64:67]
    buffer_load_dwordx4 v19, s[36:39], m0 offen sc1 lds
    ds_read_b128 v[48:51], v0 offset:46080
    s_waitcnt lgkmcnt(3)
    v_mfma_f32_16x16x32_bf16 v[84:87], a[112:115], v[52:55], v[84:87]
    s_add_u32 m0, s62, 122880
    buffer_load_dword v112, v16, s[36:39], s97 offen offset:0 sc1
    v_mfma_f32_16x16x32_bf16 v[104:107], v[52:55], a[116:119], v[104:107]
    buffer_load_dword v113, v16, s[36:39], s97 offen offset:128 sc1
    v_mfma_f32_16x16x32_bf16 v[68:71], a[108:111], v[52:55], v[68:71]
    buffer_load_dword v114, v16, s[36:39], s97 offen offset:256 sc1
    ds_read_b128 v[52:55], v0 offset:47104
    v_mfma_f32_16x16x32_bf16 v[88:91], a[112:115], v[56:59], v[88:91]
    buffer_load_dword v115, v16, s[36:39], s97 offen offset:384 sc1
    v_mfma_f32_16x16x32_bf16 v[108:111], v[56:59], a[116:119], v[108:111]
    buffer_load_dwordx4 v22, s[16:19], s86 offen lds
    s_add_u32 m0, s62, 126976
    v_mfma_f32_16x16x32_bf16 v[72:75], a[108:111], v[56:59], v[72:75]
    ds_read_b128 v[56:59], v0 offset:48128
    s_add_u32 s86, s60, 10
    v_mfma_f32_16x16x32_bf16 v[76:79], a[124:127], v[28:31], v[76:79]
    s_and_b32 s86, s86, 15
    s_mul_i32 s86, s86, 32768
    v_mfma_f32_16x16x32_bf16 v[96:99], v[28:31], a[128:131], v[96:99]
    v_mfma_f32_16x16x32_bf16 v[60:63], a[120:123], v[28:31], v[60:63]
    ds_read_b128 v[28:31], v0 offset:49152
    buffer_load_dwordx4 v22, s[16:19], s87 offen lds
    v_mfma_f32_16x16x32_bf16 v[80:83], a[124:127], v[32:35], v[80:83]
    s_add_u32 m0, s62, 131072
    s_add_u32 s87, s60, 11
    v_mfma_f32_16x16x32_bf16 v[100:103], v[32:35], a[128:131], v[100:103]
    s_and_b32 s87, s87, 15
    s_mul_i32 s87, s87, 32768
    v_mfma_f32_16x16x32_bf16 v[64:67], a[120:123], v[32:35], v[64:67]
    ds_read_b128 v[32:35], v0 offset:50176
    v_mfma_f32_16x16x32_bf16 v[84:87], a[124:127], v[36:39], v[84:87]
    v_mfma_f32_16x16x32_bf16 v[104:107], v[36:39], a[128:131], v[104:107]
    buffer_load_dwordx4 v22, s[16:19], s86 offen lds
    s_add_u32 m0, s62, 135168
    v_mfma_f32_16x16x32_bf16 v[68:71], a[120:123], v[36:39], v[68:71]
    ds_read_b128 v[36:39], v0 offset:51200
    s_add_u32 s86, s60, 12
    s_waitcnt lgkmcnt(3)
    v_mfma_f32_16x16x32_bf16 v[88:91], a[124:127], v[40:43], v[88:91]
    s_and_b32 s86, s86, 15
    s_mul_i32 s86, s86, 32768
    v_mfma_f32_16x16x32_bf16 v[108:111], v[40:43], a[128:131], v[108:111]
    v_mfma_f32_16x16x32_bf16 v[72:75], a[120:123], v[40:43], v[72:75]
    buffer_load_dwordx4 v22, s[16:19], s87 offen lds
    ds_read_b128 v[40:43], v0 offset:52224
    v_mfma_f32_16x16x32_bf16 v[76:79], a[136:139], v[44:47], v[76:79]
    s_add_u32 m0, s62, 139264
    s_add_u32 s87, s60, 13
    v_mfma_f32_16x16x32_bf16 v[96:99], v[44:47], a[140:143], v[96:99]
    s_and_b32 s87, s87, 15
    s_mul_i32 s87, s87, 32768
    v_mfma_f32_16x16x32_bf16 v[60:63], a[132:135], v[44:47], v[60:63]
    ds_read_b128 v[44:47], v0 offset:53248
    v_mfma_f32_16x16x32_bf16 v[80:83], a[136:139], v[48:51], v[80:83]
    buffer_load_dwordx4 v22, s[16:19], s86 offen lds
    v_mfma_f32_16x16x32_bf16 v[100:103], v[48:51], a[140:143], v[100:103]
    s_add_u32 m0, s62, 143360
    s_add_u32 s86, s60, 14
    v_mfma_f32_16x16x32_bf16 v[64:67], a[132:135], v[48:51], v[64:67]
    ds_read_b128 v[48:51], v0 offset:54272
    s_and_b32 s86, s86, 15
    v_mfma_f32_16x16x32_bf16 v[84:87], a[136:139], v[52:55], v[84:87]
    s_mul_i32 s86, s86, 32768
    v_mfma_f32_16x16x32_bf16 v[104:107], v[52:55], a[140:143], v[104:107]
    v_mfma_f32_16x16x32_bf16 v[68:71], a[132:135], v[52:55], v[68:71]
    buffer_load_dwordx4 v22, s[16:19], s87 offen lds
    ds_read_b128 v[52:55], v0 offset:55296
    v_mfma_f32_16x16x32_bf16 v[88:91], a[136:139], v[56:59], v[88:91]
    s_add_u32 m0, s62, 147456
    s_add_u32 s87, s60, 15
    v_mfma_f32_16x16x32_bf16 v[108:111], v[56:59], a[140:143], v[108:111]
    s_and_b32 s87, s87, 15
    s_mul_i32 s87, s87, 32768
    v_mfma_f32_16x16x32_bf16 v[72:75], a[132:135], v[56:59], v[72:75]
    ds_read_b128 v[56:59], v0 offset:56320
    s_waitcnt lgkmcnt(3)
    v_mfma_f32_16x16x32_bf16 v[76:79], a[148:151], v[28:31], v[76:79]
    buffer_load_dwordx4 v22, s[16:19], s86 offen lds
    s_add_u32 m0, s62, 151552
    v_mfma_f32_16x16x32_bf16 v[96:99], v[28:31], a[152:155], v[96:99]
    v_mfma_f32_16x16x32_bf16 v[60:63], a[144:147], v[28:31], v[60:63]
    ds_read_b128 v[28:31], v0 offset:57344
    v_mfma_f32_16x16x32_bf16 v[80:83], a[148:151], v[32:35], v[80:83]
    v_mfma_f32_16x16x32_bf16 v[100:103], v[32:35], a[152:155], v[100:103]
    buffer_load_dwordx4 v22, s[16:19], s87 offen lds
    v_mfma_f32_16x16x32_bf16 v[64:67], a[144:147], v[32:35], v[64:67]
    ds_read_b128 v[32:35], v0 offset:58368
    v_and_b32 v22, 15, v23
    v_mfma_f32_16x16x32_bf16 v[84:87], a[148:151], v[36:39], v[84:87]
    v_lshlrev_b32 v22, 2, v22
    v_add_u32 v22, 155648, v22
    v_mfma_f32_16x16x32_bf16 v[104:107], v[36:39], a[152:155], v[104:107]
    ds_read2_b32 v[12:13], v22 offset0:32 offset1:160
    ds_read2_b32 v[14:15], v22 offset0:48 offset1:176
    v_mfma_f32_16x16x32_bf16 v[68:71], a[144:147], v[36:39], v[68:71]
    ds_read_b128 v[36:39], v0 offset:59392
    v_and_b32 v23, 48, v23
    v_mfma_f32_16x16x32_bf16 v[88:91], a[148:151], v[40:43], v[88:91]
    v_add_u32 v23, 155648, v23
    v_mfma_f32_16x16x32_bf16 v[108:111], v[40:43], a[152:155], v[108:111]
    v_mfma_f32_16x16x32_bf16 v[72:75], a[144:147], v[40:43], v[72:75]
    ds_read_b128 v[40:43], v0 offset:60416
    v_mfma_f32_16x16x32_bf16 v[76:79], a[160:163], v[44:47], v[76:79]
    v_mfma_f32_16x16x32_bf16 v[96:99], v[44:47], a[164:167], v[96:99]
    v_mfma_f32_16x16x32_bf16 v[60:63], a[156:159], v[44:47], v[60:63]
    ds_read_b128 v[44:47], v0 offset:61440
    s_waitcnt lgkmcnt(4)
    v_mfma_f32_16x16x32_bf16 v[80:83], a[160:163], v[48:51], v[80:83]
    v_mfma_f32_16x16x32_bf16 v[100:103], v[48:51], a[164:167], v[100:103]
    v_mfma_f32_16x16x32_bf16 v[64:67], a[156:159], v[48:51], v[64:67]
    ds_read_b128 v[48:51], v0 offset:62464
    v_mfma_f32_16x16x32_bf16 v[84:87], a[160:163], v[52:55], v[84:87]
    v_mfma_f32_16x16x32_bf16 v[104:107], v[52:55], a[164:167], v[104:107]
    v_mfma_f32_16x16x32_bf16 v[68:71], a[156:159], v[52:55], v[68:71]
    ds_read_b128 v[52:55], v0 offset:63488
    v_mfma_f32_16x16x32_bf16 v[88:91], a[160:163], v[56:59], v[88:91]
    v_mfma_f32_16x16x32_bf16 v[108:111], v[56:59], a[164:167], v[108:111]
    v_mfma_f32_16x16x32_bf16 v[72:75], a[156:159], v[56:59], v[72:75]
    ds_read_b128 v[56:59], v0 offset:64512
    v_mfma_f32_16x16x32_bf16 v[76:79], a[172:175], v[28:31], v[76:79]
    s_waitcnt vmcnt(12)
    ds_read_b32 v92, v18 offset:0
    v_mfma_f32_16x16x32_bf16 v[96:99], v[28:31], a[176:179], v[96:99]
    ds_read_b32 v93, v18 offset:4096
    ds_read_b32 v94, v18 offset:8192
    v_mfma_f32_16x16x32_bf16 v[60:63], a[168:171], v[28:31], v[60:63]
    ds_read_b32 v95, v18 offset:12288
    ds_read_b128 v[28:31], v23 offset:128
    v_mfma_f32_16x16x32_bf16 v[80:83], a[172:175], v[32:35], v[80:83]
    v_mfma_f32_16x16x32_bf16 v[100:103], v[32:35], a[176:179], v[100:103]
    v_mfma_f32_16x16x32_bf16 v[64:67], a[168:171], v[32:35], v[64:67]
    ds_read_b128 v[32:35], v23 offset:640
    s_waitcnt lgkmcnt(7)
    v_mfma_f32_16x16x32_bf16 v[84:87], a[172:175], v[36:39], v[84:87]
    v_mfma_f32_16x16x32_bf16 v[104:107], v[36:39], a[176:179], v[104:107]
    v_mfma_f32_16x16x32_bf16 v[68:71], a[168:171], v[36:39], v[68:71]
    ds_read_b128 v[36:39], v23 offset:192
    v_mfma_f32_16x16x32_bf16 v[88:91], a[172:175], v[40:43], v[88:91]
    s_waitcnt lgkmcnt(4)
    v_max3_u32 v21, v92, v93, v94
    v_mfma_f32_16x16x32_bf16 v[108:111], v[40:43], a[176:179], v[108:111]
    s_waitcnt vmcnt(11) lgkmcnt(2)
    v_max3_u32 v21, v21, v95, v112
    v_mfma_f32_16x16x32_bf16 v[72:75], a[168:171], v[40:43], v[72:75]
    ds_read_b128 v[40:43], v23 offset:704
    s_waitcnt vmcnt(9)
    v_max3_u32 v21, v21, v113, v114
    v_mfma_f32_16x16x32_bf16 v[76:79], a[184:187], v[44:47], v[76:79]
    s_waitcnt vmcnt(8)
    v_max_u32 v21, v21, v115
    v_mfma_f32_16x16x32_bf16 v[96:99], v[44:47], a[188:191], v[96:99]
    v_cmp_eq_u32 vcc, -1, v21
    s_cbranch_vccnz L41
L42:
    v_mfma_f32_16x16x32_bf16 v[60:63], a[180:183], v[44:47], v[60:63]
    ds_read2_b32 v[18:19], v22 offset0:16 offset1:144
    v_add_f32 v112, v112, v113
    v_mfma_f32_16x16x32_bf16 v[80:83], a[184:187], v[48:51], v[80:83]
    v_add_f32 v114, v114, v115
    v_add_f32 v112, v112, v114
    v_mfma_f32_16x16x32_bf16 v[100:103], v[48:51], a[188:191], v[100:103]
    v_mov_b32 v113, v112
    v_mfma_f32_16x16x32_bf16 v[64:67], a[180:183], v[48:51], v[64:67]
    s_nop 0
    v_permlane32_swap_b32 v112, v113
    v_mfma_f32_16x16x32_bf16 v[84:87], a[184:187], v[52:55], v[84:87]
    v_add_f32 v112, v112, v113
    v_mov_b32 v113, v112
    v_mfma_f32_16x16x32_bf16 v[104:107], v[52:55], a[188:191], v[104:107]
    s_nop 0
    v_permlane16_swap_b32 v112, v113
    v_mfma_f32_16x16x32_bf16 v[68:71], a[180:183], v[52:55], v[68:71]
    v_mul_f32 v112, 0x3b000000, v112
    v_mul_f32 v113, 0x3b000000, v113
    v_mfma_f32_16x16x32_bf16 v[88:91], a[184:187], v[56:59], v[88:91]
    v_fma_f32 v113, -v112, v112, v113
    v_max_f32 v113, 0, v113
    v_mfma_f32_16x16x32_bf16 v[108:111], v[56:59], a[188:191], v[108:111]
    v_add_f32 v113, 0x3727c5ac, v113
    v_rsq_f32 v113, v113
    v_mfma_f32_16x16x32_bf16 v[72:75], a[180:183], v[56:59], v[72:75]
    s_mov_b64 exec, 0xffff
    ds_write_b32 v17, v112
    ds_write_b32 v17, v113 offset:512
    s_mov_b64 exec, -1
    ds_read2_b32 v[16:17], v22 offset0:0 offset1:128
    s_waitcnt lgkmcnt(3)
    v_fma_f32 v80, -v120, v18, v80
    v_fma_f32 v81, -v121, v18, v81
    v_fma_f32 v82, -v122, v18, v82
    v_fma_f32 v83, -v123, v18, v83
    v_mul_f32 v80, v80, v19
    v_mul_f32 v81, v81, v19
    v_mul_f32 v82, v82, v19
    v_mul_f32 v83, v83, v19
    v_fma_f32 v64, -v116, v18, v64
    v_fma_f32 v65, -v117, v18, v65
    v_fma_f32 v66, -v118, v18, v66
    v_fma_f32 v67, -v119, v18, v67
    v_mul_f32 v64, v64, v19
    v_mul_f32 v65, v65, v19
    v_mul_f32 v66, v66, v19
    v_mul_f32 v67, v67, v19
    v_pk_fma_f32 v[84:85], v[120:121], v[12:13], v[84:85] op_sel_hi:[1,0,1] neg_lo:[0,1,0] neg_hi:[0,1,0]
    v_pk_fma_f32 v[86:87], v[122:123], v[12:13], v[86:87] op_sel_hi:[1,0,1] neg_lo:[0,1,0] neg_hi:[0,1,0]
    v_pk_mul_f32 v[84:85], v[84:85], v[12:13] op_sel:[0,1] op_sel_hi:[1,1]
    v_pk_mul_f32 v[86:87], v[86:87], v[12:13] op_sel:[0,1] op_sel_hi:[1,1]
    v_cvt_pk_bf16_f32 v84, v84, v85
    v_cvt_pk_bf16_f32 v85, v86, v87
    v_pk_fma_f32 v[88:89], v[120:121], v[14:15], v[88:89] op_sel_hi:[1,0,1] neg_lo:[0,1,0] neg_hi:[0,1,0]
    v_pk_fma_f32 v[90:91], v[122:123], v[14:15], v[90:91] op_sel_hi:[1,0,1] neg_lo:[0,1,0] neg_hi:[0,1,0]
    s_waitcnt lgkmcnt(1)
    s_barrier
    ds_read_b128 v[44:47], v125 offset:0
    ds_read_b128 v[48:51], v125 offset:1024
    ds_read_b128 v[52:55], v125 offset:2048
    ds_read_b128 v[56:59], v125 offset:3072
    s_waitcnt lgkmcnt(4)
    v_fma_f32 v76, -v120, v16, v76
    v_fma_f32 v77, -v121, v16, v77
    v_fma_f32 v78, -v122, v16, v78
    v_fma_f32 v79, -v123, v16, v79
    v_mul_f32 v76, v76, v17
    v_mul_f32 v77, v77, v17
    v_mul_f32 v78, v78, v17
    v_mul_f32 v79, v79, v17
    v_cvt_pk_bf16_f32 v76, v76, v77
    v_cvt_pk_bf16_f32 v77, v78, v79
    v_cvt_pk_bf16_f32 v78, v80, v81
    v_cvt_pk_bf16_f32 v79, v82, v83
    ds_read_b128 v[80:83], v23 offset:512
    v_fma_f32 v60, -v116, v16, v60
    v_fma_f32 v61, -v117, v16, v61
    v_fma_f32 v62, -v118, v16, v62
    v_fma_f32 v63, -v119, v16, v63
    v_mul_f32 v60, v60, v17
    v_mul_f32 v61, v61, v17
    v_mul_f32 v62, v62, v17
    v_mul_f32 v63, v63, v17
    v_cvt_pk_bf16_f32 v60, v60, v61
    v_cvt_pk_bf16_f32 v61, v62, v63
    v_cvt_pk_bf16_f32 v62, v64, v65
    v_cvt_pk_bf16_f32 v63, v66, v67
    s_waitcnt lgkmcnt(4)
    v_mfma_f32_16x16x32_bf16 v[92:95], a[4:7], v[44:47], 0
    ds_read_b128 v[64:67], v23 offset:0
    v_mfma_f32_16x16x32_bf16 v[112:115], v[44:47], a[8:11], 0
    ds_read_b128 v[44:47], v125 offset:4096
    s_waitcnt lgkmcnt(3)
    v_mfma_f32_16x16x32_bf16 v[92:95], a[16:19], v[48:51], v[92:95]
    v_mfma_f32_16x16x32_bf16 v[112:115], v[48:51], a[20:23], v[112:115]
    ds_read_b128 v[48:51], v125 offset:5120
    v_mfma_f32_16x16x32_bf16 v[92:95], a[28:31], v[52:55], v[92:95]
    v_mfma_f32_16x16x32_bf16 v[112:115], v[52:55], a[32:35], v[112:115]
    ds_read_b128 v[52:55], v125 offset:6144
    v_mfma_f32_16x16x32_bf16 v[92:95], a[40:43], v[56:59], v[92:95]
    v_mfma_f32_16x16x32_bf16 v[112:115], v[56:59], a[44:47], v[112:115]
    ds_read_b128 v[56:59], v125 offset:7168
    s_waitcnt lgkmcnt(4)
    v_fma_f32 v96, -v64, v124, v96
    v_fma_f32 v97, -v65, v124, v97
    v_fma_f32 v98, -v66, v124, v98
    s_waitcnt lgkmcnt(3)
    v_mfma_f32_16x16x32_bf16 v[92:95], a[52:55], v[44:47], v[92:95]
    v_fma_f32 v99, -v67, v124, v99
    ds_read_b128 v[64:67], v23 offset:64
    v_mfma_f32_16x16x32_bf16 v[112:115], v[44:47], a[56:59], v[112:115]
    ds_read_b128 v[44:47], v125 offset:8192
    v_mul_f32 v96, v96, v80
    s_waitcnt lgkmcnt(4)
    v_mfma_f32_16x16x32_bf16 v[92:95], a[64:67], v[48:51], v[92:95]
    v_mul_f32 v97, v97, v81
    v_mul_f32 v98, v98, v82
    v_mfma_f32_16x16x32_bf16 v[112:115], v[48:51], a[68:71], v[112:115]
    ds_read_b128 v[48:51], v125 offset:9216
    v_mul_f32 v99, v99, v83
    s_waitcnt lgkmcnt(4)
    v_mfma_f32_16x16x32_bf16 v[92:95], a[76:79], v[52:55], v[92:95]
    ds_read_b128 v[80:83], v23 offset:576
    v_cvt_pk_bf16_f32 v99, v98, v99
    v_mfma_f32_16x16x32_bf16 v[112:115], v[52:55], a[80:83], v[112:115]
    ds_read_b128 v[52:55], v125 offset:10240
    v_cvt_pk_bf16_f32 v98, v96, v97
    s_waitcnt lgkmcnt(5)
    v_mfma_f32_16x16x32_bf16 v[92:95], a[88:91], v[56:59], v[92:95]
    v_mfma_f32_16x16x32_bf16 v[112:115], v[56:59], a[92:95], v[112:115]
    ds_read_b128 v[56:59], v125 offset:11264
    s_waitcnt lgkmcnt(5)
    v_fma_f32 v100, -v64, v124, v100
    s_waitcnt lgkmcnt(4)
    v_mfma_f32_16x16x32_bf16 v[92:95], a[100:103], v[44:47], v[92:95]
    v_fma_f32 v101, -v65, v124, v101
    v_fma_f32 v102, -v66, v124, v102
    v_mfma_f32_16x16x32_bf16 v[112:115], v[44:47], a[104:107], v[112:115]
    ds_read_b128 v[44:47], v125 offset:12288
    v_fma_f32 v103, -v67, v124, v103
    s_waitcnt lgkmcnt(4)
    v_mfma_f32_16x16x32_bf16 v[92:95], a[112:115], v[48:51], v[92:95]
    ds_read_b128 v[64:67], v127 offset:1024
    v_mfma_f32_16x16x32_bf16 v[112:115], v[48:51], a[116:119], v[112:115]
    ds_read_b128 v[48:51], v125 offset:13312
    s_waitcnt lgkmcnt(5)
    v_mul_f32 v100, v100, v80
    s_waitcnt lgkmcnt(4)
    v_mfma_f32_16x16x32_bf16 v[92:95], a[124:127], v[52:55], v[92:95]
    v_mul_f32 v101, v101, v81
    v_mul_f32 v102, v102, v82
    v_mfma_f32_16x16x32_bf16 v[112:115], v[52:55], a[128:131], v[112:115]
    ds_read_b128 v[52:55], v125 offset:14336
    v_mul_f32 v103, v103, v83
    s_waitcnt lgkmcnt(4)
    v_mfma_f32_16x16x32_bf16 v[92:95], a[136:139], v[56:59], v[92:95]
    ds_read_b128 v[80:83], v127
    v_cvt_pk_bf16_f32 v100, v100, v101
    v_mfma_f32_16x16x32_bf16 v[112:115], v[56:59], a[140:143], v[112:115]
    ds_read_b128 v[56:59], v125 offset:15360
    v_cvt_pk_bf16_f32 v101, v102, v103
    s_waitcnt lgkmcnt(5)
    v_mfma_f32_16x16x32_bf16 v[92:95], a[148:151], v[44:47], v[92:95]
    s_waitcnt lgkmcnt(4)
    v_mfma_f32_16x16x16_bf16 v[64:67], v[76:77], v[62:63], v[64:67]
    v_mfma_f32_16x16x32_bf16 v[112:115], v[44:47], a[152:155], v[112:115]
    ds_read_b128 v[44:47], v23 offset:256
    s_waitcnt lgkmcnt(4)
    v_mfma_f32_16x16x32_bf16 v[92:95], a[160:163], v[48:51], v[92:95]
    s_nop 3
    v_max3_f32 v20, v64, v65, v66
    v_mfma_f32_16x16x32_bf16 v[112:115], v[48:51], a[164:167], v[112:115]
    ds_read_b128 v[48:51], v23 offset:768
    s_waitcnt lgkmcnt(4)
    v_mfma_f32_16x16x32_bf16 v[92:95], a[172:175], v[52:55], v[92:95]
    s_waitcnt lgkmcnt(2)
    v_mfma_f32_16x16x16_bf16 v[80:83], v[78:79], v[62:63], v[80:83]
    v_mfma_f32_16x16x32_bf16 v[112:115], v[52:55], a[176:179], v[112:115]
    v_mfma_f32_16x16x32_bf16 v[92:95], a[184:187], v[56:59], v[92:95]
    s_nop 5
    v_max3_f32 v20, v20, v67, v80
    v_max3_f32 v20, v20, v81, v82
    v_mfma_f32_16x16x32_bf16 v[112:115], v[56:59], a[188:191], v[112:115]
    v_max_f32 v20, v20, v83
    v_mov_b32 v21, v20
    v_pk_mul_f32 v[88:89], v[88:89], v[14:15] op_sel:[0,1] op_sel_hi:[1,1]
    v_pk_mul_f32 v[90:91], v[90:91], v[14:15] op_sel:[0,1] op_sel_hi:[1,1]
    v_permlane32_swap_b32 v20, v21
    v_max_f32 v20, v20, v21
    v_mov_b32 v21, v20
    v_cvt_pk_bf16_f32 v86, v88, v89
    v_cvt_pk_bf16_f32 v87, v90, v91
    ds_read_b128 v[88:91], v127
    v_permlane16_swap_b32 v20, v21
    v_max_f32 v20, v20, v21
    v_mul_f32 v20, s12, v20
    v_fma_f32 v64, v64, s12, -v20
    v_fma_f32 v65, v65, s12, -v20
    v_fma_f32 v66, v66, s12, -v20
    v_fma_f32 v67, v67, s12, -v20
    v_fma_f32 v80, v80, s12, -v20
    v_fma_f32 v81, v81, s12, -v20
    v_fma_f32 v82, v82, s12, -v20
    v_fma_f32 v83, v83, s12, -v20
    ds_read2_b32 v[20:21], v22 offset0:64 offset1:192
    v_exp_f32 v64, v64
    v_exp_f32 v65, v65
    v_exp_f32 v66, v66
    v_exp_f32 v67, v67
    v_exp_f32 v80, v80
    v_exp_f32 v81, v81
    v_exp_f32 v82, v82
    v_exp_f32 v83, v83
    v_cvt_pk_bf16_f32 v64, v64, v65
    v_cvt_pk_bf16_f32 v65, v66, v67
    v_cvt_pk_bf16_f32 v66, v80, v81
    v_cvt_pk_bf16_f32 v67, v82, v83
    v_pk_fma_f32 v[68:69], v[116:117], v[12:13], v[68:69] op_sel_hi:[1,0,1] neg_lo:[0,1,0] neg_hi:[0,1,0]
    v_pk_fma_f32 v[70:71], v[118:119], v[12:13], v[70:71] op_sel_hi:[1,0,1] neg_lo:[0,1,0] neg_hi:[0,1,0]
    v_mfma_f32_16x16x32_bf16 v[16:19], v[24:27], v[64:67], 0
    v_mfma_f32_16x16x32_bf16 v[80:83], v[98:101], v[64:67], 0
    v_pk_mul_f32 v[68:69], v[68:69], v[12:13] op_sel:[0,1] op_sel_hi:[1,1]
    v_pk_mul_f32 v[70:71], v[70:71], v[12:13] op_sel:[0,1] op_sel_hi:[1,1]
    s_nop 4
    v_rcp_f32 v16, v16
    v_cvt_pk_bf16_f32 v68, v68, v69
    v_cvt_pk_bf16_f32 v69, v70, v71
    v_mul_f32 v80, v80, v16
    v_mul_f32 v81, v81, v16
    v_mul_f32 v82, v82, v16
    v_mul_f32 v83, v83, v16
    v_cvt_pk_bf16_f32 v102, v80, v81
    v_cvt_pk_bf16_f32 v103, v82, v83
    v_pk_fma_f32 v[72:73], v[116:117], v[14:15], v[72:73] op_sel_hi:[1,0,1] neg_lo:[0,1,0] neg_hi:[0,1,0]
    v_pk_fma_f32 v[74:75], v[118:119], v[14:15], v[74:75] op_sel_hi:[1,0,1] neg_lo:[0,1,0] neg_hi:[0,1,0]
    v_pk_mul_f32 v[72:73], v[72:73], v[14:15] op_sel:[0,1] op_sel_hi:[1,1]
    v_pk_mul_f32 v[74:75], v[74:75], v[14:15] op_sel:[0,1] op_sel_hi:[1,1]
    v_cvt_pk_bf16_f32 v70, v72, v73
    v_cvt_pk_bf16_f32 v71, v74, v75
    ds_read_b128 v[72:75], v127 offset:1024
    v_pk_fma_f32 v[104:105], v[28:29], v[124:125], v[104:105] op_sel_hi:[1,0,1] neg_lo:[0,1,0] neg_hi:[0,1,0]
    s_waitcnt lgkmcnt(1)
    v_mfma_f32_16x16x16_bf16 v[88:91], v[86:87], v[70:71], v[88:91]
    v_pk_fma_f32 v[106:107], v[30:31], v[124:125], v[106:107] op_sel_hi:[1,0,1] neg_lo:[0,1,0] neg_hi:[0,1,0]
    ds_read_b128 v[28:31], v127 offset:2048
    v_pk_mul_f32 v[104:105], v[104:105], v[32:33]
    v_pk_mul_f32 v[106:107], v[106:107], v[34:35]
    ds_read_b128 v[32:35], v127
    v_cvt_pk_bf16_f32 v107, v106, v107
    v_cvt_pk_bf16_f32 v106, v104, v105
    v_pk_fma_f32 v[108:109], v[36:37], v[124:125], v[108:109] op_sel_hi:[1,0,1] neg_lo:[0,1,0] neg_hi:[0,1,0]
    v_pk_fma_f32 v[110:111], v[38:39], v[124:125], v[110:111] op_sel_hi:[1,0,1] neg_lo:[0,1,0] neg_hi:[0,1,0]
    ds_read_b128 v[36:39], v127 offset:3072
    v_pk_mul_f32 v[108:109], v[108:109], v[40:41]
    v_pk_mul_f32 v[110:111], v[110:111], v[42:43]
    ds_read_b128 v[40:43], v127
    v_cvt_pk_bf16_f32 v108, v108, v109
    v_cvt_pk_bf16_f32 v109, v110, v111
    v_pk_fma_f32 v[92:93], v[120:121], v[20:21], v[92:93] op_sel_hi:[1,0,1] neg_lo:[0,1,0] neg_hi:[0,1,0]
    v_pk_fma_f32 v[94:95], v[122:123], v[20:21], v[94:95] op_sel_hi:[1,0,1] neg_lo:[0,1,0] neg_hi:[0,1,0]
    v_pk_mul_f32 v[92:93], v[92:93], v[20:21] op_sel:[0,1] op_sel_hi:[1,1]
    v_pk_mul_f32 v[94:95], v[94:95], v[20:21] op_sel:[0,1] op_sel_hi:[1,1]
    v_cvt_pk_bf16_f32 v92, v92, v93
    v_cvt_pk_bf16_f32 v93, v94, v95
    v_pk_fma_f32 v[112:113], v[44:45], v[124:125], v[112:113] op_sel_hi:[1,0,1] neg_lo:[0,1,0] neg_hi:[0,1,0]
    v_pk_fma_f32 v[114:115], v[46:47], v[124:125], v[114:115] op_sel_hi:[1,0,1] neg_lo:[0,1,0] neg_hi:[0,1,0]
    s_waitcnt lgkmcnt(4)
    v_mfma_f32_16x16x16_bf16 v[72:75], v[84:85], v[70:71], v[72:75]
    v_pk_mul_f32 v[112:113], v[112:113], v[48:49]
    v_pk_mul_f32 v[114:115], v[114:115], v[50:51]
    v_cvt_pk_bf16_f32 v96, v112, v113
    s_waitcnt lgkmcnt(3)
    v_mfma_f32_16x16x16_bf16 v[28:31], v[92:93], v[60:61], v[28:31]
    v_cvt_pk_bf16_f32 v97, v114, v115
    v_cvt_pk_bf16_f32 v104, v112, v113
    s_waitcnt lgkmcnt(2)
    v_mfma_f32_16x16x16_bf16 v[32:35], v[76:77], v[60:61], v[32:35]
    v_cvt_pk_bf16_f32 v105, v114, v115
    v_max3_f32 v116, v72, v73, v74
    s_waitcnt lgkmcnt(1)
    v_mfma_f32_16x16x16_bf16 v[36:39], v[92:93], v[68:69], v[36:39]
    v_max3_f32 v116, v116, v75, v88
    v_max3_f32 v116, v116, v89, v90
    s_waitcnt lgkmcnt(0)
    v_mfma_f32_16x16x16_bf16 v[40:43], v[84:85], v[68:69], v[40:43]
    v_max_f32 v116, v116, v91
    v_max3_f32 v117, v28, v29, v30
    v_max3_f32 v117, v117, v31, v32
    v_max3_f32 v117, v117, v33, v34
    v_max_f32 v117, v117, v35
    v_max3_f32 v118, v36, v37, v38
    s_nop 0
    v_permlane32_swap_b32 v116, v117
    v_max3_f32 v118, v118, v39, v40
    v_max3_f32 v118, v118, v41, v42
    v_max_f32 v118, v118, v43
    v_mov_b32 v119, v118
    v_max_f32 v116, v116, v117
    s_nop 0
    v_permlane32_swap_b32 v118, v119
    v_max_f32 v118, v118, v119
    s_nop 1
    v_permlane16_swap_b32 v116, v118
    v_max_f32 v116, v116, v118
    v_mul_f32 v116, s12, v116
    v_mov_b32 v118, v116
    s_nop 1
    v_permlane16_swap_b32 v116, v118
    v_mov_b32 v117, v116
    v_mov_b32 v119, v118
    s_nop 0
    v_permlane32_swap_b32 v116, v117
    v_permlane32_swap_b32 v118, v119
    v_pk_fma_f32 v[72:73], v[72:73], s[12:13], v[116:117] op_sel:[0,0,0] op_sel_hi:[1,1,0] neg_lo:[0,0,1] neg_hi:[0,0,1]
    v_pk_fma_f32 v[74:75], v[74:75], s[12:13], v[116:117] op_sel:[0,0,0] op_sel_hi:[1,1,0] neg_lo:[0,0,1] neg_hi:[0,0,1]
    v_pk_fma_f32 v[88:89], v[88:89], s[12:13], v[116:117] op_sel:[0,0,0] op_sel_hi:[1,1,0] neg_lo:[0,0,1] neg_hi:[0,0,1]
    v_pk_fma_f32 v[90:91], v[90:91], s[12:13], v[116:117] op_sel:[0,0,0] op_sel_hi:[1,1,0] neg_lo:[0,0,1] neg_hi:[0,0,1]
    v_exp_f32 v72, v72
    v_exp_f32 v73, v73
    v_exp_f32 v74, v74
    v_exp_f32 v75, v75
    v_exp_f32 v88, v88
    v_exp_f32 v89, v89
    v_exp_f32 v90, v90
    v_exp_f32 v91, v91
    v_cvt_pk_bf16_f32 v72, v72, v73
    v_cvt_pk_bf16_f32 v73, v74, v75
    v_cvt_pk_bf16_f32 v74, v88, v89
    v_cvt_pk_bf16_f32 v75, v90, v91
    v_pk_fma_f32 v[28:29], v[28:29], s[12:13], v[116:117] op_sel:[0,0,1] op_sel_hi:[1,1,1] neg_lo:[0,0,1] neg_hi:[0,0,1]
    v_pk_fma_f32 v[30:31], v[30:31], s[12:13], v[116:117] op_sel:[0,0,1] op_sel_hi:[1,1,1] neg_lo:[0,0,1] neg_hi:[0,0,1]
    v_pk_fma_f32 v[32:33], v[32:33], s[12:13], v[116:117] op_sel:[0,0,1] op_sel_hi:[1,1,1] neg_lo:[0,0,1] neg_hi:[0,0,1]
    v_pk_fma_f32 v[34:35], v[34:35], s[12:13], v[116:117] op_sel:[0,0,1] op_sel_hi:[1,1,1] neg_lo:[0,0,1] neg_hi:[0,0,1]
    v_exp_f32 v28, v28
    v_mfma_f32_16x16x32_bf16 v[16:19], v[24:27], v[72:75], 0
    v_exp_f32 v29, v29
    v_mfma_f32_16x16x32_bf16 v[88:91], v[106:109], v[72:75], 0
    v_exp_f32 v30, v30
    v_exp_f32 v31, v31
    v_exp_f32 v32, v32
    v_exp_f32 v33, v33
    v_exp_f32 v34, v34
    v_exp_f32 v35, v35
    v_cvt_pk_bf16_f32 v28, v28, v29
    v_cvt_pk_bf16_f32 v29, v30, v31
    v_cvt_pk_bf16_f32 v30, v32, v33
    v_cvt_pk_bf16_f32 v31, v34, v35
    v_pk_fma_f32 v[36:37], v[36:37], s[12:13], v[118:119] op_sel:[0,0,0] op_sel_hi:[1,1,0] neg_lo:[0,0,1] neg_hi:[0,0,1]
    v_pk_fma_f32 v[38:39], v[38:39], s[12:13], v[118:119] op_sel:[0,0,0] op_sel_hi:[1,1,0] neg_lo:[0,0,1] neg_hi:[0,0,1]
    v_mfma_f32_16x16x32_bf16 v[12:15], v[24:27], v[28:31], 0
    v_exp_f32 v36, v36
    v_mfma_f32_16x16x32_bf16 v[32:35], v[96:99], v[28:31], 0
    v_exp_f32 v37, v37
    v_pk_fma_f32 v[40:41], v[40:41], s[12:13], v[118:119] op_sel:[0,0,0] op_sel_hi:[1,1,0] neg_lo:[0,0,1] neg_hi:[0,0,1]
    v_pk_fma_f32 v[42:43], v[42:43], s[12:13], v[118:119] op_sel:[0,0,0] op_sel_hi:[1,1,0] neg_lo:[0,0,1] neg_hi:[0,0,1]
    v_exp_f32 v38, v38
    v_exp_f32 v39, v39
    v_exp_f32 v40, v40
    v_exp_f32 v41, v41
    v_exp_f32 v42, v42
    v_exp_f32 v43, v43
    v_cvt_pk_bf16_f32 v36, v36, v37
    v_cvt_pk_bf16_f32 v37, v38, v39
    v_cvt_pk_bf16_f32 v38, v40, v41
    v_cvt_pk_bf16_f32 v39, v42, v43
    v_rcp_f32 v16, v16
    s_nop 0
    v_mfma_f32_16x16x32_bf16 v[52:55], v[24:27], v[36:39], 0
    v_rcp_f32 v12, v12
    v_mfma_f32_16x16x32_bf16 v[40:43], v[104:107], v[36:39], 0
    v_pk_mul_f32 v[88:89], v[88:89], v[16:17] op_sel_hi:[1,0]
    v_pk_mul_f32 v[90:91], v[90:91], v[16:17] op_sel_hi:[1,0]
    v_cvt_pk_bf16_f32 v110, v88, v89
    v_cvt_pk_bf16_f32 v111, v90, v91
    v_pk_mul_f32 v[32:33], v[32:33], v[12:13] op_sel_hi:[1,0]
    v_pk_mul_f32 v[34:35], v[34:35], v[12:13] op_sel_hi:[1,0]
    v_cvt_pk_bf16_f32 v100, v32, v33
    v_cvt_pk_bf16_f32 v101, v34, v35
    v_rcp_f32 v52, v52
    s_nop 0
    v_pk_mul_f32 v[40:41], v[40:41], v[52:53] op_sel_hi:[1,0]
    v_pk_mul_f32 v[42:43], v[42:43], v[52:53] op_sel_hi:[1,0]
    v_cvt_pk_bf16_f32 v108, v40, v41
    v_cvt_pk_bf16_f32 v109, v42, v43
    v_permlane16_swap_b32 v100, v102
    v_permlane16_swap_b32 v101, v103
    v_permlane16_swap_b32 v108, v110
    v_permlane16_swap_b32 v109, v111
    s_cmp_eq_u32 s48, 0
    s_cbranch_scc1 L43
    buffer_store_dwordx4 v[100:103], v126, s[36:39], s64 offen
    buffer_store_dwordx4 v[108:111], v126, s[36:39], s65 offen
L44:
    v_mov_b32 v47, 6
    v_lshrrev_b32 v58, 4, v0
    v_lshrrev_b32 v124, 4, v58
    v_mul_u32_u24 v124, 1024, v124
    v_bfe_u32 v59, v58, 2, 2
    v_lshl_add_u32 v124, v59, 7, v124
    v_and_b32 v59, 3, v58
    v_lshl_add_u32 v124, v59, 3, v124
    v_bfe_u32 v59, v58, 3, 2
    v_lshl_add_u32 v124, v59, 5, v124
    v_add_u32 v124, 90112, v124
    v_xor_b32 v125, 32, v124
    v_xor_b32 v126, 64, v124
    v_xor_b32 v127, 96, v124
    v_permlane16_swap_b32 v2, v4
    v_permlane16_swap_b32 v3, v5
    v_permlane16_swap_b32 v6, v8
    v_permlane16_swap_b32 v7, v9
    v_lshlrev_b32 v12, 16, v2
    v_and_b32 v13, 0xffff0000, v2
    v_lshlrev_b32 v14, 16, v3
    v_and_b32 v15, 0xffff0000, v3
    v_lshlrev_b32 v16, 16, v4
    v_and_b32 v17, 0xffff0000, v4
    v_lshlrev_b32 v18, 16, v5
    v_and_b32 v19, 0xffff0000, v5
    v_lshlrev_b32 v20, 16, v6
    v_and_b32 v21, 0xffff0000, v6
    v_lshlrev_b32 v22, 16, v7
    v_and_b32 v23, 0xffff0000, v7
    v_lshlrev_b32 v24, 16, v8
    v_and_b32 v25, 0xffff0000, v8
    v_lshlrev_b32 v26, 16, v9
    v_and_b32 v27, 0xffff0000, v9
    v_lshrrev_b32 v60, 2, v0
    v_and_b32 v60, 0x7c, v60
    s_waitcnt vmcnt(0)
    s_cmp_eq_u32 s48, 0
    s_cbranch_scc1 L45
    buffer_store_dword v47, off, s[36:39], s74
L46:
    s_barrier
    ds_read_b64_tr_b16 v[28:29], v124 offset:0
    ds_read_b64_tr_b16 v[30:31], v124 offset:512
    ds_read_b64_tr_b16 v[32:33], v125 offset:0
    ds_read_b64_tr_b16 v[34:35], v125 offset:512
    ds_read_b64_tr_b16 v[36:37], v126 offset:0
    ds_read_b64_tr_b16 v[38:39], v126 offset:512
    ds_read_b64_tr_b16 v[40:41], v127 offset:0
    ds_read_b64_tr_b16 v[42:43], v127 offset:512
    ds_read_b64_tr_b16 v[44:45], v124 offset:4096
    ds_read_b64_tr_b16 v[46:47], v124 offset:4608
    ds_read_b64_tr_b16 v[48:49], v125 offset:4096
    ds_read_b64_tr_b16 v[50:51], v125 offset:4608
    ds_read_b64_tr_b16 v[52:53], v126 offset:4096
    ds_read_b64_tr_b16 v[54:55], v126 offset:4608
    ds_read_b64_tr_b16 v[56:57], v127 offset:4096
    ds_read_b64_tr_b16 v[58:59], v127 offset:4608
L47:
    buffer_load_dword v61, v60, s[36:39], s75 offen sc1
    s_sub_u32 s49, s49, 1
    s_cbranch_scc1 L_end
    s_waitcnt vmcnt(0)
    v_cmp_gt_u32 vcc, 6, v61
    s_cbranch_vccnz L47
    buffer_load_dwordx4 v[60:63], v0, s[36:39], s66 offen offset:0 sc1
    buffer_load_dwordx4 v[64:67], v0, s[36:39], s66 offen offset:1024 sc1
    buffer_load_dwordx4 v[68:71], v0, s[36:39], s66 offen offset:2048 sc1
    buffer_load_dwordx4 v[72:75], v0, s[36:39], s66 offen offset:3072 sc1
    buffer_load_dwordx4 v[76:79], v0, s[36:39], s67 offen offset:0 sc1
    buffer_load_dwordx4 v[80:83], v0, s[36:39], s67 offen offset:1024 sc1
    buffer_load_dwordx4 v[84:87], v0, s[36:39], s67 offen offset:2048 sc1
    buffer_load_dwordx4 v[88:91], v0, s[36:39], s67 offen offset:3072 sc1
    buffer_load_dwordx4 v[92:95], v0, s[36:39], s68 offen offset:0 sc1
    buffer_load_dwordx4 v[96:99], v0, s[36:39], s68 offen offset:1024 sc1
    s_waitcnt vmcnt(9) lgkmcnt(0)
    v_mfma_f32_16x16x32_bf16 v[12:15], v[28:31], v[60:63], v[12:15]
    buffer_load_dwordx4 v[100:103], v0, s[36:39], s68 offen offset:2048 sc1
    ds_read_b64_tr_b16 v[28:29], v124 offset:8192
    v_mfma_f32_16x16x32_bf16 v[16:19], v[32:35], v[60:63], v[16:19]
    ds_read_b64_tr_b16 v[30:31], v124 offset:8704
    ds_read_b64_tr_b16 v[32:33], v125 offset:8192
    v_mfma_f32_16x16x32_bf16 v[20:23], v[36:39], v[60:63], v[20:23]
    ds_read_b64_tr_b16 v[34:35], v125 offset:8704
    ds_read_b64_tr_b16 v[36:37], v126 offset:8192
    v_mfma_f32_16x16x32_bf16 v[24:27], v[40:43], v[60:63], v[24:27]
    buffer_load_dwordx4 v[104:107], v0, s[36:39], s68 offen offset:3072 sc1
    ds_read_b64_tr_b16 v[38:39], v126 offset:8704
    s_waitcnt vmcnt(10)
    v_mfma_f32_16x16x32_bf16 v[12:15], v[44:47], v[64:67], v[12:15]
    ds_read_b64_tr_b16 v[40:41], v127 offset:8192
    ds_read_b64_tr_b16 v[42:43], v127 offset:8704
    v_mfma_f32_16x16x32_bf16 v[16:19], v[48:51], v[64:67], v[16:19]
    ds_read_b64_tr_b16 v[44:45], v124 offset:12288
    buffer_load_dwordx4 v[108:111], v0, s[36:39], s69 offen offset:0 sc1
    v_mfma_f32_16x16x32_bf16 v[20:23], v[52:55], v[64:67], v[20:23]
    ds_read_b64_tr_b16 v[46:47], v124 offset:12800
    ds_read_b64_tr_b16 v[48:49], v125 offset:12288
    v_mfma_f32_16x16x32_bf16 v[24:27], v[56:59], v[64:67], v[24:27]
    ds_read_b64_tr_b16 v[50:51], v125 offset:12800
    ds_read_b64_tr_b16 v[52:53], v126 offset:12288
    ds_read_b64_tr_b16 v[54:55], v126 offset:12800
    buffer_load_dwordx4 v[112:115], v0, s[36:39], s69 offen offset:1024 sc1
    ds_read_b64_tr_b16 v[56:57], v127 offset:12288
    s_waitcnt vmcnt(11) lgkmcnt(9)
    v_mfma_f32_16x16x32_bf16 v[12:15], v[28:31], v[68:71], v[12:15]
    ds_read_b64_tr_b16 v[58:59], v127 offset:12800
    ds_read_b64_tr_b16 v[28:29], v124 offset:16384
    v_mfma_f32_16x16x32_bf16 v[16:19], v[32:35], v[68:71], v[16:19]
    ds_read_b64_tr_b16 v[30:31], v124 offset:16896
    buffer_load_dwordx4 v[116:119], v0, s[36:39], s69 offen offset:2048 sc1
    v_mfma_f32_16x16x32_bf16 v[20:23], v[36:39], v[68:71], v[20:23]
    ds_read_b64_tr_b16 v[32:33], v125 offset:16384
    ds_read_b64_tr_b16 v[34:35], v125 offset:16896
    ds_read_b64_tr_b16 v[36:37], v126 offset:16384
    s_waitcnt lgkmcnt(8)
    v_mfma_f32_16x16x32_bf16 v[24:27], v[40:43], v[68:71], v[24:27]
    ds_read_b64_tr_b16 v[38:39], v126 offset:16896
    buffer_load_dwordx4 v[120:123], v0, s[36:39], s69 offen offset:3072 sc1
    ds_read_b64_tr_b16 v[40:41], v127 offset:16384
    s_waitcnt vmcnt(12)
    v_mfma_f32_16x16x32_bf16 v[12:15], v[44:47], v[72:75], v[12:15]
    ds_read_b64_tr_b16 v[42:43], v127 offset:16896
    ds_read_b64_tr_b16 v[44:45], v124 offset:20480
    v_mfma_f32_16x16x32_bf16 v[16:19], v[48:51], v[72:75], v[16:19]
    ds_read_b64_tr_b16 v[46:47], v124 offset:20992
    ds_read_b64_tr_b16 v[48:49], v125 offset:20480
    s_waitcnt lgkmcnt(7)
    v_mfma_f32_16x16x32_bf16 v[20:23], v[52:55], v[72:75], v[20:23]
    ds_read_b64_tr_b16 v[50:51], v125 offset:20992
    ds_read_b64_tr_b16 v[52:53], v126 offset:20480
    v_mfma_f32_16x16x32_bf16 v[24:27], v[56:59], v[72:75], v[24:27]
    ds_read_b64_tr_b16 v[54:55], v126 offset:20992
    ds_read_b64_tr_b16 v[56:57], v127 offset:20480
    s_waitcnt vmcnt(11)
    v_mfma_f32_16x16x32_bf16 v[12:15], v[28:31], v[76:79], v[12:15]
    ds_read_b64_tr_b16 v[58:59], v127 offset:20992
    ds_read_b64_tr_b16 v[28:29], v124 offset:24576
    v_mfma_f32_16x16x32_bf16 v[16:19], v[32:35], v[76:79], v[16:19]
    ds_read_b64_tr_b16 v[30:31], v124 offset:25088
    ds_read_b64_tr_b16 v[32:33], v125 offset:24576
    s_waitcnt lgkmcnt(8)
    v_mfma_f32_16x16x32_bf16 v[20:23], v[36:39], v[76:79], v[20:23]
    ds_read_b64_tr_b16 v[34:35], v125 offset:25088
    ds_read_b64_tr_b16 v[36:37], v126 offset:24576
    v_mfma_f32_16x16x32_bf16 v[24:27], v[40:43], v[76:79], v[24:27]
    ds_read_b64_tr_b16 v[38:39], v126 offset:25088
    ds_read_b64_tr_b16 v[40:41], v127 offset:24576
    s_waitcnt vmcnt(10)
    v_mfma_f32_16x16x32_bf16 v[12:15], v[44:47], v[80:83], v[12:15]
    ds_read_b64_tr_b16 v[42:43], v127 offset:25088
    ds_read_b64_tr_b16 v[44:45], v124 offset:28672
    s_waitcnt lgkmcnt(8)
    v_mfma_f32_16x16x32_bf16 v[16:19], v[48:51], v[80:83], v[16:19]
    ds_read_b64_tr_b16 v[46:47], v124 offset:29184
    ds_read_b64_tr_b16 v[48:49], v125 offset:28672
    v_mfma_f32_16x16x32_bf16 v[20:23], v[52:55], v[80:83], v[20:23]
    ds_read_b64_tr_b16 v[50:51], v125 offset:29184
    ds_read_b64_tr_b16 v[52:53], v126 offset:28672
    v_mfma_f32_16x16x32_bf16 v[24:27], v[56:59], v[80:83], v[24:27]
    ds_read_b64_tr_b16 v[54:55], v126 offset:29184
    ds_read_b64_tr_b16 v[56:57], v127 offset:28672
    s_waitcnt vmcnt(9) lgkmcnt(8)
    v_mfma_f32_16x16x32_bf16 v[12:15], v[28:31], v[84:87], v[12:15]
    ds_read_b64_tr_b16 v[58:59], v127 offset:29184
    ds_read_b64_tr_b16 v[28:29], v124 offset:32768
    v_mfma_f32_16x16x32_bf16 v[16:19], v[32:35], v[84:87], v[16:19]
    ds_read_b64_tr_b16 v[30:31], v124 offset:33280
    ds_read_b64_tr_b16 v[32:33], v125 offset:32768
    v_mfma_f32_16x16x32_bf16 v[20:23], v[36:39], v[84:87], v[20:23]
    ds_read_b64_tr_b16 v[34:35], v125 offset:33280
    ds_read_b64_tr_b16 v[36:37], v126 offset:32768
    s_waitcnt lgkmcnt(8)
    v_mfma_f32_16x16x32_bf16 v[24:27], v[40:43], v[84:87], v[24:27]
    ds_read_b64_tr_b16 v[38:39], v126 offset:33280
    ds_read_b64_tr_b16 v[40:41], v127 offset:32768
    s_waitcnt vmcnt(8)
    v_mfma_f32_16x16x32_bf16 v[12:15], v[44:47], v[88:91], v[12:15]
    ds_read_b64_tr_b16 v[42:43], v127 offset:33280
    ds_read_b64_tr_b16 v[44:45], v124 offset:36864
    v_mfma_f32_16x16x32_bf16 v[16:19], v[48:51], v[88:91], v[16:19]
    ds_read_b64_tr_b16 v[46:47], v124 offset:37376
    ds_read_b64_tr_b16 v[48:49], v125 offset:36864
    s_waitcnt lgkmcnt(8)
    v_mfma_f32_16x16x32_bf16 v[20:23], v[52:55], v[88:91], v[20:23]
    ds_read_b64_tr_b16 v[50:51], v125 offset:37376
    ds_read_b64_tr_b16 v[52:53], v126 offset:36864
    v_mfma_f32_16x16x32_bf16 v[24:27], v[56:59], v[88:91], v[24:27]
    ds_read_b64_tr_b16 v[54:55], v126 offset:37376
    ds_read_b64_tr_b16 v[56:57], v127 offset:36864
    s_waitcnt vmcnt(7)
    v_mfma_f32_16x16x32_bf16 v[12:15], v[28:31], v[92:95], v[12:15]
    ds_read_b64_tr_b16 v[58:59], v127 offset:37376
    ds_read_b64_tr_b16 v[28:29], v124 offset:40960
    s_waitcnt lgkmcnt(8)
    v_mfma_f32_16x16x32_bf16 v[16:19], v[32:35], v[92:95], v[16:19]
    ds_read_b64_tr_b16 v[30:31], v124 offset:41472
    ds_read_b64_tr_b16 v[32:33], v125 offset:40960
    v_mfma_f32_16x16x32_bf16 v[20:23], v[36:39], v[92:95], v[20:23]
    ds_read_b64_tr_b16 v[34:35], v125 offset:41472
    ds_read_b64_tr_b16 v[36:37], v126 offset:40960
    v_mfma_f32_16x16x32_bf16 v[24:27], v[40:43], v[92:95], v[24:27]
    ds_read_b64_tr_b16 v[38:39], v126 offset:41472
    ds_read_b64_tr_b16 v[40:41], v127 offset:40960
    s_waitcnt vmcnt(6) lgkmcnt(8)
    v_mfma_f32_16x16x32_bf16 v[12:15], v[44:47], v[96:99], v[12:15]
    ds_read_b64_tr_b16 v[42:43], v127 offset:41472
    ds_read_b64_tr_b16 v[44:45], v124 offset:45056
    v_mfma_f32_16x16x32_bf16 v[16:19], v[48:51], v[96:99], v[16:19]
    ds_read_b64_tr_b16 v[46:47], v124 offset:45568
    ds_read_b64_tr_b16 v[48:49], v125 offset:45056
    v_mfma_f32_16x16x32_bf16 v[20:23], v[52:55], v[96:99], v[20:23]
    ds_read_b64_tr_b16 v[50:51], v125 offset:45568
    ds_read_b64_tr_b16 v[52:53], v126 offset:45056
    v_and_b32 v92, 0xf0, v0
    s_waitcnt lgkmcnt(8)
    v_mfma_f32_16x16x32_bf16 v[24:27], v[56:59], v[96:99], v[24:27]
    ds_read_b64_tr_b16 v[54:55], v126 offset:45568
    ds_read_b64_tr_b16 v[56:57], v127 offset:45056
    s_waitcnt vmcnt(5)
    v_mfma_f32_16x16x32_bf16 v[12:15], v[28:31], v[100:103], v[12:15]
    ds_read_b64_tr_b16 v[58:59], v127 offset:45568
    ds_read_b64_tr_b16 v[28:29], v124 offset:49152
    v_mfma_f32_16x16x32_bf16 v[16:19], v[32:35], v[100:103], v[16:19]
    ds_read_b64_tr_b16 v[30:31], v124 offset:49664
    ds_read_b64_tr_b16 v[32:33], v125 offset:49152
    s_waitcnt lgkmcnt(8)
    v_mfma_f32_16x16x32_bf16 v[20:23], v[36:39], v[100:103], v[20:23]
    ds_read_b64_tr_b16 v[34:35], v125 offset:49664
    ds_read_b64_tr_b16 v[36:37], v126 offset:49152
    v_mfma_f32_16x16x32_bf16 v[24:27], v[40:43], v[100:103], v[24:27]
    ds_read_b64_tr_b16 v[38:39], v126 offset:49664
    ds_read_b64_tr_b16 v[40:41], v127 offset:49152
    s_waitcnt vmcnt(4)
    v_mfma_f32_16x16x32_bf16 v[12:15], v[44:47], v[104:107], v[12:15]
    ds_read_b64_tr_b16 v[42:43], v127 offset:49664
    ds_read_b64_tr_b16 v[44:45], v124 offset:53248
    s_waitcnt lgkmcnt(8)
    v_mfma_f32_16x16x32_bf16 v[16:19], v[48:51], v[104:107], v[16:19]
    ds_read_b64_tr_b16 v[46:47], v124 offset:53760
    ds_read_b64_tr_b16 v[48:49], v125 offset:53248
    v_mfma_f32_16x16x32_bf16 v[20:23], v[52:55], v[104:107], v[20:23]
    ds_read_b64_tr_b16 v[50:51], v125 offset:53760
    ds_read_b64_tr_b16 v[52:53], v126 offset:53248
    v_bfe_u32 v96, v0, 8, 1
    v_mfma_f32_16x16x32_bf16 v[24:27], v[56:59], v[104:107], v[24:27]
    ds_read_b64_tr_b16 v[54:55], v126 offset:53760
    ds_read_b64_tr_b16 v[56:57], v127 offset:53248
    s_waitcnt vmcnt(3) lgkmcnt(8)
    v_mfma_f32_16x16x32_bf16 v[12:15], v[28:31], v[108:111], v[12:15]
    ds_read_b64_tr_b16 v[58:59], v127 offset:53760
    ds_read_b64_tr_b16 v[28:29], v124 offset:57344
    v_mfma_f32_16x16x32_bf16 v[16:19], v[32:35], v[108:111], v[16:19]
    ds_read_b64_tr_b16 v[30:31], v124 offset:57856
    ds_read_b64_tr_b16 v[32:33], v125 offset:57344
    v_mfma_f32_16x16x32_bf16 v[20:23], v[36:39], v[108:111], v[20:23]
    ds_read_b64_tr_b16 v[34:35], v125 offset:57856
    ds_read_b64_tr_b16 v[36:37], v126 offset:57344
    v_lshl_add_u32 v92, v96, 9, v92
    s_waitcnt lgkmcnt(8)
    v_mfma_f32_16x16x32_bf16 v[24:27], v[40:43], v[108:111], v[24:27]
    ds_read_b64_tr_b16 v[38:39], v126 offset:57856
    ds_read_b64_tr_b16 v[40:41], v127 offset:57344
    s_waitcnt vmcnt(2)
    v_mfma_f32_16x16x32_bf16 v[12:15], v[44:47], v[112:115], v[12:15]
    ds_read_b64_tr_b16 v[42:43], v127 offset:57856
    ds_read_b64_tr_b16 v[44:45], v124 offset:61440
    v_mfma_f32_16x16x32_bf16 v[16:19], v[48:51], v[112:115], v[16:19]
    ds_read_b64_tr_b16 v[46:47], v124 offset:61952
    ds_read_b64_tr_b16 v[48:49], v125 offset:61440
    s_waitcnt lgkmcnt(8)
    v_mfma_f32_16x16x32_bf16 v[20:23], v[52:55], v[112:115], v[20:23]
    ds_read_b64_tr_b16 v[50:51], v125 offset:61952
    ds_read_b64_tr_b16 v[52:53], v126 offset:61440
    v_mfma_f32_16x16x32_bf16 v[24:27], v[56:59], v[112:115], v[24:27]
    ds_read_b64_tr_b16 v[54:55], v126 offset:61952
    ds_read_b64_tr_b16 v[56:57], v127 offset:61440
    s_waitcnt vmcnt(1)
    v_mfma_f32_16x16x32_bf16 v[12:15], v[28:31], v[116:119], v[12:15]
    ds_read_b64_tr_b16 v[58:59], v127 offset:61952
    v_lshrrev_b32 v96, 9, v0
    s_waitcnt lgkmcnt(7)
    v_mfma_f32_16x16x32_bf16 v[16:19], v[32:35], v[116:119], v[16:19]
    v_lshl_add_u32 v92, v96, 8, v92
    v_bfe_u32 v93, v0, 4, 4
    v_mfma_f32_16x16x32_bf16 v[20:23], v[36:39], v[116:119], v[20:23]
    v_lshlrev_b32 v93, 2, v93
    v_lshl_add_u32 v93, v96, 6, v93
    v_mov_b32 v98, 7
    v_mfma_f32_16x16x32_bf16 v[24:27], v[40:43], v[116:119], v[24:27]
    s_waitcnt vmcnt(0) lgkmcnt(1)
    v_mfma_f32_16x16x32_bf16 v[12:15], v[44:47], v[120:123], v[12:15]
    v_mfma_f32_16x16x32_bf16 v[16:19], v[48:51], v[120:123], v[16:19]
    v_mfma_f32_16x16x32_bf16 v[20:23], v[52:55], v[120:123], v[20:23]
    s_nop 5
    v_cvt_pk_bf16_f32 v2, v12, v13
    v_cvt_pk_bf16_f32 v3, v14, v15
    s_waitcnt lgkmcnt(0)
    v_mfma_f32_16x16x32_bf16 v[24:27], v[56:59], v[120:123], v[24:27]
    v_cvt_pk_bf16_f32 v4, v16, v17
    v_cvt_pk_bf16_f32 v5, v18, v19
    v_cvt_pk_bf16_f32 v6, v20, v21
    v_cvt_pk_bf16_f32 v7, v22, v23
    v_permlane16_swap_b32 v2, v4
    v_permlane16_swap_b32 v3, v5
    s_nop 1
    v_cvt_pk_bf16_f32 v8, v24, v25
    v_cvt_pk_bf16_f32 v9, v26, v27
    v_dot2_f32_bf16 v94, v2, s50, 0
    v_permlane16_swap_b32 v6, v8
    v_permlane16_swap_b32 v7, v9
    s_cmp_eq_u32 s48, 0
    s_cbranch_scc1 L48
    buffer_store_dwordx4 v[2:5], v92, s[36:39], s70 offen
    buffer_store_dwordx4 v[6:9], v92, s[36:39], s71 offen
L49:
    v_dot2_f32_bf16 v95, v2, v2, 0
    v_dot2_f32_bf16 v94, v3, s50, v94
    v_dot2_f32_bf16 v95, v3, v3, v95
    v_dot2_f32_bf16 v94, v4, s50, v94
    v_dot2_f32_bf16 v95, v4, v4, v95
    v_dot2_f32_bf16 v94, v5, s50, v94
    v_dot2_f32_bf16 v95, v5, v5, v95
    v_dot2_f32_bf16 v94, v6, s50, v94
    v_dot2_f32_bf16 v95, v6, v6, v95
    v_dot2_f32_bf16 v94, v7, s50, v94
    v_dot2_f32_bf16 v95, v7, v7, v95
    v_dot2_f32_bf16 v94, v8, s50, v94
    v_dot2_f32_bf16 v95, v8, v8, v95
    v_dot2_f32_bf16 v94, v9, s50, v94
    v_dot2_f32_bf16 v95, v9, v9, v95
    s_nop 2
    v_permlane32_swap_b32 v94, v95
    v_add_f32 v94, v94, v95
    v_mov_b32 v95, v94
    s_nop 1
    v_permlane16_swap_b32 v94, v95
    v_add_f32 v94, v94, v95
    s_cmp_eq_u32 s48, 0
    s_cbranch_scc1 L50
    buffer_store_dword v94, v93, s[36:39], s72 offen
L51:
    s_waitcnt vmcnt(0)
    s_cmp_eq_u32 s48, 0
    s_cbranch_scc1 L52
    buffer_store_dword v98, off, s[36:39], s74
L53:
    v_lshrrev_b32 v13, 2, v0
    v_and_b32 v13, 0x7c, v13
    v_bfe_u32 v15, v0, 4, 4
    v_lshlrev_b32 v15, 2, v15
    v_bfe_u32 v16, v0, 8, 1
    v_lshl_add_u32 v16, v16, 6, v15
    v_lshrrev_b32 v17, 9, v0
    v_lshl_add_u32 v16, v17, 9, v16
L54:
    buffer_load_dword v21, v13, s[36:39], s75 offen sc1
    s_sub_u32 s49, s49, 1
    s_cbranch_scc1 L_end
    s_waitcnt vmcnt(0)
    v_cmp_gt_u32 vcc, 7, v21
    s_cbranch_vccnz L54
    s_add_u32 m0, s78, 0
    v_lshrrev_b32 v18, 4, v0
    buffer_load_dwordx4 v0, s[44:47], m0 offen sc1 lds
    s_add_u32 m0, s78, 2048
    v_lshrrev_b32 v22, 3, v18
    s_lshl_b32 s80, s3, 3
    v_add_u32 v22, s80, v22
    v_mul_u32_u24 v22, 1024, v22
    buffer_load_dwordx4 v0, s[44:47], m0 offen sc1 lds
    s_add_u32 m0, s78, 8192
    v_bfe_u32 v19, v18, 4, 1
    s_and_b32 s81, s3, 1
    s_lshl_b32 s81, s81, 1
    v_or_b32 v19, s81, v19
    buffer_load_dwordx4 v0, s[44:47], m0 offen sc1 lds
    s_add_u32 m0, s78, 10240
    v_lshlrev_b32 v19, 1, v19
    v_and_b32 v18, 7, v18
    v_xor_b32 v18, v18, v19
    v_lshl_add_u32 v22, v18, 4, v22
    s_lshl_b32 s80, s4, 7
    v_add_u32 v22, s80, v22
    s_lshl_b32 s98, s3, 6
    s_add_u32 s98, s98, 155648
    v_add_u32 v17, s98, v15
    s_add_u32 s86, s60, 0
    s_and_b32 s86, s86, 15
    s_mul_i32 s86, s86, 32768
    s_add_u32 s87, s60, 1
    s_and_b32 s87, s87, 15
    s_mul_i32 s87, s87, 32768
    buffer_load_dwordx4 v0, s[44:47], m0 offen sc1 lds
    s_add_u32 m0, s78, 16384
    v_lshrrev_b32 v14, 4, v0
    s_mul_i32 s82, s3, 192
    s_add_u32 s82, s82, 157952
    v_and_b32 v12, 48, v14
    v_add_u32 v12, s82, v12
    v_and_b32 v13, 15, v14
    v_lshl_add_u32 v13, v13, 2, s82
    v_mov_b32 v24, s50
    v_mov_b32 v25, s50
    v_mov_b32 v26, s50
    v_mov_b32 v27, s50
    v_lshrrev_b32 v23, 4, v0
    s_mul_i32 s82, s7, 3072
    s_add_u32 s82, s82, s77
    v_bfe_u32 v21, v0, 7, 1
    buffer_load_dwordx4 v0, s[44:47], m0 offen sc1 lds
    s_add_u32 m0, s78, 18432
    v_lshrrev_b32 v20, 4, v0
    v_and_b32 v20, 48, v20
    v_lshl_add_u32 v20, v21, 6, v20
    buffer_load_dwordx4 v0, s[44:47], m0 offen sc1 lds
    s_add_u32 m0, s78, 24576
    buffer_load_dword v116, v16, s[36:39], s73 offen offset:0 sc1
    buffer_load_dword v117, v16, s[36:39], s73 offen offset:128 sc1
    buffer_load_dword v118, v16, s[36:39], s73 offen offset:256 sc1
    buffer_load_dword v119, v16, s[36:39], s73 offen offset:384 sc1
    buffer_load_dwordx4 v0, s[44:47], m0 offen sc1 lds
    s_add_u32 m0, s78, 26624
    s_nop 0
    buffer_load_dwordx4 v0, s[44:47], m0 offen sc1 lds
    s_add_u32 m0, s78, 32768
    s_waitcnt vmcnt(10)
    s_barrier
    ds_read_b128 v[28:31], v0 offset:0
    ds_read_b128 v[32:35], v0 offset:1024
    buffer_load_dwordx4 v0, s[44:47], m0 offen sc1 lds
    ds_read_b128 v[36:39], v0 offset:2048
    ds_read_b128 v[40:43], v0 offset:3072
    ds_read_b128 v[44:47], v0 offset:4096
    ds_read_b128 v[48:51], v0 offset:5120
    ds_read_b128 v[52:55], v0 offset:6144
    ds_read_b128 v[56:59], v0 offset:7168
    s_add_u32 m0, s78, 34816
    s_nop 0
    buffer_load_dwordx4 v0, s[44:47], m0 offen sc1 lds
    s_add_u32 m0, s78, 40960
    s_waitcnt vmcnt(10)
    s_barrier
    s_waitcnt lgkmcnt(7)
    v_mfma_f32_16x16x32_bf16 v[76:79], a[196:199], v[28:31], 0
    v_mfma_f32_16x16x32_bf16 v[96:99], v[28:31], a[200:203], 0
    buffer_load_dwordx4 v0, s[44:47], m0 offen sc1 lds
    ds_read_b128 v[28:31], v0 offset:8192
    s_waitcnt lgkmcnt(1)
    v_mfma_f32_16x16x32_bf16 v[80:83], a[196:199], v[32:35], 0
    s_add_u32 m0, s78, 43008
    v_mfma_f32_16x16x32_bf16 v[100:103], v[32:35], a[200:203], 0
    ds_read_b128 v[32:35], v0 offset:9216
    v_mfma_f32_16x16x32_bf16 v[84:87], a[196:199], v[36:39], 0
    v_mfma_f32_16x16x32_bf16 v[104:107], v[36:39], a[200:203], 0
    buffer_load_dwordx4 v0, s[44:47], m0 offen sc1 lds
    ds_read_b128 v[36:39], v0 offset:10240
    v_mfma_f32_16x16x32_bf16 v[88:91], a[196:199], v[40:43], 0
    s_add_u32 m0, s78, 49152
    v_mfma_f32_16x16x32_bf16 v[108:111], v[40:43], a[200:203], 0
    ds_read_b128 v[40:43], v0 offset:11264
    v_mfma_f32_16x16x32_bf16 v[76:79], a[208:211], v[44:47], v[76:79]
    v_mfma_f32_16x16x32_bf16 v[96:99], v[44:47], a[212:215], v[96:99]
    ds_read_b128 v[44:47], v0 offset:12288
    buffer_load_dwordx4 v0, s[44:47], m0 offen sc1 lds
    v_mfma_f32_16x16x32_bf16 v[80:83], a[208:211], v[48:51], v[80:83]
    s_add_u32 m0, s78, 51200
    v_mfma_f32_16x16x32_bf16 v[100:103], v[48:51], a[212:215], v[100:103]
    ds_read_b128 v[48:51], v0 offset:13312
    v_mfma_f32_16x16x32_bf16 v[84:87], a[208:211], v[52:55], v[84:87]
    v_mfma_f32_16x16x32_bf16 v[104:107], v[52:55], a[212:215], v[104:107]
    ds_read_b128 v[52:55], v0 offset:14336
    v_mfma_f32_16x16x32_bf16 v[88:91], a[208:211], v[56:59], v[88:91]
    buffer_load_dwordx4 v0, s[44:47], m0 offen sc1 lds
    s_add_u32 m0, s78, 57344
    v_mfma_f32_16x16x32_bf16 v[108:111], v[56:59], a[212:215], v[108:111]
    ds_read_b128 v[56:59], v0 offset:15360
    s_waitcnt lgkmcnt(4)
    v_mfma_f32_16x16x32_bf16 v[76:79], a[220:223], v[28:31], v[76:79]
    s_waitcnt vmcnt(6)
    s_barrier
    v_mfma_f32_16x16x32_bf16 v[96:99], v[28:31], a[224:227], v[96:99]
    ds_read_b128 v[28:31], v0 offset:16384
    v_mfma_f32_16x16x32_bf16 v[80:83], a[220:223], v[32:35], v[80:83]
    buffer_load_dwordx4 v0, s[44:47], m0 offen sc1 lds
    s_add_u32 m0, s78, 59392
    v_mfma_f32_16x16x32_bf16 v[100:103], v[32:35], a[224:227], v[100:103]
    ds_read_b128 v[32:35], v0 offset:17408
    v_mfma_f32_16x16x32_bf16 v[84:87], a[220:223], v[36:39], v[84:87]
    v_mfma_f32_16x16x32_bf16 v[104:107], v[36:39], a[224:227], v[104:107]
    ds_read_b128 v[36:39], v0 offset:18432
    v_mfma_f32_16x16x32_bf16 v[88:91], a[220:223], v[40:43], v[88:91]
    buffer_load_dwordx4 v0, s[44:47], m0 offen sc1 lds
    v_mfma_f32_16x16x32_bf16 v[108:111], v[40:43], a[224:227], v[108:111]
    ds_read_b128 v[40:43], v0 offset:19456
    s_add_u32 m0, s62, 90112
    s_waitcnt lgkmcnt(4)
    v_mfma_f32_16x16x32_bf16 v[76:79], a[232:235], v[44:47], v[76:79]
    v_mfma_f32_16x16x32_bf16 v[96:99], v[44:47], a[236:239], v[96:99]
    ds_read_b128 v[44:47], v0 offset:20480
    v_add_f32 v116, v116, v117
    v_mfma_f32_16x16x32_bf16 v[80:83], a[232:235], v[48:51], v[80:83]
    v_add_f32 v118, v118, v119
    v_add_f32 v116, v116, v118
    v_mfma_f32_16x16x32_bf16 v[100:103], v[48:51], a[236:239], v[100:103]
    ds_read_b128 v[48:51], v0 offset:21504
    v_mov_b32 v117, v116
    v_mfma_f32_16x16x32_bf16 v[84:87], a[232:235], v[52:55], v[84:87]
    s_nop 0
    v_permlane32_swap_b32 v116, v117
    v_mfma_f32_16x16x32_bf16 v[104:107], v[52:55], a[236:239], v[104:107]
    ds_read_b128 v[52:55], v0 offset:22528
    v_add_f32 v116, v116, v117
    v_mfma_f32_16x16x32_bf16 v[88:91], a[232:235], v[56:59], v[88:91]
    v_mov_b32 v117, v116
    v_mfma_f32_16x16x32_bf16 v[108:111], v[56:59], a[236:239], v[108:111]
    ds_read_b128 v[56:59], v0 offset:23552
    v_permlane16_swap_b32 v116, v117
    s_waitcnt lgkmcnt(4)
    v_mfma_f32_16x16x32_bf16 v[76:79], a[244:247], v[28:31], v[76:79]
    v_mul_f32 v116, 0x3b000000, v116
    v_mul_f32 v117, 0x3b000000, v117
    v_mfma_f32_16x16x32_bf16 v[96:99], v[28:31], a[248:251], v[96:99]
    ds_read_b128 v[28:31], v0 offset:24576
    v_fma_f32 v117, -v116, v116, v117
    v_mfma_f32_16x16x32_bf16 v[80:83], a[244:247], v[32:35], v[80:83]
    v_max_f32 v117, 0, v117
    v_add_f32 v117, 0x3727c5ac, v117
    v_mfma_f32_16x16x32_bf16 v[100:103], v[32:35], a[248:251], v[100:103]
    ds_read_b128 v[32:35], v0 offset:25600
    v_rsq_f32 v117, v117
    v_mfma_f32_16x16x32_bf16 v[84:87], a[244:247], v[36:39], v[84:87]
    s_mov_b64 exec, 0xffff
    ds_write_b32 v17, v116
    ds_write_b32 v17, v117 offset:512
    s_mov_b64 exec, -1
    v_mfma_f32_16x16x32_bf16 v[104:107], v[36:39], a[248:251], v[104:107]
    ds_read_b128 v[36:39], v0 offset:26624
    v_mfma_f32_16x16x32_bf16 v[88:91], a[244:247], v[40:43], v[88:91]
    v_mfma_f32_16x16x32_bf16 v[108:111], v[40:43], a[248:251], v[108:111]
    ds_read_b128 v[40:43], v0 offset:27648
    s_waitcnt lgkmcnt(6)
    v_mfma_f32_16x16x32_bf16 v[76:79], v[128:131], v[44:47], v[76:79]
    v_mfma_f32_16x16x32_bf16 v[96:99], v[44:47], v[132:135], v[96:99]
    ds_read_b128 v[44:47], v0 offset:28672
    v_mfma_f32_16x16x32_bf16 v[80:83], v[128:131], v[48:51], v[80:83]
    v_mfma_f32_16x16x32_bf16 v[100:103], v[48:51], v[132:135], v[100:103]
    ds_read_b128 v[48:51], v0 offset:29696
    v_mfma_f32_16x16x32_bf16 v[84:87], v[128:131], v[52:55], v[84:87]
    v_mfma_f32_16x16x32_bf16 v[104:107], v[52:55], v[132:135], v[104:107]
    ds_read_b128 v[52:55], v0 offset:30720
    v_mfma_f32_16x16x32_bf16 v[88:91], v[128:131], v[56:59], v[88:91]
    v_mfma_f32_16x16x32_bf16 v[108:111], v[56:59], v[132:135], v[108:111]
    ds_read_b128 v[56:59], v0 offset:31744
    s_waitcnt lgkmcnt(4)
    v_mfma_f32_16x16x32_bf16 v[76:79], v[140:143], v[28:31], v[76:79]
    s_waitcnt vmcnt(0)
    s_barrier
    v_mfma_f32_16x16x32_bf16 v[96:99], v[28:31], v[144:147], v[96:99]
    buffer_load_dwordx4 v22, s[24:27], s86 offen lds
    ds_read_b128 v[28:31], v0 offset:32768
    v_mfma_f32_16x16x32_bf16 v[80:83], v[140:143], v[32:35], v[80:83]
    s_add_u32 m0, s62, 94208
    s_add_u32 s86, s60, 2
    v_mfma_f32_16x16x32_bf16 v[100:103], v[32:35], v[144:147], v[100:103]
    ds_read_b128 v[32:35], v0 offset:33792
    s_and_b32 s86, s86, 15
    v_mfma_f32_16x16x32_bf16 v[84:87], v[140:143], v[36:39], v[84:87]
    s_mul_i32 s86, s86, 32768
    v_mfma_f32_16x16x32_bf16 v[104:107], v[36:39], v[144:147], v[104:107]
    ds_read_b128 v[36:39], v0 offset:34816
    buffer_load_dwordx4 v22, s[24:27], s87 offen lds
    v_mfma_f32_16x16x32_bf16 v[88:91], v[140:143], v[40:43], v[88:91]
    s_add_u32 m0, s62, 98304
    s_add_u32 s87, s60, 3
    v_mfma_f32_16x16x32_bf16 v[108:111], v[40:43], v[144:147], v[108:111]
    ds_read_b128 v[40:43], v0 offset:35840
    s_and_b32 s87, s87, 15
    s_waitcnt lgkmcnt(4)
    v_mfma_f32_16x16x32_bf16 v[76:79], v[152:155], v[44:47], v[76:79]
    s_mul_i32 s87, s87, 32768
    v_mfma_f32_16x16x32_bf16 v[96:99], v[44:47], v[156:159], v[96:99]
    ds_read_b128 v[44:47], v0 offset:36864
    buffer_load_dwordx4 v22, s[24:27], s86 offen lds
    v_mfma_f32_16x16x32_bf16 v[80:83], v[152:155], v[48:51], v[80:83]
    s_add_u32 m0, s62, 102400
    s_add_u32 s86, s60, 4
    v_mfma_f32_16x16x32_bf16 v[100:103], v[48:51], v[156:159], v[100:103]
    ds_read_b128 v[48:51], v0 offset:37888
    s_and_b32 s86, s86, 15
    v_mfma_f32_16x16x32_bf16 v[84:87], v[152:155], v[52:55], v[84:87]
    s_mul_i32 s86, s86, 32768
    v_mfma_f32_16x16x32_bf16 v[104:107], v[52:55], v[156:159], v[104:107]
    ds_read_b128 v[52:55], v0 offset:38912
    v_mfma_f32_16x16x32_bf16 v[88:91], v[152:155], v[56:59], v[88:91]
    buffer_load_dwordx4 v22, s[24:27], s87 offen lds
    s_add_u32 m0, s62, 106496
    v_mfma_f32_16x16x32_bf16 v[108:111], v[56:59], v[156:159], v[108:111]
    ds_read_b128 v[56:59], v0 offset:39936
    s_barrier
    s_waitcnt lgkmcnt(4)
    v_mfma_f32_16x16x32_bf16 v[76:79], v[164:167], v[28:31], v[76:79]
    ds_read_b128 v[116:119], v12
    ds_read_b128 v[120:123], v12 offset:64
    v_mfma_f32_16x16x32_bf16 v[96:99], v[28:31], v[168:171], v[96:99]
    ds_read_b32 v124, v13 offset:128
    ds_read_b128 v[28:31], v0 offset:40960
    v_mfma_f32_16x16x32_bf16 v[80:83], v[164:167], v[32:35], v[80:83]
    buffer_load_dwordx4 v22, s[24:27], s86 offen lds
    s_add_u32 s87, s60, 5
    v_mfma_f32_16x16x32_bf16 v[100:103], v[32:35], v[168:171], v[100:103]
    ds_read_b128 v[32:35], v0 offset:41984
    s_and_b32 s87, s87, 15
    v_mfma_f32_16x16x32_bf16 v[84:87], v[164:167], v[36:39], v[84:87]
    s_mul_i32 s87, s87, 32768
    s_add_u32 m0, s62, 110592
    v_mfma_f32_16x16x32_bf16 v[104:107], v[36:39], v[168:171], v[104:107]
    ds_read_b128 v[36:39], v0 offset:43008
    s_add_u32 s86, s60, 6
    v_mfma_f32_16x16x32_bf16 v[88:91], v[164:167], v[40:43], v[88:91]
    s_and_b32 s86, s86, 15
    buffer_load_dwordx4 v22, s[24:27], s87 offen lds
    v_mfma_f32_16x16x32_bf16 v[108:111], v[40:43], v[168:171], v[108:111]
    ds_read_b128 v[40:43], v0 offset:44032
    s_mul_i32 s86, s86, 32768
    s_waitcnt lgkmcnt(6)
    v_mfma_f32_16x16x32_bf16 v[76:79], v[176:179], v[44:47], v[76:79]
    s_add_u32 m0, s62, 114688
    s_add_u32 s87, s60, 7
    v_mfma_f32_16x16x32_bf16 v[96:99], v[44:47], v[180:183], v[96:99]
    ds_read_b128 v[44:47], v0 offset:45056
    s_and_b32 s87, s87, 15
    v_mfma_f32_16x16x32_bf16 v[80:83], v[176:179], v[48:51], v[80:83]
    s_mul_i32 s87, s87, 32768
    buffer_load_dwordx4 v22, s[24:27], s86 offen lds
    v_mfma_f32_16x16x32_bf16 v[100:103], v[48:51], v[180:183], v[100:103]
    ds_read_b128 v[48:51], v0 offset:46080
    s_add_u32 m0, s62, 118784
    v_mfma_f32_16x16x32_bf16 v[84:87], v[176:179], v[52:55], v[84:87]
    s_add_u32 s86, s60, 8
    s_and_b32 s86, s86, 15
    v_mfma_f32_16x16x32_bf16 v[104:107], v[52:55], v[180:183], v[104:107]
    ds_read_b128 v[52:55], v0 offset:47104
    s_mul_i32 s86, s86, 32768
    v_mfma_f32_16x16x32_bf16 v[88:91], v[176:179], v[56:59], v[88:91]
    v_mfma_f32_16x16x32_bf16 v[108:111], v[56:59], v[180:183], v[108:111]
    buffer_load_dwordx4 v22, s[24:27], s87 offen lds
    ds_read_b128 v[56:59], v0 offset:48128
    s_waitcnt lgkmcnt(4)
    v_mfma_f32_16x16x32_bf16 v[76:79], v[188:191], v[28:31], v[76:79]
    s_add_u32 m0, s62, 122880
    s_add_u32 s87, s60, 9
    v_mfma_f32_16x16x32_bf16 v[96:99], v[28:31], v[192:195], v[96:99]
    ds_read_b128 v[28:31], v0 offset:49152
    s_and_b32 s87, s87, 15
    v_mfma_f32_16x16x32_bf16 v[80:83], v[188:191], v[32:35], v[80:83]
    s_mul_i32 s87, s87, 32768
    v_mfma_f32_16x16x32_bf16 v[100:103], v[32:35], v[192:195], v[100:103]
    buffer_load_dwordx4 v22, s[24:27], s86 offen lds
    ds_read_b128 v[32:35], v0 offset:50176
    v_mfma_f32_16x16x32_bf16 v[84:87], v[188:191], v[36:39], v[84:87]
    s_add_u32 m0, s62, 126976
    s_add_u32 s86, s60, 10
    v_mfma_f32_16x16x32_bf16 v[104:107], v[36:39], v[192:195], v[104:107]
    ds_read_b128 v[36:39], v0 offset:51200
    s_and_b32 s86, s86, 15
    v_mfma_f32_16x16x32_bf16 v[88:91], v[188:191], v[40:43], v[88:91]
    s_mul_i32 s86, s86, 32768
    v_mfma_f32_16x16x32_bf16 v[108:111], v[40:43], v[192:195], v[108:111]
    ds_read_b128 v[40:43], v0 offset:52224
    buffer_load_dwordx4 v22, s[24:27], s87 offen lds
    s_waitcnt lgkmcnt(4)
    v_mfma_f32_16x16x32_bf16 v[76:79], v[200:203], v[44:47], v[76:79]
    s_add_u32 m0, s62, 131072
    s_add_u32 s87, s60, 11
    v_mfma_f32_16x16x32_bf16 v[96:99], v[44:47], v[204:207], v[96:99]
    ds_read_b128 v[44:47], v0 offset:53248
    s_and_b32 s87, s87, 15
    v_mfma_f32_16x16x32_bf16 v[80:83], v[200:203], v[48:51], v[80:83]
    s_mul_i32 s87, s87, 32768
    v_mfma_f32_16x16x32_bf16 v[100:103], v[48:51], v[204:207], v[100:103]
    ds_read_b128 v[48:51], v0 offset:54272
    buffer_load_dwordx4 v22, s[24:27], s86 offen lds
    v_mfma_f32_16x16x32_bf16 v[84:87], v[200:203], v[52:55], v[84:87]
    s_add_u32 m0, s62, 135168
    s_add_u32 s86, s60, 12
    v_mfma_f32_16x16x32_bf16 v[104:107], v[52:55], v[204:207], v[104:107]
    ds_read_b128 v[52:55], v0 offset:55296
    s_and_b32 s86, s86, 15
    v_mfma_f32_16x16x32_bf16 v[88:91], v[200:203], v[56:59], v[88:91]
    s_mul_i32 s86, s86, 32768
    v_mfma_f32_16x16x32_bf16 v[108:111], v[56:59], v[204:207], v[108:111]
    ds_read_b128 v[56:59], v0 offset:56320
    s_waitcnt lgkmcnt(4)
    v_mfma_f32_16x16x32_bf16 v[76:79], v[212:215], v[28:31], v[76:79]
    buffer_load_dwordx4 v22, s[24:27], s87 offen lds
    s_add_u32 m0, s62, 139264
    v_mfma_f32_16x16x32_bf16 v[96:99], v[28:31], v[216:219], v[96:99]
    ds_read_b128 v[28:31], v0 offset:57344
    s_add_u32 s87, s60, 13
    v_mfma_f32_16x16x32_bf16 v[80:83], v[212:215], v[32:35], v[80:83]
    s_and_b32 s87, s87, 15
    s_mul_i32 s87, s87, 32768
    v_mfma_f32_16x16x32_bf16 v[100:103], v[32:35], v[216:219], v[100:103]
    ds_read_b128 v[32:35], v0 offset:58368
    v_mfma_f32_16x16x32_bf16 v[84:87], v[212:215], v[36:39], v[84:87]
    buffer_load_dwordx4 v22, s[24:27], s86 offen lds
    v_mfma_f32_16x16x32_bf16 v[104:107], v[36:39], v[216:219], v[104:107]
    ds_read_b128 v[36:39], v0 offset:59392
    s_add_u32 m0, s62, 143360
    v_mfma_f32_16x16x32_bf16 v[88:91], v[212:215], v[40:43], v[88:91]
    s_add_u32 s86, s60, 14
    s_and_b32 s86, s86, 15
    v_mfma_f32_16x16x32_bf16 v[108:111], v[40:43], v[216:219], v[108:111]
    ds_read_b128 v[40:43], v0 offset:60416
    s_mul_i32 s86, s86, 32768
    s_waitcnt lgkmcnt(4)
    v_mfma_f32_16x16x32_bf16 v[76:79], v[224:227], v[44:47], v[76:79]
    buffer_load_dwordx4 v22, s[24:27], s87 offen lds
    v_mfma_f32_16x16x32_bf16 v[96:99], v[44:47], v[228:231], v[96:99]
    ds_read_b128 v[44:47], v0 offset:61440
    s_add_u32 m0, s62, 147456
    v_mfma_f32_16x16x32_bf16 v[80:83], v[224:227], v[48:51], v[80:83]
    s_add_u32 s87, s60, 15
    s_and_b32 s87, s87, 15
    v_mfma_f32_16x16x32_bf16 v[100:103], v[48:51], v[228:231], v[100:103]
    ds_read_b128 v[48:51], v0 offset:62464
    s_mul_i32 s87, s87, 32768
    v_mfma_f32_16x16x32_bf16 v[84:87], v[224:227], v[52:55], v[84:87]
    v_mfma_f32_16x16x32_bf16 v[104:107], v[52:55], v[228:231], v[104:107]
    buffer_load_dwordx4 v22, s[24:27], s86 offen lds
    ds_read_b128 v[52:55], v0 offset:63488
    v_mfma_f32_16x16x32_bf16 v[88:91], v[224:227], v[56:59], v[88:91]
    s_add_u32 m0, s62, 151552
    v_mfma_f32_16x16x32_bf16 v[108:111], v[56:59], v[228:231], v[108:111]
    ds_read_b128 v[56:59], v0 offset:64512
    s_waitcnt lgkmcnt(4)
    v_mfma_f32_16x16x32_bf16 v[76:79], v[236:239], v[28:31], v[76:79]
    v_mfma_f32_16x16x32_bf16 v[96:99], v[28:31], v[240:243], v[96:99]
    buffer_load_dwordx4 v22, s[24:27], s87 offen lds
    v_and_b32 v22, 15, v23
    v_mfma_f32_16x16x32_bf16 v[80:83], v[236:239], v[32:35], v[80:83]
    v_lshlrev_b32 v22, 2, v22
    v_add_u32 v22, 155648, v22
    v_mfma_f32_16x16x32_bf16 v[100:103], v[32:35], v[240:243], v[100:103]
    ds_read2_b32 v[12:13], v22 offset0:0 offset1:128
    ds_read2_b32 v[14:15], v22 offset0:16 offset1:144
    v_mfma_f32_16x16x32_bf16 v[84:87], v[236:239], v[36:39], v[84:87]
    ds_read2_b32 v[16:17], v22 offset0:32 offset1:160
    ds_read2_b32 v[18:19], v22 offset0:48 offset1:176
    v_mfma_f32_16x16x32_bf16 v[104:107], v[36:39], v[240:243], v[104:107]
    v_and_b32 v23, 48, v23
    v_add_u32 v23, 155648, v23
    v_mfma_f32_16x16x32_bf16 v[88:91], v[236:239], v[40:43], v[88:91]
    ds_read_b128 v[36:39], v23 offset:0
    v_mfma_f32_16x16x32_bf16 v[108:111], v[40:43], v[240:243], v[108:111]
    ds_read_b128 v[40:43], v23 offset:512
    s_waitcnt lgkmcnt(6)
    v_mfma_f32_16x16x32_bf16 v[76:79], v[248:251], v[44:47], v[76:79]
    v_mfma_f32_16x16x32_bf16 v[96:99], v[44:47], v[252:255], v[96:99]
    ds_read_b128 v[44:47], v23 offset:64
    v_mfma_f32_16x16x32_bf16 v[80:83], v[248:251], v[48:51], v[80:83]
    v_mfma_f32_16x16x32_bf16 v[100:103], v[48:51], v[252:255], v[100:103]
    ds_read_b128 v[48:51], v23 offset:576
    v_mfma_f32_16x16x32_bf16 v[84:87], v[248:251], v[52:55], v[84:87]
    v_mfma_f32_16x16x32_bf16 v[104:107], v[52:55], v[252:255], v[104:107]
    v_mov_b32 v53, s50
    v_mfma_f32_16x16x32_bf16 v[88:91], v[248:251], v[56:59], v[88:91]
    v_mfma_f32_16x16x32_bf16 v[108:111], v[56:59], v[252:255], v[108:111]
    v_lshrrev_b32 v58, 4, v0
    v_and_b32 v59, 3, v58
    s_waitcnt lgkmcnt(2)
    v_pk_fma_f32 v[76:77], v[120:121], v[12:13], v[76:77] op_sel_hi:[1,0,1] neg_lo:[0,1,0] neg_hi:[0,1,0]
    v_pk_fma_f32 v[78:79], v[122:123], v[12:13], v[78:79] op_sel_hi:[1,0,1] neg_lo:[0,1,0] neg_hi:[0,1,0]
    v_pk_mul_f32 v[76:77], v[76:77], v[12:13] op_sel:[0,1] op_sel_hi:[1,1]
    v_pk_mul_f32 v[78:79], v[78:79], v[12:13] op_sel:[0,1] op_sel_hi:[1,1]
    v_cvt_pk_bf16_f32 v76, v76, v77
    v_cvt_pk_bf16_f32 v77, v78, v79
    v_pk_fma_f32 v[80:81], v[120:121], v[14:15], v[80:81] op_sel_hi:[1,0,1] neg_lo:[0,1,0] neg_hi:[0,1,0]
    v_pk_fma_f32 v[82:83], v[122:123], v[14:15], v[82:83] op_sel_hi:[1,0,1] neg_lo:[0,1,0] neg_hi:[0,1,0]
    v_mfma_f32_16x16x16_bf16 v[60:63], v[10:11], v[76:77], 0
    v_cmp_eq_u32 vcc, 0, v59
    v_mov_b32 v56, 0x3f80
    v_pk_mul_f32 v[80:81], v[80:81], v[14:15] op_sel:[0,1] op_sel_hi:[1,1]
    v_pk_mul_f32 v[82:83], v[82:83], v[14:15] op_sel:[0,1] op_sel_hi:[1,1]
    v_cvt_pk_bf16_f32 v80, v80, v81
    v_cvt_pk_bf16_f32 v81, v82, v83
    v_pk_fma_f32 v[84:85], v[120:121], v[16:17], v[84:85] op_sel_hi:[1,0,1] neg_lo:[0,1,0] neg_hi:[0,1,0]
    v_pk_fma_f32 v[86:87], v[122:123], v[16:17], v[86:87] op_sel_hi:[1,0,1] neg_lo:[0,1,0] neg_hi:[0,1,0]
    v_mfma_f32_16x16x16_bf16 v[64:67], v[10:11], v[80:81], 0
    v_cndmask_b32 v52, 0, v53, vcc
    v_cmp_eq_u32 vcc, 1, v59
    v_pk_mul_f32 v[84:85], v[84:85], v[16:17] op_sel:[0,1] op_sel_hi:[1,1]
    v_pk_mul_f32 v[86:87], v[86:87], v[16:17] op_sel:[0,1] op_sel_hi:[1,1]
    v_cvt_pk_bf16_f32 v84, v84, v85
    v_cvt_pk_bf16_f32 v85, v86, v87
    v_pk_fma_f32 v[88:89], v[120:121], v[18:19], v[88:89] op_sel_hi:[1,0,1] neg_lo:[0,1,0] neg_hi:[0,1,0]
    v_pk_fma_f32 v[90:91], v[122:123], v[18:19], v[90:91] op_sel_hi:[1,0,1] neg_lo:[0,1,0] neg_hi:[0,1,0]
    v_mfma_f32_16x16x16_bf16 v[68:71], v[10:11], v[84:85], 0
    v_cndmask_b32 v54, 0, v53, vcc
    v_mov_b32 v53, v52
    v_pk_mul_f32 v[88:89], v[88:89], v[18:19] op_sel:[0,1] op_sel_hi:[1,1]
    v_pk_mul_f32 v[90:91], v[90:91], v[18:19] op_sel:[0,1] op_sel_hi:[1,1]
    v_cvt_pk_bf16_f32 v88, v88, v89
    v_cvt_pk_bf16_f32 v89, v90, v91
    v_pk_fma_f32 v[96:97], v[36:37], v[124:125], v[96:97] op_sel_hi:[1,0,1] neg_lo:[0,1,0] neg_hi:[0,1,0]
    v_pk_fma_f32 v[98:99], v[38:39], v[124:125], v[98:99] op_sel_hi:[1,0,1] neg_lo:[0,1,0] neg_hi:[0,1,0]
    v_mfma_f32_16x16x16_bf16 v[72:75], v[10:11], v[88:89], 0
    ds_read_b128 v[36:39], v23 offset:128
    v_mov_b32 v55, v54
    v_pk_mul_f32 v[96:97], v[96:97], v[40:41]
    v_pk_mul_f32 v[98:99], v[98:99], v[42:43]
    ds_read_b128 v[40:43], v23 offset:640
    v_cvt_pk_bf16_f32 v28, v96, v97
    v_cvt_pk_bf16_f32 v29, v98, v99
    s_waitcnt lgkmcnt(2)
    v_pk_fma_f32 v[100:101], v[44:45], v[124:125], v[100:101] op_sel_hi:[1,0,1] neg_lo:[0,1,0] neg_hi:[0,1,0]
    v_pk_fma_f32 v[102:103], v[46:47], v[124:125], v[102:103] op_sel_hi:[1,0,1] neg_lo:[0,1,0] neg_hi:[0,1,0]
    ds_read_b128 v[44:47], v23 offset:192
    v_pk_mul_f32 v[100:101], v[100:101], v[48:49]
    v_pk_mul_f32 v[102:103], v[102:103], v[50:51]
    ds_read_b128 v[48:51], v23 offset:704
    v_cvt_pk_bf16_f32 v30, v100, v101
    v_cvt_pk_bf16_f32 v31, v102, v103
    v_and_b32 v59, 1, v58
    v_lshlrev_b32 v59, 4, v59
    v_lshlrev_b32 v59, v59, v56
    v_bfe_u32 v58, v58, 1, 1
    v_cndmask_b32 v59, 0, v59, s[56:57]
    v_cmp_eq_u32 vcc, 0, v58
    v_max3_f32 v12, v60, v61, v62
    v_max3_f32 v16, -v60, -v61, -v62
    v_cndmask_b32 v56, 0, v59, vcc
    v_cndmask_b32 v57, v59, 0, vcc
    v_max_f32 v12, v12, v63
    v_max_f32_e64 v16, v16, -v63
    v_max3_f32 v13, v64, v65, v66
    v_max3_f32 v17, -v64, -v65, -v66
    s_waitcnt lgkmcnt(3)
    v_pk_fma_f32 v[104:105], v[36:37], v[124:125], v[104:105] op_sel_hi:[1,0,1] neg_lo:[0,1,0] neg_hi:[0,1,0]
    v_pk_fma_f32 v[106:107], v[38:39], v[124:125], v[106:107] op_sel_hi:[1,0,1] neg_lo:[0,1,0] neg_hi:[0,1,0]
    v_max_f32 v13, v13, v67
    s_waitcnt lgkmcnt(2)
    v_pk_mul_f32 v[104:105], v[104:105], v[40:41]
    v_pk_mul_f32 v[106:107], v[106:107], v[42:43]
    v_cvt_pk_bf16_f32 v32, v104, v105
    v_cvt_pk_bf16_f32 v33, v106, v107
    v_max_f32_e64 v17, v17, -v67
    s_waitcnt lgkmcnt(1)
    v_pk_fma_f32 v[108:109], v[44:45], v[124:125], v[108:109] op_sel_hi:[1,0,1] neg_lo:[0,1,0] neg_hi:[0,1,0]
    v_pk_fma_f32 v[110:111], v[46:47], v[124:125], v[110:111] op_sel_hi:[1,0,1] neg_lo:[0,1,0] neg_hi:[0,1,0]
    s_waitcnt lgkmcnt(0)
    v_pk_mul_f32 v[108:109], v[108:109], v[48:49]
    v_pk_mul_f32 v[110:111], v[110:111], v[50:51]
    v_cvt_pk_bf16_f32 v34, v108, v109
    v_cvt_pk_bf16_f32 v35, v110, v111
    v_max3_f32 v14, v68, v69, v70
    v_max3_f32 v18, -v68, -v69, -v70
    v_max_f32 v14, v14, v71
    v_max_f32_e64 v18, v18, -v71
    v_max3_f32 v15, v72, v73, v74
    v_max3_f32 v19, -v72, -v73, -v74
    v_max_f32 v15, v15, v75
    v_max_f32_e64 v19, v19, -v75
    v_permlane32_swap_b32 v12, v13
    v_permlane32_swap_b32 v14, v15
    v_max_f32 v12, v12, v13
    v_max_f32 v14, v14, v15
    v_permlane32_swap_b32 v16, v17
    s_nop 0
    v_permlane16_swap_b32 v12, v14
    v_max_f32 v12, v12, v14
    v_mul_f32 v12, s52, v12
    v_mov_b32 v14, v12
    v_permlane32_swap_b32 v18, v19
    s_nop 0
    v_permlane16_swap_b32 v12, v14
    v_mov_b32 v13, v12
    v_mov_b32 v15, v14
    v_max_f32 v16, v16, v17
    v_permlane32_swap_b32 v12, v13
    v_permlane32_swap_b32 v14, v15
    v_max_f32 v18, v18, v19
    v_pk_fma_f32 v[76:77], v[60:61], s[52:53], v[12:13] op_sel:[0,0,0] op_sel_hi:[1,1,0] neg_lo:[0,0,1] neg_hi:[0,0,1]
    v_pk_fma_f32 v[78:79], v[62:63], s[52:53], v[12:13] op_sel:[0,0,0] op_sel_hi:[1,1,0] neg_lo:[0,0,1] neg_hi:[0,0,1]
    v_permlane16_swap_b32 v16, v18
    v_max_f32 v16, v16, v18
    v_mul_f32 v16, s52, v16
    v_mov_b32 v18, v16
    v_exp_f32 v76, v76
    s_nop 0
    v_permlane16_swap_b32 v16, v18
    v_mov_b32 v17, v16
    v_mov_b32 v19, v18
    v_exp_f32 v77, v77
    v_permlane32_swap_b32 v16, v17
    v_permlane32_swap_b32 v18, v19
    v_pk_fma_f32 v[80:81], v[60:61], s[52:53], v[16:17] op_sel:[0,0,0] op_sel_hi:[1,1,0] neg_lo:[0,1,1] neg_hi:[0,1,1]
    v_pk_fma_f32 v[82:83], v[62:63], s[52:53], v[16:17] op_sel:[0,0,0] op_sel_hi:[1,1,0] neg_lo:[0,1,1] neg_hi:[0,1,1]
    v_exp_f32 v78, v78
    v_exp_f32 v79, v79
    v_exp_f32 v80, v80
    v_exp_f32 v81, v81
    v_exp_f32 v82, v82
    v_exp_f32 v83, v83
    v_cvt_pk_bf16_f32 v36, v76, v77
    v_cvt_pk_bf16_f32 v37, v78, v79
    v_cvt_pk_bf16_f32 v38, v80, v81
    v_cvt_pk_bf16_f32 v39, v82, v83
    v_pk_fma_f32 v[84:85], v[64:65], s[52:53], v[12:13] op_sel:[0,0,1] op_sel_hi:[1,1,1] neg_lo:[0,0,1] neg_hi:[0,0,1]
    v_pk_fma_f32 v[88:89], v[64:65], s[52:53], v[16:17] op_sel:[0,0,1] op_sel_hi:[1,1,1] neg_lo:[0,1,1] neg_hi:[0,1,1]
    v_pk_fma_f32 v[86:87], v[66:67], s[52:53], v[12:13] op_sel:[0,0,1] op_sel_hi:[1,1,1] neg_lo:[0,0,1] neg_hi:[0,0,1]
    v_pk_fma_f32 v[90:91], v[66:67], s[52:53], v[16:17] op_sel:[0,0,1] op_sel_hi:[1,1,1] neg_lo:[0,1,1] neg_hi:[0,1,1]
    v_exp_f32 v84, v84
    v_mfma_f32_16x16x32_bf16 v[60:63], v[52:55], v[36:39], 0
    v_exp_f32 v85, v85
    v_exp_f32 v86, v86
    v_exp_f32 v87, v87
    v_exp_f32 v88, v88
    v_exp_f32 v89, v89
    v_exp_f32 v90, v90
    v_exp_f32 v91, v91
    v_cvt_pk_bf16_f32 v40, v84, v85
    v_cvt_pk_bf16_f32 v41, v86, v87
    v_cvt_pk_bf16_f32 v42, v88, v89
    v_cvt_pk_bf16_f32 v43, v90, v91
    v_pk_fma_f32 v[92:93], v[68:69], s[52:53], v[14:15] op_sel:[0,0,0] op_sel_hi:[1,1,0] neg_lo:[0,0,1] neg_hi:[0,0,1]
    v_pk_fma_f32 v[96:97], v[68:69], s[52:53], v[18:19] op_sel:[0,0,0] op_sel_hi:[1,1,0] neg_lo:[0,1,1] neg_hi:[0,1,1]
    v_mfma_f32_16x16x32_bf16 v[64:67], v[52:55], v[40:43], 0
    v_exp_f32 v92, v92
    v_pk_fma_f32 v[94:95], v[70:71], s[52:53], v[14:15] op_sel:[0,0,0] op_sel_hi:[1,1,0] neg_lo:[0,0,1] neg_hi:[0,0,1]
    v_pk_fma_f32 v[98:99], v[70:71], s[52:53], v[18:19] op_sel:[0,0,0] op_sel_hi:[1,1,0] neg_lo:[0,1,1] neg_hi:[0,1,1]
    v_exp_f32 v93, v93
    v_exp_f32 v94, v94
    v_exp_f32 v95, v95
    v_exp_f32 v96, v96
    v_exp_f32 v97, v97
    v_exp_f32 v98, v98
    v_exp_f32 v99, v99
    v_cvt_pk_bf16_f32 v44, v92, v93
    v_cvt_pk_bf16_f32 v45, v94, v95
    v_cvt_pk_bf16_f32 v46, v96, v97
    v_cvt_pk_bf16_f32 v47, v98, v99
    v_pk_fma_f32 v[100:101], v[72:73], s[52:53], v[14:15] op_sel:[0,0,1] op_sel_hi:[1,1,1] neg_lo:[0,0,1] neg_hi:[0,0,1]
    v_pk_fma_f32 v[104:105], v[72:73], s[52:53], v[18:19] op_sel:[0,0,1] op_sel_hi:[1,1,1] neg_lo:[0,1,1] neg_hi:[0,1,1]
    v_pk_fma_f32 v[102:103], v[74:75], s[52:53], v[14:15] op_sel:[0,0,1] op_sel_hi:[1,1,1] neg_lo:[0,0,1] neg_hi:[0,0,1]
    v_pk_fma_f32 v[106:107], v[74:75], s[52:53], v[18:19] op_sel:[0,0,1] op_sel_hi:[1,1,1] neg_lo:[0,1,1] neg_hi:[0,1,1]
    v_exp_f32 v100, v100
    v_mfma_f32_16x16x32_bf16 v[68:71], v[52:55], v[44:47], 0
    v_exp_f32 v101, v101
    v_exp_f32 v102, v102
    v_exp_f32 v103, v103
    v_exp_f32 v104, v104
    v_exp_f32 v105, v105
    v_exp_f32 v106, v106
    v_exp_f32 v107, v107
    v_cvt_pk_bf16_f32 v48, v100, v101
    v_cvt_pk_bf16_f32 v49, v102, v103
    v_cvt_pk_bf16_f32 v50, v104, v105
    v_cvt_pk_bf16_f32 v51, v106, v107
    v_rcp_f32 v60, v60
    s_nop 0
    v_mfma_f32_16x16x32_bf16 v[72:75], v[52:55], v[48:51], 0
    v_rcp_f32 v61, v61
    v_rcp_f32 v64, v64
    v_pk_mul_f32 v[76:77], v[76:77], v[60:61] op_sel_hi:[1,0]
    v_pk_mul_f32 v[78:79], v[78:79], v[60:61] op_sel_hi:[1,0]
    v_pk_mul_f32 v[80:81], v[80:81], v[60:61] op_sel:[0,1] op_sel_hi:[1,1]
    v_pk_mul_f32 v[82:83], v[82:83], v[60:61] op_sel:[0,1] op_sel_hi:[1,1]
    v_cvt_pk_bf16_f32 v36, v76, v77
    v_cvt_pk_bf16_f32 v37, v78, v79
    v_cvt_pk_bf16_f32 v38, v80, v81
    v_cvt_pk_bf16_f32 v39, v82, v83
    v_mfma_f32_16x16x16_bf16 v[76:79], v[36:37], v[56:57], 0
    v_rcp_f32 v65, v65
    v_mfma_f32_16x16x16_bf16 v[80:83], v[38:39], v[56:57], 0
    v_rcp_f32 v68, v68
    v_pk_mul_f32 v[84:85], v[84:85], v[64:65] op_sel_hi:[1,0]
    v_pk_mul_f32 v[86:87], v[86:87], v[64:65] op_sel_hi:[1,0]
    v_pk_mul_f32 v[88:89], v[88:89], v[64:65] op_sel:[0,1] op_sel_hi:[1,1]
    v_pk_mul_f32 v[90:91], v[90:91], v[64:65] op_sel:[0,1] op_sel_hi:[1,1]
    v_cvt_pk_bf16_f32 v40, v84, v85
    v_cvt_pk_bf16_f32 v41, v86, v87
    v_cvt_pk_bf16_f32 v42, v88, v89
    v_cvt_pk_bf16_f32 v43, v90, v91
    v_mfma_f32_16x16x16_bf16 v[84:87], v[40:41], v[56:57], 0
    v_rcp_f32 v69, v69
    v_mfma_f32_16x16x16_bf16 v[88:91], v[42:43], v[56:57], 0
    v_rcp_f32 v72, v72
    v_pk_mul_f32 v[92:93], v[92:93], v[68:69] op_sel_hi:[1,0]
    v_pk_mul_f32 v[94:95], v[94:95], v[68:69] op_sel_hi:[1,0]
    v_pk_mul_f32 v[96:97], v[96:97], v[68:69] op_sel:[0,1] op_sel_hi:[1,1]
    v_pk_mul_f32 v[98:99], v[98:99], v[68:69] op_sel:[0,1] op_sel_hi:[1,1]
    v_cvt_pk_bf16_f32 v44, v92, v93
    v_cvt_pk_bf16_f32 v45, v94, v95
    v_cvt_pk_bf16_f32 v46, v96, v97
    v_cvt_pk_bf16_f32 v47, v98, v99
    v_mfma_f32_16x16x16_bf16 v[92:95], v[44:45], v[56:57], 0
    v_rcp_f32 v73, v73
    v_mfma_f32_16x16x16_bf16 v[96:99], v[46:47], v[56:57], 0
    v_cvt_pk_bf16_f32 v60, v76, v77
    v_cvt_pk_bf16_f32 v61, v78, v79
    v_pk_mul_f32 v[100:101], v[100:101], v[72:73] op_sel_hi:[1,0]
    v_pk_mul_f32 v[102:103], v[102:103], v[72:73] op_sel_hi:[1,0]
    v_pk_mul_f32 v[104:105], v[104:105], v[72:73] op_sel:[0,1] op_sel_hi:[1,1]
    v_pk_mul_f32 v[106:107], v[106:107], v[72:73] op_sel:[0,1] op_sel_hi:[1,1]
    v_cvt_pk_bf16_f32 v48, v100, v101
    v_cvt_pk_bf16_f32 v49, v102, v103
    v_cvt_pk_bf16_f32 v50, v104, v105
    v_cvt_pk_bf16_f32 v51, v106, v107
    v_mfma_f32_16x16x16_bf16 v[100:103], v[48:49], v[56:57], 0
    v_cvt_pk_bf16_f32 v64, v80, v81
    v_cvt_pk_bf16_f32 v65, v82, v83
    v_mfma_f32_16x16x16_bf16 v[104:107], v[50:51], v[56:57], 0
    v_cvt_pk_bf16_f32 v62, v84, v85
    v_cvt_pk_bf16_f32 v63, v86, v87
    v_cvt_pk_bf16_f32 v66, v88, v89
    v_cvt_pk_bf16_f32 v67, v90, v91
    v_mfma_f32_16x16x32_bf16 v[108:111], v[60:63], v[28:31], 0
    v_cvt_pk_bf16_f32 v68, v92, v93
    v_cvt_pk_bf16_f32 v69, v94, v95
    v_mfma_f32_16x16x32_bf16 v[116:119], v[60:63], v[24:27], 0
    v_cvt_pk_bf16_f32 v72, v96, v97
    v_cvt_pk_bf16_f32 v73, v98, v99
    v_mfma_f32_16x16x32_bf16 v[112:115], v[64:67], v[28:31], 0
    v_cvt_pk_bf16_f32 v70, v100, v101
    v_cvt_pk_bf16_f32 v71, v102, v103
    v_mfma_f32_16x16x32_bf16 v[120:123], v[64:67], v[24:27], 0
    v_cvt_pk_bf16_f32 v74, v104, v105
    v_cvt_pk_bf16_f32 v75, v106, v107
    v_mfma_f32_16x16x32_bf16 v[108:111], v[68:71], v[32:35], v[108:111]
    v_mfma_f32_16x16x32_bf16 v[116:119], v[68:71], v[24:27], v[116:119]
    v_mfma_f32_16x16x32_bf16 v[112:115], v[72:75], v[32:35], v[112:115]
    v_mfma_f32_16x16x32_bf16 v[120:123], v[72:75], v[24:27], v[120:123]
    s_nop 7
    v_cndmask_b32 v116, v116, v120, s[54:55]
    v_cndmask_b32 v117, v117, v121, s[54:55]
    v_cndmask_b32 v118, v118, v122, s[54:55]
    v_cndmask_b32 v119, v119, v123, s[54:55]
    s_cmp_eq_u32 s48, 0
    s_cbranch_scc1 L55
    buffer_store_dwordx4 v[108:111], v0, s[36:39], s82 offen
    buffer_store_dwordx4 v[112:115], v0, s[36:39], s82 offen offset:1024
L56:
    s_mov_b32 exec_lo, 0x01010101
    s_mov_b32 exec_hi, 0x01010101
    s_cmp_eq_u32 s48, 0
    s_cbranch_scc1 L57
    buffer_store_dwordx4 v[116:119], v20, s[36:39], s82 offen offset:2048
L58:
    s_mov_b64 exec, -1
    ds_read_b128 v[76:79], v0 offset:0
    ds_read_b128 v[80:83], v0 offset:1024
    ds_read_b128 v[84:87], v0 offset:2048
    ds_read_b128 v[88:91], v0 offset:3072
    ds_read_b128 v[92:95], v0 offset:4096
    ds_read_b128 v[96:99], v0 offset:5120
    ds_read_b128 v[100:103], v0 offset:6144
    ds_read_b128 v[104:107], v0 offset:7168
    v_mov_b32 v58, 8
    v_bfe_u32 v59, v0, 4, 2
    v_lshlrev_b32 v21, 7, v59
    s_lshl_b32 s89, s7, 7
    s_sub_u32 s88, s74, s89
    s_lshl_b32 s89, s4, 2
    s_add_u32 s89, s89, s3
    s_lshl_b32 s89, s89, 3
    s_add_u32 s89, s89, s6
    s_lshl_b32 s90, s89, 10
    s_add_u32 s90, s90, 9240576
    s_lshl_b32 s91, s89, 7
    s_add_u32 s91, s91, 9535488
    v_add_u32 v59, s7, v59
    v_add_u32 v59, 1, v59
    v_and_b32 v59, 3, v59
    v_mul_u32_u24 v59, 3072, v59
    v_add_u32 v59, v59, v20
    v_bfe_u32 v56, v0, 4, 3
    v_cmp_gt_u32 vcc, 3, v56
    v_mov_b32 v56, 0x7ff00000
    s_add_u32 s92, s7, 1
    s_waitcnt lgkmcnt(7)
    v_mfma_f32_16x16x32_bf16 v[60:63], a[192:195], v[76:79], 0
    ds_read_b128 v[76:79], v0 offset:8192
    v_cndmask_b32 v59, v56, v59, vcc
    s_waitcnt lgkmcnt(3)
    v_mfma_f32_16x16x32_bf16 v[64:67], a[192:195], v[80:83], 0
    ds_read_b128 v[80:83], v0 offset:9216
    s_and_b32 s92, s92, 3
    v_mfma_f32_16x16x32_bf16 v[68:71], a[192:195], v[84:87], 0
    ds_read_b128 v[84:87], v0 offset:10240
    s_mul_i32 s92, s92, 3072
    v_mfma_f32_16x16x32_bf16 v[72:75], a[192:195], v[88:91], 0
    ds_read_b128 v[88:91], v0 offset:11264
    s_add_u32 s92, s92, s77
    v_mfma_f32_16x16x32_bf16 v[60:63], a[204:207], v[92:95], v[60:63]
    ds_read_b128 v[92:95], v0 offset:12288
    s_add_u32 s93, s7, 2
    v_mfma_f32_16x16x32_bf16 v[64:67], a[204:207], v[96:99], v[64:67]
    ds_read_b128 v[96:99], v0 offset:13312
    s_and_b32 s93, s93, 3
    s_waitcnt lgkmcnt(6)
    v_mfma_f32_16x16x32_bf16 v[68:71], a[204:207], v[100:103], v[68:71]
    ds_read_b128 v[100:103], v0 offset:14336
    s_mul_i32 s93, s93, 3072
    v_mfma_f32_16x16x32_bf16 v[72:75], a[204:207], v[104:107], v[72:75]
    ds_read_b128 v[104:107], v0 offset:15360
    s_add_u32 s93, s93, s77
    s_waitcnt lgkmcnt(7)
    v_mfma_f32_16x16x32_bf16 v[60:63], a[216:219], v[76:79], v[60:63]
    ds_read_b128 v[76:79], v0 offset:16384
    s_add_u32 s94, s7, 3
    s_waitcnt lgkmcnt(7)
    v_mfma_f32_16x16x32_bf16 v[64:67], a[216:219], v[80:83], v[64:67]
    ds_read_b128 v[80:83], v0 offset:17408
    s_and_b32 s94, s94, 3
    s_waitcnt lgkmcnt(7)
    v_mfma_f32_16x16x32_bf16 v[68:71], a[216:219], v[84:87], v[68:71]
    ds_read_b128 v[84:87], v0 offset:18432
    s_mul_i32 s94, s94, 3072
    s_waitcnt lgkmcnt(6)
    v_mfma_f32_16x16x32_bf16 v[72:75], a[216:219], v[88:91], v[72:75]
    ds_read_b128 v[88:91], v0 offset:19456
    s_add_u32 s94, s94, s77
    v_mfma_f32_16x16x32_bf16 v[60:63], a[228:231], v[92:95], v[60:63]
    ds_read_b128 v[92:95], v0 offset:20480
    s_waitcnt lgkmcnt(6)
    v_mfma_f32_16x16x32_bf16 v[64:67], a[228:231], v[96:99], v[64:67]
    ds_read_b128 v[96:99], v0 offset:21504
    v_mfma_f32_16x16x32_bf16 v[68:71], a[228:231], v[100:103], v[68:71]
    ds_read_b128 v[100:103], v0 offset:22528
    s_waitcnt lgkmcnt(6)
    v_mfma_f32_16x16x32_bf16 v[72:75], a[228:231], v[104:107], v[72:75]
    s_waitcnt vmcnt(0)
    s_cmp_eq_u32 s48, 0
    s_cbranch_scc1 L59
    buffer_store_dword v58, off, s[36:39], s74
L60:
    v_mfma_f32_16x16x32_bf16 v[60:63], a[240:243], v[76:79], v[60:63]
    ds_read_b128 v[104:107], v0 offset:23552
    ds_read_b128 v[76:79], v0 offset:24576
    s_waitcnt lgkmcnt(6)
    v_mfma_f32_16x16x32_bf16 v[64:67], a[240:243], v[80:83], v[64:67]
    ds_read_b128 v[80:83], v0 offset:25600
    v_mfma_f32_16x16x32_bf16 v[68:71], a[240:243], v[84:87], v[68:71]
    ds_read_b128 v[84:87], v0 offset:26624
    s_waitcnt lgkmcnt(6)
    v_mfma_f32_16x16x32_bf16 v[72:75], a[240:243], v[88:91], v[72:75]
    ds_read_b128 v[88:91], v0 offset:27648
    v_mfma_f32_16x16x32_bf16 v[60:63], a[252:255], v[92:95], v[60:63]
    ds_read_b128 v[92:95], v0 offset:28672
    s_waitcnt lgkmcnt(6)
    v_mfma_f32_16x16x32_bf16 v[64:67], a[252:255], v[96:99], v[64:67]
    ds_read_b128 v[96:99], v0 offset:29696
    v_mfma_f32_16x16x32_bf16 v[68:71], a[252:255], v[100:103], v[68:71]
    ds_read_b128 v[100:103], v0 offset:30720
    s_waitcnt lgkmcnt(7)
    v_mfma_f32_16x16x32_bf16 v[72:75], a[252:255], v[104:107], v[72:75]
    ds_read_b128 v[104:107], v0 offset:31744
    s_waitcnt lgkmcnt(6)
    v_mfma_f32_16x16x32_bf16 v[60:63], v[136:139], v[76:79], v[60:63]
    ds_read_b128 v[76:79], v0 offset:32768
    v_mfma_f32_16x16x32_bf16 v[64:67], v[136:139], v[80:83], v[64:67]
    ds_read_b128 v[80:83], v0 offset:33792
    s_waitcnt lgkmcnt(6)
    v_mfma_f32_16x16x32_bf16 v[68:71], v[136:139], v[84:87], v[68:71]
    buffer_load_dword v57, v21, s[36:39], s88 offen sc1
    ds_read_b128 v[84:87], v0 offset:34816
    v_mfma_f32_16x16x32_bf16 v[72:75], v[136:139], v[88:91], v[72:75]
    ds_read_b128 v[88:91], v0 offset:35840
    s_waitcnt lgkmcnt(6)
    v_mfma_f32_16x16x32_bf16 v[60:63], v[148:151], v[92:95], v[60:63]
    ds_read_b128 v[92:95], v0 offset:36864
    v_mfma_f32_16x16x32_bf16 v[64:67], v[148:151], v[96:99], v[64:67]
    ds_read_b128 v[96:99], v0 offset:37888
    s_waitcnt lgkmcnt(7)
    v_mfma_f32_16x16x32_bf16 v[68:71], v[148:151], v[100:103], v[68:71]
    ds_read_b128 v[100:103], v0 offset:38912
    s_waitcnt lgkmcnt(7)
    v_mfma_f32_16x16x32_bf16 v[72:75], v[148:151], v[104:107], v[72:75]
    ds_read_b128 v[104:107], v0 offset:39936
    s_waitcnt lgkmcnt(6)
    v_mfma_f32_16x16x32_bf16 v[60:63], v[160:163], v[76:79], v[60:63]
    ds_read_b128 v[76:79], v0 offset:40960
    v_mfma_f32_16x16x32_bf16 v[64:67], v[160:163], v[80:83], v[64:67]
    ds_read_b128 v[80:83], v0 offset:41984
    s_waitcnt lgkmcnt(6)
    v_mfma_f32_16x16x32_bf16 v[68:71], v[160:163], v[84:87], v[68:71]
    ds_read_b128 v[84:87], v0 offset:43008
    v_mfma_f32_16x16x32_bf16 v[72:75], v[160:163], v[88:91], v[72:75]
    ds_read_b128 v[88:91], v0 offset:44032
    s_waitcnt lgkmcnt(6)
    v_mfma_f32_16x16x32_bf16 v[60:63], v[172:175], v[92:95], v[60:63]
    ds_read_b128 v[92:95], v0 offset:45056
    v_mfma_f32_16x16x32_bf16 v[64:67], v[172:175], v[96:99], v[64:67]
    ds_read_b128 v[96:99], v0 offset:46080
    s_waitcnt lgkmcnt(7)
    v_mfma_f32_16x16x32_bf16 v[68:71], v[172:175], v[100:103], v[68:71]
    ds_read_b128 v[100:103], v0 offset:47104
    s_waitcnt lgkmcnt(7)
    v_mfma_f32_16x16x32_bf16 v[72:75], v[172:175], v[104:107], v[72:75]
    ds_read_b128 v[104:107], v0 offset:48128
    s_waitcnt lgkmcnt(6)
    v_mfma_f32_16x16x32_bf16 v[60:63], v[184:187], v[76:79], v[60:63]
    ds_read_b128 v[76:79], v0 offset:49152
    v_mfma_f32_16x16x32_bf16 v[64:67], v[184:187], v[80:83], v[64:67]
    ds_read_b128 v[80:83], v0 offset:50176
    s_waitcnt lgkmcnt(6)
    v_mfma_f32_16x16x32_bf16 v[68:71], v[184:187], v[84:87], v[68:71]
    ds_read_b128 v[84:87], v0 offset:51200
    v_mfma_f32_16x16x32_bf16 v[72:75], v[184:187], v[88:91], v[72:75]
    ds_read_b128 v[88:91], v0 offset:52224
    s_waitcnt lgkmcnt(6)
    v_mfma_f32_16x16x32_bf16 v[60:63], v[196:199], v[92:95], v[60:63]
    ds_read_b128 v[92:95], v0 offset:53248
    s_waitcnt vmcnt(0)
    s_cmp_lg_u32 s3, s7
    s_cbranch_scc1 L61
    v_cmp_gt_u32 vcc, 8, v57
    s_cbranch_vccz L62
L63:
    buffer_load_dword v57, v21, s[36:39], s88 offen sc1
    s_sub_u32 s49, s49, 1
    s_cbranch_scc1 L_end
    s_waitcnt vmcnt(0)
    v_cmp_gt_u32 vcc, 8, v57
    s_cbranch_vccnz L63
L62:
    buffer_load_dwordx4 v[28:31], v0, s[36:39], s92 offen offset:0 sc1
    buffer_load_dwordx4 v[32:35], v0, s[36:39], s92 offen offset:1024 sc1
    buffer_load_dwordx4 v[36:39], v0, s[36:39], s93 offen offset:0 sc1
    buffer_load_dwordx4 v[40:43], v0, s[36:39], s93 offen offset:1024 sc1
    buffer_load_dwordx4 v[44:47], v0, s[36:39], s94 offen offset:0 sc1
    buffer_load_dwordx4 v[48:51], v0, s[36:39], s94 offen offset:1024 sc1
    buffer_load_dwordx4 v[120:123], v59, s[36:39], s77 offen offset:2048 sc1
L61:
    v_mfma_f32_16x16x32_bf16 v[64:67], v[196:199], v[96:99], v[64:67]
    ds_read_b128 v[96:99], v0 offset:54272
    s_waitcnt lgkmcnt(3)
    v_mfma_f32_16x16x32_bf16 v[68:71], v[196:199], v[100:103], v[68:71]
    ds_read_b128 v[100:103], v0 offset:55296
    v_mfma_f32_16x16x32_bf16 v[72:75], v[196:199], v[104:107], v[72:75]
    ds_read_b128 v[104:107], v0 offset:56320
    v_mfma_f32_16x16x32_bf16 v[60:63], v[208:211], v[76:79], v[60:63]
    ds_read_b128 v[76:79], v0 offset:57344
    v_mfma_f32_16x16x32_bf16 v[64:67], v[208:211], v[80:83], v[64:67]
    ds_read_b128 v[80:83], v0 offset:58368
    v_mfma_f32_16x16x32_bf16 v[68:71], v[208:211], v[84:87], v[68:71]
    ds_read_b128 v[84:87], v0 offset:59392
    s_waitcnt lgkmcnt(6)
    v_mfma_f32_16x16x32_bf16 v[72:75], v[208:211], v[88:91], v[72:75]
    ds_read_b128 v[88:91], v0 offset:60416
    v_mfma_f32_16x16x32_bf16 v[60:63], v[220:223], v[92:95], v[60:63]
    ds_read_b128 v[92:95], v0 offset:61440
    s_waitcnt lgkmcnt(7)
    v_mfma_f32_16x16x32_bf16 v[64:67], v[220:223], v[96:99], v[64:67]
    ds_read_b128 v[96:99], v0 offset:62464
    s_waitcnt lgkmcnt(7)
    v_mfma_f32_16x16x32_bf16 v[68:71], v[220:223], v[100:103], v[68:71]
    ds_read_b128 v[100:103], v0 offset:63488
    s_waitcnt lgkmcnt(7)
    v_mfma_f32_16x16x32_bf16 v[72:75], v[220:223], v[104:107], v[72:75]
    ds_read_b128 v[104:107], v0 offset:64512
    s_waitcnt lgkmcnt(6)
    v_mfma_f32_16x16x32_bf16 v[60:63], v[232:235], v[76:79], v[60:63]
    v_mfma_f32_16x16x32_bf16 v[64:67], v[232:235], v[80:83], v[64:67]
    s_waitcnt lgkmcnt(4)
    v_mfma_f32_16x16x32_bf16 v[68:71], v[232:235], v[84:87], v[68:71]
    v_mfma_f32_16x16x32_bf16 v[72:75], v[232:235], v[88:91], v[72:75]
    s_waitcnt lgkmcnt(2)
    v_mfma_f32_16x16x32_bf16 v[60:63], v[244:247], v[92:95], v[60:63]
    v_mfma_f32_16x16x32_bf16 v[64:67], v[244:247], v[96:99], v[64:67]
    s_waitcnt lgkmcnt(1)
    v_mfma_f32_16x16x32_bf16 v[68:71], v[244:247], v[100:103], v[68:71]
    s_waitcnt lgkmcnt(0)
    v_mfma_f32_16x16x32_bf16 v[72:75], v[244:247], v[104:107], v[72:75]
    s_cmp_lg_u32 s3, s7
    s_cbranch_scc1 L64
    s_waitcnt vmcnt(3)
    v_pk_add_f32 v[108:109], v[108:109], v[28:29]
    v_pk_add_f32 v[110:111], v[110:111], v[30:31]
    v_pk_add_f32 v[112:113], v[112:113], v[32:33]
    v_pk_add_f32 v[114:115], v[114:115], v[34:35]
    v_pk_add_f32 v[108:109], v[108:109], v[36:37]
    v_pk_add_f32 v[110:111], v[110:111], v[38:39]
    v_pk_add_f32 v[112:113], v[112:113], v[40:41]
    v_pk_add_f32 v[114:115], v[114:115], v[42:43]
    s_waitcnt vmcnt(0)
    v_pk_add_f32 v[108:109], v[108:109], v[44:45]
    v_pk_add_f32 v[110:111], v[110:111], v[46:47]
    v_pk_add_f32 v[112:113], v[112:113], v[48:49]
    v_pk_add_f32 v[114:115], v[114:115], v[50:51]
    v_add_f32_dpp v120, v120, v120 quad_perm:[1,0,3,2] row_mask:0xf bank_mask:0xf
    v_add_f32_dpp v121, v121, v121 quad_perm:[1,0,3,2] row_mask:0xf bank_mask:0xf
    v_add_f32_dpp v122, v122, v122 quad_perm:[1,0,3,2] row_mask:0xf bank_mask:0xf
    v_add_f32_dpp v123, v123, v123 quad_perm:[1,0,3,2] row_mask:0xf bank_mask:0xf
    v_cvt_pk_bf16_f32 v108, v108, v109
    v_cvt_pk_bf16_f32 v109, v110, v111
    v_cvt_pk_bf16_f32 v110, v112, v113
    v_cvt_pk_bf16_f32 v111, v114, v115
    buffer_store_dwordx4 v[108:111], v0, s[36:39], s90 offen sc1
    v_add_f32_dpp v120, v120, v120 quad_perm:[2,3,0,1] row_mask:0xf bank_mask:0xf
    v_add_f32_dpp v121, v121, v121 quad_perm:[2,3,0,1] row_mask:0xf bank_mask:0xf
    v_add_f32_dpp v122, v122, v122 quad_perm:[2,3,0,1] row_mask:0xf bank_mask:0xf
    v_add_f32_dpp v123, v123, v123 quad_perm:[2,3,0,1] row_mask:0xf bank_mask:0xf
    v_pk_add_f32 v[120:121], v[120:121], v[116:117]
    v_pk_add_f32 v[122:123], v[122:123], v[118:119]
    s_mov_b32 exec_lo, 0x01010101
    s_mov_b32 exec_hi, 0x01010101
    buffer_store_dwordx4 v[120:123], v20, s[36:39], s91 offen sc1
    s_mov_b64 exec, -1
L64:
    ds_read2_b32 v[12:13], v22 offset0:0 offset1:128
    ds_read2_b32 v[14:15], v22 offset0:16 offset1:144
    ds_read2_b32 v[16:17], v22 offset0:32 offset1:160
    ds_read2_b32 v[18:19], v22 offset0:48 offset1:176
    v_lshrrev_b32 v30, 4, v0
    s_mul_i32 s82, s3, 192
    s_add_u32 s82, s82, 157952
    v_and_b32 v28, 48, v30
    v_add_u32 v28, s82, v28
    ds_read_b128 v[116:119], v28
    v_and_b32 v29, 15, v30
    v_lshl_add_u32 v29, v29, 2, s82
    v_bfe_u32 v59, v0, 4, 3
    v_lshl_add_u32 v58, v59, 7, v20
    s_lshl_b32 s84, s4, 2
    s_add_u32 s84, s84, s3
    s_lshl_b32 s85, s84, 10
    s_add_u32 s85, s85, 9535488
    s_lshl_b32 s84, s84, 13
    s_add_u32 s84, s84, 9240576
    s_add_u32 s81, s84, 4096
    v_and_b32 v22, 0xf0, v0
    v_bfe_u32 v23, v0, 8, 1
    v_lshl_add_u32 v22, v23, 14, v22
    v_lshrrev_b32 v23, 9, v0
    v_lshl_add_u32 v22, v23, 8, v22
    s_waitcnt lgkmcnt(0)
    v_pk_fma_f32 v[60:61], v[116:117], v[12:13], v[60:61] op_sel_hi:[1,0,1] neg_lo:[0,1,0] neg_hi:[0,1,0]
    v_pk_fma_f32 v[62:63], v[118:119], v[12:13], v[62:63] op_sel_hi:[1,0,1] neg_lo:[0,1,0] neg_hi:[0,1,0]
    v_pk_mul_f32 v[60:61], v[60:61], v[12:13] op_sel:[0,1] op_sel_hi:[1,1]
    v_pk_mul_f32 v[62:63], v[62:63], v[12:13] op_sel:[0,1] op_sel_hi:[1,1]
    v_cvt_pk_bf16_f32 v28, v60, v61
    v_cvt_pk_bf16_f32 v29, v62, v63
    v_pk_fma_f32 v[64:65], v[116:117], v[14:15], v[64:65] op_sel_hi:[1,0,1] neg_lo:[0,1,0] neg_hi:[0,1,0]
    v_pk_fma_f32 v[66:67], v[118:119], v[14:15], v[66:67] op_sel_hi:[1,0,1] neg_lo:[0,1,0] neg_hi:[0,1,0]
    v_mfma_f32_16x16x16_bf16 v[60:63], v[10:11], v[28:29], 0
    v_pk_mul_f32 v[64:65], v[64:65], v[14:15] op_sel:[0,1] op_sel_hi:[1,1]
    v_pk_mul_f32 v[66:67], v[66:67], v[14:15] op_sel:[0,1] op_sel_hi:[1,1]
    v_cvt_pk_bf16_f32 v30, v64, v65
    v_cvt_pk_bf16_f32 v31, v66, v67
    v_pk_fma_f32 v[68:69], v[116:117], v[16:17], v[68:69] op_sel_hi:[1,0,1] neg_lo:[0,1,0] neg_hi:[0,1,0]
    v_pk_fma_f32 v[70:71], v[118:119], v[16:17], v[70:71] op_sel_hi:[1,0,1] neg_lo:[0,1,0] neg_hi:[0,1,0]
    v_mfma_f32_16x16x16_bf16 v[64:67], v[10:11], v[30:31], 0
    s_nop 0
    v_max3_f32 v12, v60, v61, v62
    v_max_f32 v12, v12, v63
    v_pk_mul_f32 v[68:69], v[68:69], v[16:17] op_sel:[0,1] op_sel_hi:[1,1]
    v_pk_mul_f32 v[70:71], v[70:71], v[16:17] op_sel:[0,1] op_sel_hi:[1,1]
    v_cvt_pk_bf16_f32 v32, v68, v69
    v_cvt_pk_bf16_f32 v33, v70, v71
    v_pk_fma_f32 v[72:73], v[116:117], v[18:19], v[72:73] op_sel_hi:[1,0,1] neg_lo:[0,1,0] neg_hi:[0,1,0]
    v_pk_fma_f32 v[74:75], v[118:119], v[18:19], v[74:75] op_sel_hi:[1,0,1] neg_lo:[0,1,0] neg_hi:[0,1,0]
    v_mfma_f32_16x16x16_bf16 v[68:71], v[10:11], v[32:33], 0
    v_max3_f32 v16, -v60, -v61, -v62
    v_max_f32_e64 v16, v16, -v63
    v_pk_mul_f32 v[72:73], v[72:73], v[18:19] op_sel:[0,1] op_sel_hi:[1,1]
    v_pk_mul_f32 v[74:75], v[74:75], v[18:19] op_sel:[0,1] op_sel_hi:[1,1]
    v_cvt_pk_bf16_f32 v34, v72, v73
    v_cvt_pk_bf16_f32 v35, v74, v75
    v_max3_f32 v13, v64, v65, v66
    v_max3_f32 v17, -v64, -v65, -v66
    v_mfma_f32_16x16x16_bf16 v[72:75], v[10:11], v[34:35], 0
    v_max_f32 v13, v13, v67
    v_max_f32_e64 v17, v17, -v67
    v_max3_f32 v14, v68, v69, v70
    v_max3_f32 v18, -v68, -v69, -v70
    v_max_f32 v14, v14, v71
    v_max_f32_e64 v18, v18, -v71
    v_permlane32_swap_b32 v12, v13
    s_nop 0
    v_max3_f32 v15, v72, v73, v74
    v_max3_f32 v19, -v72, -v73, -v74
    v_max_f32 v15, v15, v75
    v_max_f32_e64 v19, v19, -v75
    v_max_f32 v12, v12, v13
    v_permlane32_swap_b32 v14, v15
    v_max_f32 v14, v14, v15
    v_permlane32_swap_b32 v16, v17
    s_nop 0
    v_permlane16_swap_b32 v12, v14
    v_max_f32 v12, v12, v14
    v_mul_f32 v12, s52, v12
    v_mov_b32 v14, v12
    v_permlane32_swap_b32 v18, v19
    s_nop 0
    v_permlane16_swap_b32 v12, v14
    v_mov_b32 v13, v12
    v_mov_b32 v15, v14
    v_max_f32 v16, v16, v17
    v_permlane32_swap_b32 v12, v13
    v_permlane32_swap_b32 v14, v15
    v_max_f32 v18, v18, v19
    v_pk_fma_f32 v[76:77], v[60:61], s[52:53], v[12:13] op_sel:[0,0,0] op_sel_hi:[1,1,0] neg_lo:[0,0,1] neg_hi:[0,0,1]
    v_pk_fma_f32 v[78:79], v[62:63], s[52:53], v[12:13] op_sel:[0,0,0] op_sel_hi:[1,1,0] neg_lo:[0,0,1] neg_hi:[0,0,1]
    v_permlane16_swap_b32 v16, v18
    v_max_f32 v16, v16, v18
    v_mul_f32 v16, s52, v16
    v_mov_b32 v18, v16
    v_exp_f32 v76, v76
    s_nop 0
    v_permlane16_swap_b32 v16, v18
    v_mov_b32 v17, v16
    v_mov_b32 v19, v18
    v_exp_f32 v77, v77
    v_permlane32_swap_b32 v16, v17
    v_permlane32_swap_b32 v18, v19
    v_pk_fma_f32 v[80:81], v[60:61], s[52:53], v[16:17] op_sel:[0,0,0] op_sel_hi:[1,1,0] neg_lo:[0,1,1] neg_hi:[0,1,1]
    v_pk_fma_f32 v[82:83], v[62:63], s[52:53], v[16:17] op_sel:[0,0,0] op_sel_hi:[1,1,0] neg_lo:[0,1,1] neg_hi:[0,1,1]
    v_exp_f32 v78, v78
    v_exp_f32 v79, v79
    v_exp_f32 v80, v80
    v_exp_f32 v81, v81
    v_exp_f32 v82, v82
    v_exp_f32 v83, v83
    v_cvt_pk_bf16_f32 v36, v76, v77
    v_cvt_pk_bf16_f32 v37, v78, v79
    v_cvt_pk_bf16_f32 v38, v80, v81
    v_cvt_pk_bf16_f32 v39, v82, v83
    v_pk_fma_f32 v[84:85], v[64:65], s[52:53], v[12:13] op_sel:[0,0,1] op_sel_hi:[1,1,1] neg_lo:[0,0,1] neg_hi:[0,0,1]
    v_pk_fma_f32 v[88:89], v[64:65], s[52:53], v[16:17] op_sel:[0,0,1] op_sel_hi:[1,1,1] neg_lo:[0,1,1] neg_hi:[0,1,1]
    v_pk_fma_f32 v[86:87], v[66:67], s[52:53], v[12:13] op_sel:[0,0,1] op_sel_hi:[1,1,1] neg_lo:[0,0,1] neg_hi:[0,0,1]
    v_pk_fma_f32 v[90:91], v[66:67], s[52:53], v[16:17] op_sel:[0,0,1] op_sel_hi:[1,1,1] neg_lo:[0,1,1] neg_hi:[0,1,1]
    v_exp_f32 v84, v84
    v_mfma_f32_16x16x32_bf16 v[60:63], v[52:55], v[36:39], 0
    v_exp_f32 v85, v85
    v_exp_f32 v86, v86
    v_exp_f32 v87, v87
    v_exp_f32 v88, v88
    v_exp_f32 v89, v89
    v_exp_f32 v90, v90
    v_exp_f32 v91, v91
    v_cvt_pk_bf16_f32 v40, v84, v85
    v_cvt_pk_bf16_f32 v41, v86, v87
    v_cvt_pk_bf16_f32 v42, v88, v89
    v_cvt_pk_bf16_f32 v43, v90, v91
    v_pk_fma_f32 v[92:93], v[68:69], s[52:53], v[14:15] op_sel:[0,0,0] op_sel_hi:[1,1,0] neg_lo:[0,0,1] neg_hi:[0,0,1]
    v_pk_fma_f32 v[96:97], v[68:69], s[52:53], v[18:19] op_sel:[0,0,0] op_sel_hi:[1,1,0] neg_lo:[0,1,1] neg_hi:[0,1,1]
    v_mfma_f32_16x16x32_bf16 v[64:67], v[52:55], v[40:43], 0
    v_exp_f32 v92, v92
    v_pk_fma_f32 v[94:95], v[70:71], s[52:53], v[14:15] op_sel:[0,0,0] op_sel_hi:[1,1,0] neg_lo:[0,0,1] neg_hi:[0,0,1]
    v_pk_fma_f32 v[98:99], v[70:71], s[52:53], v[18:19] op_sel:[0,0,0] op_sel_hi:[1,1,0] neg_lo:[0,1,1] neg_hi:[0,1,1]
    v_exp_f32 v93, v93
    v_exp_f32 v94, v94
    v_exp_f32 v95, v95
    v_exp_f32 v96, v96
    v_exp_f32 v97, v97
    v_exp_f32 v98, v98
    v_exp_f32 v99, v99
    v_cvt_pk_bf16_f32 v44, v92, v93
    v_cvt_pk_bf16_f32 v45, v94, v95
    v_cvt_pk_bf16_f32 v46, v96, v97
    v_cvt_pk_bf16_f32 v47, v98, v99
    v_pk_fma_f32 v[100:101], v[72:73], s[52:53], v[14:15] op_sel:[0,0,1] op_sel_hi:[1,1,1] neg_lo:[0,0,1] neg_hi:[0,0,1]
    v_pk_fma_f32 v[104:105], v[72:73], s[52:53], v[18:19] op_sel:[0,0,1] op_sel_hi:[1,1,1] neg_lo:[0,1,1] neg_hi:[0,1,1]
    v_pk_fma_f32 v[102:103], v[74:75], s[52:53], v[14:15] op_sel:[0,0,1] op_sel_hi:[1,1,1] neg_lo:[0,0,1] neg_hi:[0,0,1]
    v_pk_fma_f32 v[106:107], v[74:75], s[52:53], v[18:19] op_sel:[0,0,1] op_sel_hi:[1,1,1] neg_lo:[0,1,1] neg_hi:[0,1,1]
    v_exp_f32 v100, v100
    v_mfma_f32_16x16x32_bf16 v[68:71], v[52:55], v[44:47], 0
    v_exp_f32 v101, v101
    v_exp_f32 v102, v102
    v_exp_f32 v103, v103
    v_exp_f32 v104, v104
    v_exp_f32 v105, v105
    v_exp_f32 v106, v106
    v_exp_f32 v107, v107
    v_cvt_pk_bf16_f32 v48, v100, v101
    v_cvt_pk_bf16_f32 v49, v102, v103
    v_cvt_pk_bf16_f32 v50, v104, v105
    v_cvt_pk_bf16_f32 v51, v106, v107
    v_rcp_f32 v60, v60
    s_nop 0
    v_mfma_f32_16x16x32_bf16 v[72:75], v[52:55], v[48:51], 0
    v_rcp_f32 v61, v61
    v_rcp_f32 v64, v64
    v_pk_mul_f32 v[76:77], v[76:77], v[60:61] op_sel_hi:[1,0]
    v_pk_mul_f32 v[78:79], v[78:79], v[60:61] op_sel_hi:[1,0]
    v_pk_mul_f32 v[80:81], v[80:81], v[60:61] op_sel:[0,1] op_sel_hi:[1,1]
    v_pk_mul_f32 v[82:83], v[82:83], v[60:61] op_sel:[0,1] op_sel_hi:[1,1]
    v_cvt_pk_bf16_f32 v36, v76, v77
    v_cvt_pk_bf16_f32 v37, v78, v79
    v_cvt_pk_bf16_f32 v38, v80, v81
    v_cvt_pk_bf16_f32 v39, v82, v83
    v_rcp_f32 v65, v65
    v_rcp_f32 v68, v68
    v_pk_mul_f32 v[84:85], v[84:85], v[64:65] op_sel_hi:[1,0]
    v_pk_mul_f32 v[86:87], v[86:87], v[64:65] op_sel_hi:[1,0]
    v_pk_mul_f32 v[88:89], v[88:89], v[64:65] op_sel:[0,1] op_sel_hi:[1,1]
    v_pk_mul_f32 v[90:91], v[90:91], v[64:65] op_sel:[0,1] op_sel_hi:[1,1]
    v_cvt_pk_bf16_f32 v40, v84, v85
    v_cvt_pk_bf16_f32 v41, v86, v87
    v_cvt_pk_bf16_f32 v42, v88, v89
    v_cvt_pk_bf16_f32 v43, v90, v91
    v_rcp_f32 v69, v69
    v_rcp_f32 v72, v72
    v_pk_mul_f32 v[92:93], v[92:93], v[68:69] op_sel_hi:[1,0]
    v_pk_mul_f32 v[94:95], v[94:95], v[68:69] op_sel_hi:[1,0]
    v_pk_mul_f32 v[96:97], v[96:97], v[68:69] op_sel:[0,1] op_sel_hi:[1,1]
    v_pk_mul_f32 v[98:99], v[98:99], v[68:69] op_sel:[0,1] op_sel_hi:[1,1]
    v_cvt_pk_bf16_f32 v44, v92, v93
    v_cvt_pk_bf16_f32 v45, v94, v95
    v_cvt_pk_bf16_f32 v46, v96, v97
    v_cvt_pk_bf16_f32 v47, v98, v99
    v_rcp_f32 v73, v73
    s_nop 0
    v_pk_mul_f32 v[100:101], v[100:101], v[72:73] op_sel_hi:[1,0]
    v_pk_mul_f32 v[102:103], v[102:103], v[72:73] op_sel_hi:[1,0]
    v_pk_mul_f32 v[104:105], v[104:105], v[72:73] op_sel:[0,1] op_sel_hi:[1,1]
    v_pk_mul_f32 v[106:107], v[106:107], v[72:73] op_sel:[0,1] op_sel_hi:[1,1]
    v_cvt_pk_bf16_f32 v48, v100, v101
    v_cvt_pk_bf16_f32 v49, v102, v103
    v_cvt_pk_bf16_f32 v50, v104, v105
    v_cvt_pk_bf16_f32 v51, v106, v107
L65:
    buffer_load_dwordx4 v[76:79], v0, s[36:39], s84 offen offset:0 sc1
    buffer_load_dwordx4 v[80:83], v0, s[36:39], s84 offen offset:1024 sc1
    buffer_load_dwordx4 v[84:87], v0, s[36:39], s84 offen offset:2048 sc1
    buffer_load_dwordx4 v[88:91], v0, s[36:39], s84 offen offset:3072 sc1
    buffer_load_dwordx4 v[92:95], v0, s[36:39], s81 offen offset:0 sc1
    buffer_load_dwordx4 v[96:99], v0, s[36:39], s81 offen offset:1024 sc1
    buffer_load_dwordx4 v[100:103], v0, s[36:39], s81 offen offset:2048 sc1
    buffer_load_dwordx4 v[104:107], v0, s[36:39], s81 offen offset:3072 sc1
    buffer_load_dwordx4 v[108:111], v58, s[36:39], s85 offen sc1
    s_waitcnt vmcnt(6)
    v_max3_u32 v21, v76, v80, v84
    s_waitcnt vmcnt(2)
    v_max3_u32 v21, v21, v88, v92
    v_max3_u32 v21, v21, v96, v100
    s_waitcnt vmcnt(0)
    v_max3_u32 v21, v21, v104, v108
    v_cmp_eq_u32 vcc, -1, v21
    s_cbranch_vccnz L66
    v_mfma_f32_16x16x32_bf16 v[60:63], v[76:79], v[36:39], 0
    v_add_f32_dpp v108, v108, v108 quad_perm:[1,0,3,2] row_mask:0xf bank_mask:0xf
    v_add_f32_dpp v109, v109, v109 quad_perm:[1,0,3,2] row_mask:0xf bank_mask:0xf
    v_mfma_f32_16x16x32_bf16 v[64:67], v[76:79], v[40:43], 0
    v_add_f32_dpp v110, v110, v110 quad_perm:[1,0,3,2] row_mask:0xf bank_mask:0xf
    v_add_f32_dpp v111, v111, v111 quad_perm:[1,0,3,2] row_mask:0xf bank_mask:0xf
    v_mfma_f32_16x16x32_bf16 v[68:71], v[76:79], v[44:47], 0
    v_add_f32_dpp v108, v108, v108 quad_perm:[2,3,0,1] row_mask:0xf bank_mask:0xf
    v_add_f32_dpp v109, v109, v109 quad_perm:[2,3,0,1] row_mask:0xf bank_mask:0xf
    v_mfma_f32_16x16x32_bf16 v[72:75], v[76:79], v[48:51], 0
    v_add_f32_dpp v110, v110, v110 quad_perm:[2,3,0,1] row_mask:0xf bank_mask:0xf
    v_add_f32_dpp v111, v111, v111 quad_perm:[2,3,0,1] row_mask:0xf bank_mask:0xf
    v_mfma_f32_16x16x32_bf16 v[60:63], v[80:83], v[36:39], v[60:63]
    v_add_f32_dpp v108, v108, v108 row_half_mirror row_mask:0xf bank_mask:0xf
    v_add_f32_dpp v109, v109, v109 row_half_mirror row_mask:0xf bank_mask:0xf
    v_mfma_f32_16x16x32_bf16 v[64:67], v[80:83], v[40:43], v[64:67]
    v_add_f32_dpp v110, v110, v110 row_half_mirror row_mask:0xf bank_mask:0xf
    v_add_f32_dpp v111, v111, v111 row_half_mirror row_mask:0xf bank_mask:0xf
    v_mfma_f32_16x16x32_bf16 v[68:71], v[80:83], v[44:47], v[68:71]
    v_cvt_pk_bf16_f32 v108, v108, v109
    v_cvt_pk_bf16_f32 v109, v110, v111
    v_mfma_f32_16x16x32_bf16 v[72:75], v[80:83], v[48:51], v[72:75]
    v_mov_b32 v110, v108
    v_mov_b32 v111, v109
    v_mfma_f32_16x16x32_bf16 v[60:63], v[84:87], v[36:39], v[60:63]
    v_mov_b32_dpp v110, v108 row_ror:8 row_mask:0xf bank_mask:0x3
    v_mov_b32_dpp v111, v109 row_ror:8 row_mask:0xf bank_mask:0x3
    v_mfma_f32_16x16x32_bf16 v[64:67], v[84:87], v[40:43], v[64:67]
    v_mov_b32_dpp v108, v108 row_ror:8 row_mask:0xf bank_mask:0xc
    v_mov_b32_dpp v109, v109 row_ror:8 row_mask:0xf bank_mask:0xc
    v_mfma_f32_16x16x32_bf16 v[68:71], v[84:87], v[44:47], v[68:71]
    v_mfma_f32_16x16x32_bf16 v[72:75], v[84:87], v[48:51], v[72:75]
    v_mfma_f32_16x16x32_bf16 v[60:63], v[88:91], v[36:39], v[60:63]
    v_mfma_f32_16x16x32_bf16 v[64:67], v[88:91], v[40:43], v[64:67]
    v_mfma_f32_16x16x32_bf16 v[68:71], v[88:91], v[44:47], v[68:71]
    v_mfma_f32_16x16x32_bf16 v[72:75], v[88:91], v[48:51], v[72:75]
    v_mfma_f32_16x16x32_bf16 v[60:63], v[92:95], v[36:39], v[60:63]
    v_mfma_f32_16x16x32_bf16 v[64:67], v[92:95], v[40:43], v[64:67]
    v_mfma_f32_16x16x32_bf16 v[68:71], v[92:95], v[44:47], v[68:71]
    v_mfma_f32_16x16x32_bf16 v[72:75], v[92:95], v[48:51], v[72:75]
    v_mfma_f32_16x16x32_bf16 v[60:63], v[96:99], v[36:39], v[60:63]
    v_mfma_f32_16x16x32_bf16 v[64:67], v[96:99], v[40:43], v[64:67]
    v_mfma_f32_16x16x32_bf16 v[68:71], v[96:99], v[44:47], v[68:71]
    v_mfma_f32_16x16x32_bf16 v[72:75], v[96:99], v[48:51], v[72:75]
    v_mfma_f32_16x16x32_bf16 v[112:115], v[108:111], v[36:39], 0
    v_mfma_f32_16x16x32_bf16 v[116:119], v[108:111], v[40:43], 0
    v_mfma_f32_16x16x32_bf16 v[120:123], v[108:111], v[44:47], 0
    s_nop 5
    v_add_f32 v112, 0x358637bd, v112
    v_rcp_f32 v112, v112
    v_mfma_f32_16x16x32_bf16 v[124:127], v[108:111], v[48:51], 0
    v_add_f32 v116, 0x358637bd, v116
    v_rcp_f32 v116, v116
    v_mfma_f32_16x16x32_bf16 v[60:63], v[100:103], v[36:39], v[60:63]
    v_add_f32 v120, 0x358637bd, v120
    v_rcp_f32 v120, v120
    v_mfma_f32_16x16x32_bf16 v[64:67], v[100:103], v[40:43], v[64:67]
    s_nop 1
    v_add_f32 v124, 0x358637bd, v124
    v_rcp_f32 v124, v124
    v_mfma_f32_16x16x32_bf16 v[68:71], v[100:103], v[44:47], v[68:71]
    v_mfma_f32_16x16x32_bf16 v[72:75], v[100:103], v[48:51], v[72:75]
    v_mfma_f32_16x16x32_bf16 v[60:63], v[104:107], v[36:39], v[60:63]
    v_mfma_f32_16x16x32_bf16 v[64:67], v[104:107], v[40:43], v[64:67]
    v_mfma_f32_16x16x32_bf16 v[68:71], v[104:107], v[44:47], v[68:71]
    v_mfma_f32_16x16x32_bf16 v[72:75], v[104:107], v[48:51], v[72:75]
    s_nop 4
    v_pk_mul_f32 v[60:61], v[60:61], v[112:113] op_sel_hi:[1,0]
    v_pk_mul_f32 v[62:63], v[62:63], v[112:113] op_sel_hi:[1,0]
    v_cvt_pk_bf16_f32 v28, v60, v61
    v_cvt_pk_bf16_f32 v29, v62, v63
    v_pk_mul_f32 v[64:65], v[64:65], v[116:117] op_sel_hi:[1,0]
    v_pk_mul_f32 v[66:67], v[66:67], v[116:117] op_sel_hi:[1,0]
    v_cvt_pk_bf16_f32 v30, v64, v65
    v_cvt_pk_bf16_f32 v31, v66, v67
    v_pk_mul_f32 v[68:69], v[68:69], v[120:121] op_sel_hi:[1,0]
    v_pk_mul_f32 v[70:71], v[70:71], v[120:121] op_sel_hi:[1,0]
    v_cvt_pk_bf16_f32 v32, v68, v69
    v_cvt_pk_bf16_f32 v33, v70, v71
    v_pk_mul_f32 v[72:73], v[72:73], v[124:125] op_sel_hi:[1,0]
    v_pk_mul_f32 v[74:75], v[74:75], v[124:125] op_sel_hi:[1,0]
    v_cvt_pk_bf16_f32 v34, v72, v73
    v_cvt_pk_bf16_f32 v35, v74, v75
    v_permlane16_swap_b32 v28, v30
    v_permlane16_swap_b32 v29, v31
    v_permlane16_swap_b32 v32, v34
    v_permlane16_swap_b32 v33, v35
    s_cmp_eq_u32 s48, 0
    s_cbranch_scc1 L67
    buffer_store_dwordx4 v[28:31], v22, s[36:39], s64 offen
    buffer_store_dwordx4 v[32:35], v22, s[36:39], s65 offen
L68:
    v_mov_b32 v23, 9
    v_lshrrev_b32 v58, 4, v0
    v_lshrrev_b32 v124, 4, v58
    v_mul_u32_u24 v124, 1024, v124
    v_bfe_u32 v59, v58, 2, 2
    v_lshl_add_u32 v124, v59, 7, v124
    v_and_b32 v59, 3, v58
    v_lshl_add_u32 v124, v59, 3, v124
    v_bfe_u32 v59, v58, 3, 2
    v_lshl_add_u32 v124, v59, 5, v124
    v_add_u32 v124, 90112, v124
    v_xor_b32 v125, 32, v124
    v_xor_b32 v126, 64, v124
    v_xor_b32 v127, 96, v124
    v_permlane16_swap_b32 v2, v4
    v_permlane16_swap_b32 v3, v5
    v_permlane16_swap_b32 v6, v8
    v_permlane16_swap_b32 v7, v9
    v_lshlrev_b32 v12, 16, v2
    v_and_b32 v13, 0xffff0000, v2
    v_lshlrev_b32 v14, 16, v3
    v_and_b32 v15, 0xffff0000, v3
    v_lshlrev_b32 v16, 16, v4
    v_and_b32 v17, 0xffff0000, v4
    v_lshlrev_b32 v18, 16, v5
    v_and_b32 v19, 0xffff0000, v5
    v_lshlrev_b32 v20, 16, v6
    v_and_b32 v21, 0xffff0000, v6
    v_lshlrev_b32 v22, 16, v7
    v_lshlrev_b32 v24, 16, v8
    v_and_b32 v25, 0xffff0000, v8
    v_lshlrev_b32 v26, 16, v9
    v_and_b32 v27, 0xffff0000, v9
    v_lshrrev_b32 v60, 2, v0
    v_and_b32 v60, 0x7c, v60
    s_waitcnt vmcnt(0)
    s_cmp_eq_u32 s48, 0
    s_cbranch_scc1 L69
    buffer_store_dword v23, off, s[36:39], s74
L70:
    s_barrier
    ds_read_b64_tr_b16 v[28:29], v124 offset:0
    ds_read_b64_tr_b16 v[30:31], v124 offset:512
    ds_read_b64_tr_b16 v[32:33], v125 offset:0
    ds_read_b64_tr_b16 v[34:35], v125 offset:512
    ds_read_b64_tr_b16 v[36:37], v126 offset:0
    ds_read_b64_tr_b16 v[38:39], v126 offset:512
    ds_read_b64_tr_b16 v[40:41], v127 offset:0
    ds_read_b64_tr_b16 v[42:43], v127 offset:512
    ds_read_b64_tr_b16 v[44:45], v124 offset:4096
    ds_read_b64_tr_b16 v[46:47], v124 offset:4608
    ds_read_b64_tr_b16 v[48:49], v125 offset:4096
    ds_read_b64_tr_b16 v[50:51], v125 offset:4608
    ds_read_b64_tr_b16 v[52:53], v126 offset:4096
    ds_read_b64_tr_b16 v[54:55], v126 offset:4608
    v_and_b32 v23, 0xffff0000, v7
    ds_read_b64_tr_b16 v[56:57], v127 offset:4096
    ds_read_b64_tr_b16 v[58:59], v127 offset:4608
L71:
    buffer_load_dword v61, v60, s[36:39], s75 offen sc1
    s_sub_u32 s49, s49, 1
    s_cbranch_scc1 L_end
    s_waitcnt vmcnt(0)
    v_cmp_gt_u32 vcc, 9, v61
    s_cbranch_vccnz L71
    buffer_load_dwordx4 v[60:63], v0, s[36:39], s66 offen offset:0 sc1
    s_lshl_b32 s82, s5, 6
    s_and_b32 s83, s3, 1
    s_lshl_b32 s83, s83, 5
    s_add_u32 s82, s82, s83
    s_lshr_b32 s83, s3, 1
    s_add_u32 s82, s82, s83
    s_lshl_b32 s82, s82, 10
    s_lshl_b32 s83, s4, 7
    s_add_u32 s82, s82, s83
    buffer_load_dwordx4 v[64:67], v0, s[36:39], s66 offen offset:1024 sc1
    buffer_load_dwordx4 v[68:71], v0, s[36:39], s66 offen offset:2048 sc1
    buffer_load_dwordx4 v[72:75], v0, s[36:39], s66 offen offset:3072 sc1
    buffer_load_dwordx4 v[76:79], v0, s[36:39], s67 offen offset:0 sc1
    buffer_load_dwordx4 v[80:83], v0, s[36:39], s67 offen offset:1024 sc1
    buffer_load_dwordx4 v[84:87], v0, s[36:39], s67 offen offset:2048 sc1
    buffer_load_dwordx4 v[88:91], v0, s[36:39], s67 offen offset:3072 sc1
    buffer_load_dwordx4 v[92:95], v0, s[36:39], s68 offen offset:0 sc1
    buffer_load_dwordx4 v[96:99], v0, s[36:39], s68 offen offset:1024 sc1
    s_waitcnt vmcnt(9) lgkmcnt(0)
    v_mfma_f32_16x16x32_bf16 v[12:15], v[28:31], v[60:63], v[12:15]
    buffer_load_dwordx4 v[100:103], v0, s[36:39], s68 offen offset:2048 sc1
    ds_read_b64_tr_b16 v[28:29], v124 offset:8192
    v_mfma_f32_16x16x32_bf16 v[16:19], v[32:35], v[60:63], v[16:19]
    ds_read_b64_tr_b16 v[30:31], v124 offset:8704
    ds_read_b64_tr_b16 v[32:33], v125 offset:8192
    v_mfma_f32_16x16x32_bf16 v[20:23], v[36:39], v[60:63], v[20:23]
    ds_read_b64_tr_b16 v[34:35], v125 offset:8704
    ds_read_b64_tr_b16 v[36:37], v126 offset:8192
    v_mfma_f32_16x16x32_bf16 v[24:27], v[40:43], v[60:63], v[24:27]
    buffer_load_dwordx4 v[104:107], v0, s[36:39], s68 offen offset:3072 sc1
    ds_read_b64_tr_b16 v[38:39], v126 offset:8704
    s_waitcnt vmcnt(10)
    v_mfma_f32_16x16x32_bf16 v[12:15], v[44:47], v[64:67], v[12:15]
    ds_read_b64_tr_b16 v[40:41], v127 offset:8192
    ds_read_b64_tr_b16 v[42:43], v127 offset:8704
    v_mfma_f32_16x16x32_bf16 v[16:19], v[48:51], v[64:67], v[16:19]
    ds_read_b64_tr_b16 v[44:45], v124 offset:12288
    buffer_load_dwordx4 v[108:111], v0, s[36:39], s69 offen offset:0 sc1
    v_mfma_f32_16x16x32_bf16 v[20:23], v[52:55], v[64:67], v[20:23]
    ds_read_b64_tr_b16 v[46:47], v124 offset:12800
    ds_read_b64_tr_b16 v[48:49], v125 offset:12288
    v_mfma_f32_16x16x32_bf16 v[24:27], v[56:59], v[64:67], v[24:27]
    ds_read_b64_tr_b16 v[50:51], v125 offset:12800
    ds_read_b64_tr_b16 v[52:53], v126 offset:12288
    ds_read_b64_tr_b16 v[54:55], v126 offset:12800
    buffer_load_dwordx4 v[112:115], v0, s[36:39], s69 offen offset:1024 sc1
    ds_read_b64_tr_b16 v[56:57], v127 offset:12288
    s_waitcnt vmcnt(11) lgkmcnt(9)
    v_mfma_f32_16x16x32_bf16 v[12:15], v[28:31], v[68:71], v[12:15]
    ds_read_b64_tr_b16 v[58:59], v127 offset:12800
    ds_read_b64_tr_b16 v[28:29], v124 offset:16384
    v_mfma_f32_16x16x32_bf16 v[16:19], v[32:35], v[68:71], v[16:19]
    ds_read_b64_tr_b16 v[30:31], v124 offset:16896
    buffer_load_dwordx4 v[116:119], v0, s[36:39], s69 offen offset:2048 sc1
    v_mfma_f32_16x16x32_bf16 v[20:23], v[36:39], v[68:71], v[20:23]
    ds_read_b64_tr_b16 v[32:33], v125 offset:16384
    ds_read_b64_tr_b16 v[34:35], v125 offset:16896
    ds_read_b64_tr_b16 v[36:37], v126 offset:16384
    s_waitcnt lgkmcnt(8)
    v_mfma_f32_16x16x32_bf16 v[24:27], v[40:43], v[68:71], v[24:27]
    ds_read_b64_tr_b16 v[38:39], v126 offset:16896
    buffer_load_dwordx4 v[120:123], v0, s[36:39], s69 offen offset:3072 sc1
    ds_read_b64_tr_b16 v[40:41], v127 offset:16384
    s_waitcnt vmcnt(12)
    v_mfma_f32_16x16x32_bf16 v[12:15], v[44:47], v[72:75], v[12:15]
    ds_read_b64_tr_b16 v[42:43], v127 offset:16896
    ds_read_b64_tr_b16 v[44:45], v124 offset:20480
    v_mfma_f32_16x16x32_bf16 v[16:19], v[48:51], v[72:75], v[16:19]
    ds_read_b64_tr_b16 v[46:47], v124 offset:20992
    ds_read_b64_tr_b16 v[48:49], v125 offset:20480
    s_waitcnt lgkmcnt(7)
    v_mfma_f32_16x16x32_bf16 v[20:23], v[52:55], v[72:75], v[20:23]
    ds_read_b64_tr_b16 v[50:51], v125 offset:20992
    ds_read_b64_tr_b16 v[52:53], v126 offset:20480
    v_mfma_f32_16x16x32_bf16 v[24:27], v[56:59], v[72:75], v[24:27]
    ds_read_b64_tr_b16 v[54:55], v126 offset:20992
    ds_read_b64_tr_b16 v[56:57], v127 offset:20480
    s_waitcnt vmcnt(11)
    v_mfma_f32_16x16x32_bf16 v[12:15], v[28:31], v[76:79], v[12:15]
    ds_read_b64_tr_b16 v[58:59], v127 offset:20992
    ds_read_b64_tr_b16 v[28:29], v124 offset:24576
    v_mfma_f32_16x16x32_bf16 v[16:19], v[32:35], v[76:79], v[16:19]
    ds_read_b64_tr_b16 v[30:31], v124 offset:25088
    ds_read_b64_tr_b16 v[32:33], v125 offset:24576
    s_waitcnt lgkmcnt(8)
    v_mfma_f32_16x16x32_bf16 v[20:23], v[36:39], v[76:79], v[20:23]
    ds_read_b64_tr_b16 v[34:35], v125 offset:25088
    ds_read_b64_tr_b16 v[36:37], v126 offset:24576
    v_mfma_f32_16x16x32_bf16 v[24:27], v[40:43], v[76:79], v[24:27]
    ds_read_b64_tr_b16 v[38:39], v126 offset:25088
    ds_read_b64_tr_b16 v[40:41], v127 offset:24576
    s_waitcnt vmcnt(10)
    v_mfma_f32_16x16x32_bf16 v[12:15], v[44:47], v[80:83], v[12:15]
    ds_read_b64_tr_b16 v[42:43], v127 offset:25088
    ds_read_b64_tr_b16 v[44:45], v124 offset:28672
    s_waitcnt lgkmcnt(8)
    v_mfma_f32_16x16x32_bf16 v[16:19], v[48:51], v[80:83], v[16:19]
    ds_read_b64_tr_b16 v[46:47], v124 offset:29184
    ds_read_b64_tr_b16 v[48:49], v125 offset:28672
    v_mfma_f32_16x16x32_bf16 v[20:23], v[52:55], v[80:83], v[20:23]
    ds_read_b64_tr_b16 v[50:51], v125 offset:29184
    ds_read_b64_tr_b16 v[52:53], v126 offset:28672
    v_mfma_f32_16x16x32_bf16 v[24:27], v[56:59], v[80:83], v[24:27]
    ds_read_b64_tr_b16 v[54:55], v126 offset:29184
    ds_read_b64_tr_b16 v[56:57], v127 offset:28672
    s_waitcnt vmcnt(9) lgkmcnt(8)
    v_mfma_f32_16x16x32_bf16 v[12:15], v[28:31], v[84:87], v[12:15]
    ds_read_b64_tr_b16 v[58:59], v127 offset:29184
    ds_read_b64_tr_b16 v[28:29], v124 offset:32768
    v_mfma_f32_16x16x32_bf16 v[16:19], v[32:35], v[84:87], v[16:19]
    ds_read_b64_tr_b16 v[30:31], v124 offset:33280
    ds_read_b64_tr_b16 v[32:33], v125 offset:32768
    v_mfma_f32_16x16x32_bf16 v[20:23], v[36:39], v[84:87], v[20:23]
    ds_read_b64_tr_b16 v[34:35], v125 offset:33280
    ds_read_b64_tr_b16 v[36:37], v126 offset:32768
    s_waitcnt lgkmcnt(8)
    v_mfma_f32_16x16x32_bf16 v[24:27], v[40:43], v[84:87], v[24:27]
    ds_read_b64_tr_b16 v[38:39], v126 offset:33280
    ds_read_b64_tr_b16 v[40:41], v127 offset:32768
    s_waitcnt vmcnt(8)
    v_mfma_f32_16x16x32_bf16 v[12:15], v[44:47], v[88:91], v[12:15]
    ds_read_b64_tr_b16 v[42:43], v127 offset:33280
    ds_read_b64_tr_b16 v[44:45], v124 offset:36864
    v_mfma_f32_16x16x32_bf16 v[16:19], v[48:51], v[88:91], v[16:19]
    ds_read_b64_tr_b16 v[46:47], v124 offset:37376
    ds_read_b64_tr_b16 v[48:49], v125 offset:36864
    s_waitcnt lgkmcnt(8)
    v_mfma_f32_16x16x32_bf16 v[20:23], v[52:55], v[88:91], v[20:23]
    ds_read_b64_tr_b16 v[50:51], v125 offset:37376
    ds_read_b64_tr_b16 v[52:53], v126 offset:36864
    v_mfma_f32_16x16x32_bf16 v[24:27], v[56:59], v[88:91], v[24:27]
    ds_read_b64_tr_b16 v[54:55], v126 offset:37376
    ds_read_b64_tr_b16 v[56:57], v127 offset:36864
    s_waitcnt vmcnt(7)
    v_mfma_f32_16x16x32_bf16 v[12:15], v[28:31], v[92:95], v[12:15]
    ds_read_b64_tr_b16 v[58:59], v127 offset:37376
    ds_read_b64_tr_b16 v[28:29], v124 offset:40960
    s_waitcnt lgkmcnt(8)
    v_mfma_f32_16x16x32_bf16 v[16:19], v[32:35], v[92:95], v[16:19]
    ds_read_b64_tr_b16 v[30:31], v124 offset:41472
    ds_read_b64_tr_b16 v[32:33], v125 offset:40960
    v_mfma_f32_16x16x32_bf16 v[20:23], v[36:39], v[92:95], v[20:23]
    ds_read_b64_tr_b16 v[34:35], v125 offset:41472
    ds_read_b64_tr_b16 v[36:37], v126 offset:40960
    v_mfma_f32_16x16x32_bf16 v[24:27], v[40:43], v[92:95], v[24:27]
    ds_read_b64_tr_b16 v[38:39], v126 offset:41472
    ds_read_b64_tr_b16 v[40:41], v127 offset:40960
    s_waitcnt vmcnt(6) lgkmcnt(8)
    v_mfma_f32_16x16x32_bf16 v[12:15], v[44:47], v[96:99], v[12:15]
    ds_read_b64_tr_b16 v[42:43], v127 offset:41472
    ds_read_b64_tr_b16 v[44:45], v124 offset:45056
    v_mfma_f32_16x16x32_bf16 v[16:19], v[48:51], v[96:99], v[16:19]
    ds_read_b64_tr_b16 v[46:47], v124 offset:45568
    ds_read_b64_tr_b16 v[48:49], v125 offset:45056
    v_mfma_f32_16x16x32_bf16 v[20:23], v[52:55], v[96:99], v[20:23]
    ds_read_b64_tr_b16 v[50:51], v125 offset:45568
    ds_read_b64_tr_b16 v[52:53], v126 offset:45056
    s_waitcnt lgkmcnt(8)
    v_mfma_f32_16x16x32_bf16 v[24:27], v[56:59], v[96:99], v[24:27]
    ds_read_b64_tr_b16 v[54:55], v126 offset:45568
    ds_read_b64_tr_b16 v[56:57], v127 offset:45056
    s_waitcnt vmcnt(5)
    v_mfma_f32_16x16x32_bf16 v[12:15], v[28:31], v[100:103], v[12:15]
    ds_read_b64_tr_b16 v[58:59], v127 offset:45568
    ds_read_b64_tr_b16 v[28:29], v124 offset:49152
    v_mfma_f32_16x16x32_bf16 v[16:19], v[32:35], v[100:103], v[16:19]
    ds_read_b64_tr_b16 v[30:31], v124 offset:49664
    ds_read_b64_tr_b16 v[32:33], v125 offset:49152
    s_waitcnt lgkmcnt(8)
    v_mfma_f32_16x16x32_bf16 v[20:23], v[36:39], v[100:103], v[20:23]
    ds_read_b64_tr_b16 v[34:35], v125 offset:49664
    ds_read_b64_tr_b16 v[36:37], v126 offset:49152
    v_mfma_f32_16x16x32_bf16 v[24:27], v[40:43], v[100:103], v[24:27]
    ds_read_b64_tr_b16 v[38:39], v126 offset:49664
    ds_read_b64_tr_b16 v[40:41], v127 offset:49152
    s_waitcnt vmcnt(4)
    v_mfma_f32_16x16x32_bf16 v[12:15], v[44:47], v[104:107], v[12:15]
    ds_read_b64_tr_b16 v[42:43], v127 offset:49664
    ds_read_b64_tr_b16 v[44:45], v124 offset:53248
    s_waitcnt lgkmcnt(8)
    v_mfma_f32_16x16x32_bf16 v[16:19], v[48:51], v[104:107], v[16:19]
    ds_read_b64_tr_b16 v[46:47], v124 offset:53760
    ds_read_b64_tr_b16 v[48:49], v125 offset:53248
    v_mfma_f32_16x16x32_bf16 v[20:23], v[52:55], v[104:107], v[20:23]
    ds_read_b64_tr_b16 v[50:51], v125 offset:53760
    ds_read_b64_tr_b16 v[52:53], v126 offset:53248
    v_lshrrev_b32 v96, 4, v0
    v_mfma_f32_16x16x32_bf16 v[24:27], v[56:59], v[104:107], v[24:27]
    ds_read_b64_tr_b16 v[54:55], v126 offset:53760
    ds_read_b64_tr_b16 v[56:57], v127 offset:53248
    s_waitcnt vmcnt(3) lgkmcnt(8)
    v_mfma_f32_16x16x32_bf16 v[12:15], v[28:31], v[108:111], v[12:15]
    ds_read_b64_tr_b16 v[58:59], v127 offset:53760
    ds_read_b64_tr_b16 v[28:29], v124 offset:57344
    v_mfma_f32_16x16x32_bf16 v[16:19], v[32:35], v[108:111], v[16:19]
    ds_read_b64_tr_b16 v[30:31], v124 offset:57856
    ds_read_b64_tr_b16 v[32:33], v125 offset:57344
    v_mfma_f32_16x16x32_bf16 v[20:23], v[36:39], v[108:111], v[20:23]
    ds_read_b64_tr_b16 v[34:35], v125 offset:57856
    ds_read_b64_tr_b16 v[36:37], v126 offset:57344
    v_and_b32 v92, 15, v96
    s_waitcnt lgkmcnt(8)
    v_mfma_f32_16x16x32_bf16 v[24:27], v[40:43], v[108:111], v[24:27]
    ds_read_b64_tr_b16 v[38:39], v126 offset:57856
    ds_read_b64_tr_b16 v[40:41], v127 offset:57344
    s_waitcnt vmcnt(2)
    v_mfma_f32_16x16x32_bf16 v[12:15], v[44:47], v[112:115], v[12:15]
    ds_read_b64_tr_b16 v[42:43], v127 offset:57856
    ds_read_b64_tr_b16 v[44:45], v124 offset:61440
    v_mfma_f32_16x16x32_bf16 v[16:19], v[48:51], v[112:115], v[16:19]
    ds_read_b64_tr_b16 v[46:47], v124 offset:61952
    ds_read_b64_tr_b16 v[48:49], v125 offset:61440
    s_waitcnt lgkmcnt(8)
    v_mfma_f32_16x16x32_bf16 v[20:23], v[52:55], v[112:115], v[20:23]
    ds_read_b64_tr_b16 v[50:51], v125 offset:61952
    ds_read_b64_tr_b16 v[52:53], v126 offset:61440
    v_mfma_f32_16x16x32_bf16 v[24:27], v[56:59], v[112:115], v[24:27]
    ds_read_b64_tr_b16 v[54:55], v126 offset:61952
    ds_read_b64_tr_b16 v[56:57], v127 offset:61440
    s_waitcnt vmcnt(1)
    v_mfma_f32_16x16x32_bf16 v[12:15], v[28:31], v[116:119], v[12:15]
    ds_read_b64_tr_b16 v[58:59], v127 offset:61952
    v_lshlrev_b32 v92, 11, v92
    s_waitcnt lgkmcnt(7)
    v_mfma_f32_16x16x32_bf16 v[16:19], v[32:35], v[116:119], v[16:19]
    v_bfe_u32 v97, v96, 4, 1
    v_lshl_add_u32 v92, v97, 5, v92
    v_mfma_f32_16x16x32_bf16 v[20:23], v[36:39], v[116:119], v[20:23]
    v_lshrrev_b32 v97, 5, v96
    v_lshl_add_u32 v92, v97, 4, v92
    v_add_u32 v92, s82, v92
    v_mfma_f32_16x16x32_bf16 v[24:27], v[40:43], v[116:119], v[24:27]
    s_waitcnt vmcnt(0) lgkmcnt(1)
    v_mfma_f32_16x16x32_bf16 v[12:15], v[44:47], v[120:123], v[12:15]
    v_mfma_f32_16x16x32_bf16 v[16:19], v[48:51], v[120:123], v[16:19]
    v_mfma_f32_16x16x32_bf16 v[20:23], v[52:55], v[120:123], v[20:23]
    s_nop 5
    v_cvt_pk_bf16_f32 v2, v12, v13
    v_cvt_pk_bf16_f32 v3, v14, v15
    s_waitcnt lgkmcnt(0)
    v_mfma_f32_16x16x32_bf16 v[24:27], v[56:59], v[120:123], v[24:27]
    v_cvt_pk_bf16_f32 v4, v16, v17
    v_cvt_pk_bf16_f32 v5, v18, v19
    v_cvt_pk_bf16_f32 v6, v20, v21
    v_cvt_pk_bf16_f32 v7, v22, v23
    v_permlane16_swap_b32 v2, v4
    v_permlane16_swap_b32 v3, v5
    s_nop 1
    v_cvt_pk_bf16_f32 v8, v24, v25
    v_cvt_pk_bf16_f32 v9, v26, v27
    s_nop 0
    v_permlane16_swap_b32 v6, v8
    v_permlane16_swap_b32 v7, v9
    buffer_store_dwordx4 v[2:5], v92, s[32:35], 0 offen
    buffer_store_dwordx4 v[6:9], v92, s[32:35], 0 offen offset:64
L_end:
    s_endpgm
L5:
    s_nop 1
    buffer_store_dwordx4 v[100:103], v126, s[36:39], s64 offen sc1
    buffer_store_dwordx4 v[108:111], v126, s[36:39], s65 offen sc1
    s_nop 1
    s_branch L6
L7:
    buffer_store_dword v47, off, s[36:39], s74 sc1
    s_nop 1
    s_branch L8
L10:
    buffer_store_dwordx4 v[2:5], v92, s[36:39], s70 offen sc1
    buffer_store_dwordx4 v[6:9], v92, s[36:39], s71 offen sc1
    s_nop 1
    s_branch L11
L12:
    buffer_store_dword v94, v93, s[36:39], s72 offen sc1
    s_nop 1
    s_branch L13
L14:
    buffer_store_dword v98, off, s[36:39], s74 sc1
    s_nop 1
    s_branch L15
L17:
    buffer_store_dwordx4 v[108:111], v0, s[36:39], s82 offen sc1
    buffer_store_dwordx4 v[112:115], v0, s[36:39], s82 offen offset:1024 sc1
    s_nop 1
    s_branch L18
L19:
    buffer_store_dwordx4 v[116:119], v20, s[36:39], s82 offen offset:2048 sc1
    s_nop 1
    s_branch L20
L21:
    buffer_store_dword v58, off, s[36:39], s74 sc1
    s_nop 1
    s_branch L22
L28:
    buffer_load_dwordx4 v[108:111], v58, s[36:39], s85 offen sc1
    s_sub_u32 s49, s49, 1
    s_cbranch_scc1 L_end
    s_waitcnt vmcnt(0)
    v_cmp_eq_u32 vcc, -1, v108
    s_cbranch_vccnz L28
    s_branch L27
L29:
    buffer_store_dwordx4 v[28:31], v22, s[36:39], s64 offen sc1
    buffer_store_dwordx4 v[32:35], v22, s[36:39], s65 offen sc1
    s_nop 1
    s_branch L30
L31:
    buffer_store_dword v23, off, s[36:39], s74 sc1
    s_nop 1
    s_branch L32
L34:
    buffer_store_dwordx4 v[2:5], v92, s[36:39], s70 offen sc1
    buffer_store_dwordx4 v[6:9], v92, s[36:39], s71 offen sc1
    s_nop 1
    s_branch L35
L36:
    buffer_store_dword v94, v93, s[36:39], s72 offen sc1
    s_nop 1
    s_branch L37
L38:
    buffer_store_dword v98, off, s[36:39], s74 sc1
    s_nop 1
    s_branch L39
L41:
    s_sub_u32 s49, s49, 1
    s_cbranch_scc1 L_end
    s_add_u32 m0, s62, 65536
    s_nop 0
    buffer_load_dwordx4 v19, s[36:39], m0 offen sc1 lds
    s_add_u32 m0, s62, 69632
    s_nop 0
    buffer_load_dwordx4 v19, s[36:39], m0 offen sc1 lds
    s_add_u32 m0, s62, 73728
    s_nop 0
    buffer_load_dwordx4 v19, s[36:39], m0 offen sc1 lds
    s_add_u32 m0, s62, 77824
    s_nop 0
    buffer_load_dwordx4 v19, s[36:39], m0 offen sc1 lds
    buffer_load_dword v112, v16, s[36:39], s97 offen offset:0 sc1
    buffer_load_dword v113, v16, s[36:39], s97 offen offset:128 sc1
    buffer_load_dword v114, v16, s[36:39], s97 offen offset:256 sc1
    buffer_load_dword v115, v16, s[36:39], s97 offen offset:384 sc1
    s_waitcnt vmcnt(0)
    ds_read_b32 v92, v18 offset:0
    ds_read_b32 v93, v18 offset:4096
    ds_read_b32 v94, v18 offset:8192
    ds_read_b32 v95, v18 offset:12288
    s_waitcnt lgkmcnt(0)
    v_max3_u32 v21, v92, v93, v94
    v_max3_u32 v21, v21, v95, v112
    v_max3_u32 v21, v21, v113, v114
    v_max_u32 v21, v21, v115
    v_cmp_eq_u32 vcc, -1, v21
    s_cbranch_vccnz L41
    s_branch L42
L43:
    buffer_store_dwordx4 v[100:103], v126, s[36:39], s64 offen sc1
    buffer_store_dwordx4 v[108:111], v126, s[36:39], s65 offen sc1
    s_nop 1
    s_branch L44
L45:
    buffer_store_dword v47, off, s[36:39], s74 sc1
    s_nop 1
    s_branch L46
L48:
    buffer_store_dwordx4 v[2:5], v92, s[36:39], s70 offen sc1
    buffer_store_dwordx4 v[6:9], v92, s[36:39], s71 offen sc1
    s_nop 1
    s_branch L49
L50:
    buffer_store_dword v94, v93, s[36:39], s72 offen sc1
    s_nop 1
    s_branch L51
L52:
    buffer_store_dword v98, off, s[36:39], s74 sc1
    s_nop 1
    s_branch L53
L55:
    buffer_store_dwordx4 v[108:111], v0, s[36:39], s82 offen sc1
    buffer_store_dwordx4 v[112:115], v0, s[36:39], s82 offen offset:1024 sc1
    s_nop 1
    s_branch L56
L57:
    buffer_store_dwordx4 v[116:119], v20, s[36:39], s82 offen offset:2048 sc1
    s_nop 1
    s_branch L58
L59:
    buffer_store_dword v58, off, s[36:39], s74 sc1
    s_nop 1
    s_branch L60
L66:
    buffer_load_dwordx4 v[108:111], v58, s[36:39], s85 offen sc1
    s_sub_u32 s49, s49, 1
    s_cbranch_scc1 L_end
    s_waitcnt vmcnt(0)
    v_cmp_eq_u32 vcc, -1, v108
    s_cbranch_vccnz L66
    s_branch L65
L67:
    buffer_store_dwordx4 v[28:31], v22, s[36:39], s64 offen sc1
    buffer_store_dwordx4 v[32:35], v22, s[36:39], s65 offen sc1
    s_nop 1
    s_branch L68
L69:
    buffer_store_dword v23, off, s[36:39], s74 sc1
    s_nop 1
    s_branch L70
L_last:
.fill 64, 4, 0xbf800000
.section .rodata,"a"
.p2align 6
.amdhsa_kernel interleave_layers__sliding_local_dilated__linear_kernel_hedgehog__prompt_kernel
  .amdhsa_next_free_vgpr 512
  .amdhsa_next_free_sgpr 102
  .amdhsa_accum_offset 256
  .amdhsa_group_segment_fixed_size 0
  .amdhsa_kernarg_size 80
  .amdhsa_user_sgpr_count 2
  .amdhsa_user_sgpr_kernarg_segment_ptr 1
  .amdhsa_system_sgpr_workgroup_id_x 1
.end_amdhsa_kernel
```
